```python
import torch

def _softmax(x, axis=-1):
    return torch.softmax(x, dim=axis)
def _gelu(x):
    return torch.nn.functional.gelu(x, approximate="tanh")
def _silu(x):
    return torch.nn.functional.silu(x)
def _sigmoid(x):
    return torch.sigmoid(x)
def _layernorm(x, axis=-1, eps=1e-5):
    m = x.mean(dim=axis, keepdim=True)
    v = x.var(dim=axis, keepdim=True, unbiased=False)
    return (x - m) / torch.sqrt(v + eps)
def _scatter_add(tgt, idx, src, axis=0):
    return tgt.clone().index_add_(axis, idx, src)
def _segment_sum(src, seg, n):
    out = torch.zeros((n,) + src.shape[1:], dtype=src.dtype)
    return out.index_add_(0, seg, src)
def _pad(x, pw):
    flat = tuple(v for pair in reversed(pw) for v in pair)
    return torch.nn.functional.pad(x, flat)

kernel_name = 'interleave_layers__linear_kernel_hedgehog__softmax_full_mha__prompt'

def setup_inputs():

    _w = (lambda a: (lambda t: t.to(torch.bfloat16) if t.is_floating_point() else t)(torch.as_tensor(a)))
    def _A_setup():
        B, S, D, H = 1, 2048, 576, 32
        Dh = D // H
        return {
            "x": _w((lambda *s: torch.randn(*s, dtype=torch.bfloat16) * 0.05)(B, S, D)),
            "wqkv": _w((lambda *s: torch.randn(*s, dtype=torch.bfloat16) * 0.4)(D, 3 * D)),
            "w_phi": _w((lambda *s: torch.randn(*s, dtype=torch.bfloat16) * 0.4)(H, Dh, Dh) * (Dh ** -0.5)),
            "wo": _w((lambda *s: torch.randn(*s, dtype=torch.bfloat16) * 0.05)(D, D)),
        }
    _A_in = _A_setup()

    def _B_setup():
        B, S, D = 1, 2048, 576
        return {
            "x": _w((lambda *s: torch.randn(*s, dtype=torch.bfloat16) * 0.05)(B, S, D)),
            "wqkv": _w((lambda *s: torch.randn(*s, dtype=torch.bfloat16) * 0.1)(D, 3 * D)),
            "wo": _w((lambda *s: torch.randn(*s, dtype=torch.bfloat16) * 0.05)(D, D)),
        }
    _B_in = _B_setup()

    return {
        "A_x": _A_in["x"],
        "A_wqkv": _A_in["wqkv"],
        "A_w_phi": _A_in["w_phi"],
        "A_wo": _A_in["wo"],
        "B_x": _B_in["x"],
        "B_wqkv": _B_in["wqkv"],
        "B_wo": _B_in["wo"],
    }

def reference(A_x, A_wqkv, A_w_phi, A_wo, B_x, B_wqkv, B_wo):
    def _A_ref(x, wqkv, w_phi, wo):
        B, S, D = x.shape
        H = 32; Dh = D // H
        qkv = (lambda x, *d: x.permute(*d))((x @ wqkv).reshape(B, S, 3, H, Dh), 2, 0, 3, 1, 4)
        q, k, v = qkv[0], qkv[1], qkv[2]
        pq = torch.einsum("bhsd,hdf->bhsf", q, w_phi)
        pk = torch.einsum("bhsd,hdf->bhsf", k, w_phi)
        phi_q = torch.concatenate([_softmax(pq, axis=-1), _softmax(-pq, axis=-1)], axis=-1)
        phi_k = torch.concatenate([_softmax(pk, axis=-1), _softmax(-pk, axis=-1)], axis=-1)
        kv = torch.einsum("bhsf,bhsd->bhfd", phi_k, v)
        z  = torch.einsum("bhsf->bhf", phi_k)
        num = torch.einsum("bhqf,bhfd->bhqd", phi_q, kv)
        den = torch.einsum("bhqf,bhf->bhq", phi_q, z)[..., None] + 1e-6
        o = num / den
        return (lambda x, *d: x.permute(*d))(o, 0, 2, 1, 3).reshape(B, S, D) @ wo

    def _B_ref(x, wqkv, wo):
        B, S, D = x.shape
        H = 32; Dh = D // H
        qkv = (lambda x, *d: x.permute(*d))((x @ wqkv).reshape(B, S, 3, H, Dh), 2, 0, 3, 1, 4)
        q, k, v = qkv[0], qkv[1], qkv[2]
        scale = Dh ** -0.5
        scores = torch.einsum("bhqd,bhkd->bhqk", q, k) * scale
        p = _softmax(scores, axis=-1)
        o = torch.einsum("bhqk,bhkd->bhqd", p, v)
        return (lambda x, *d: x.permute(*d))(o, 0, 2, 1, 3).reshape(B, S, D) @ wo

    x = A_x
    x = x + _A_ref(_layernorm(x, axis=-1), A_wqkv, A_w_phi, A_wo)
    x = x + _B_ref(_layernorm(x, axis=-1), B_wqkv, B_wo)
    x = x + _A_ref(_layernorm(x, axis=-1), A_wqkv, A_w_phi, A_wo)
    x = x + _B_ref(_layernorm(x, axis=-1), B_wqkv, B_wo)
    return x
```

```asm
; @launch kernel=ln0_kernel grid=(256,1,1) block=(256,1,1) lds=0
; @launch kernel=qkva_kernel grid=(432,1,1) block=(256,1,1) lds=61440
; @launch kernel=kvred_kernel grid=(256,1,1) block=(512,1,1) lds=65536
; @launch kernel=apply_kernel grid=(512,1,1) block=(256,1,1) lds=32768
; @launch kernel=op0_kernel grid=(144,1,1) block=(256,1,1) lds=61440
; @launch kernel=ln1_kernel grid=(256,1,1) block=(256,1,1) lds=0
; @launch kernel=qkvb_kernel grid=(432,1,1) block=(256,1,1) lds=61440
; @launch kernel=attn_kernel grid=(256,1,1) block=(512,1,1) lds=36864
; @launch kernel=op1_kernel grid=(144,1,1) block=(256,1,1) lds=61440
; @launch kernel=ln2_kernel grid=(256,1,1) block=(256,1,1) lds=0
; @launch kernel=qkva_kernel grid=(432,1,1) block=(256,1,1) lds=61440
; @launch kernel=kvred_kernel grid=(256,1,1) block=(512,1,1) lds=65536
; @launch kernel=apply_kernel grid=(512,1,1) block=(256,1,1) lds=32768
; @launch kernel=op2_kernel grid=(144,1,1) block=(256,1,1) lds=61440
; @launch kernel=ln3_kernel grid=(256,1,1) block=(256,1,1) lds=0
; @launch kernel=qkvb_kernel grid=(432,1,1) block=(256,1,1) lds=61440
; @launch kernel=attn_kernel grid=(256,1,1) block=(512,1,1) lds=36864
; @launch kernel=op3_kernel grid=(144,1,1) block=(256,1,1) lds=61440
.amdgcn_target "amdgcn-amd-amdhsa--gfx950"
.text
.globl qkva_kernel
.p2align 8
.type qkva_kernel,@function
qkva_kernel:
    s_load_dwordx2 s[4:5], s[0:1], 72
    s_load_dwordx2 s[6:7], s[0:1], 8
    s_load_dwordx2 s[8:9], s[0:1], 72
    s_cmp_ge_u32 s2, 432
    s_cbranch_scc1 qkva_kernel_done
    s_waitcnt lgkmcnt(0)
    s_add_u32 s8, s8, 0x240000
    s_addc_u32 s9, s9, 0
    s_mov_b32 s12, s4
    s_and_b32 s13, s5, 0xffff
    s_mov_b32 s14, 0x240000
    s_mov_b32 s15, 0x20000
    s_mov_b32 s16, s6
    s_and_b32 s17, s7, 0xffff
    s_mov_b32 s18, 0x1e6000
    s_mov_b32 s19, 0x20000
    s_mov_b32 s20, s8
    s_and_b32 s21, s9, 0xffff
    s_mov_b32 s22, 0x6c0000
    s_mov_b32 s23, 0x20000
    s_mov_b32 s30, 0x97b425f
    s_mul_hi_u32 s28, s2, s30
    s_mul_i32 s30, s28, 27
    s_sub_u32 s29, s2, s30
    s_lshl_b32 s30, s28, 7
    v_lshrrev_b32 v7, 1, v0
    v_add_u32 v8, s30, v7
    v_mul_u32_u24 v1, 1152, v8
    v_and_b32 v8, 1, v0
    v_lshlrev_b32 v8, 6, v8
    v_add_u32 v1, v1, v8
    v_mul_u32_u24 v3, 144, v7
    v_add_u32 v3, v3, v8
    v_lshrrev_b32 v7, 2, v0
    v_mul_u32_u24 v2, 3456, v7
    v_and_b32 v8, 3, v0
    v_lshlrev_b32 v8, 5, v8
    v_add_u32 v2, v2, v8
    s_lshl_b32 s31, s29, 7
    v_add_u32 v2, s31, v2
    v_mul_u32_u24 v4, 192, v7
    v_add_u32 v4, v4, v8
    v_add_u32 v4, 18432, v4
    v_lshrrev_b32 v7, 6, v0
    v_lshlrev_b32 v7, 5, v7
    v_and_b32 v8, 31, v0
    v_add_u32 v7, v7, v8
    v_mul_u32_u24 v5, 144, v7
    v_bfe_u32 v8, v0, 5, 1
    v_lshlrev_b32 v8, 4, v8
    v_add_u32 v5, v5, v8
    v_bfe_u32 v7, v0, 5, 1
    v_lshlrev_b32 v7, 3, v7
    v_bfe_u32 v8, v0, 2, 2
    v_add_u32 v7, v7, v8
    v_mul_u32_u24 v6, 192, v7
    v_bfe_u32 v7, v0, 4, 1
    v_lshlrev_b32 v7, 5, v7
    v_and_b32 v8, 3, v0
    v_lshlrev_b32 v8, 3, v8
    v_add3_u32 v6, v6, v7, v8
    v_add_u32 v6, 18432, v6
    v_mov_b32 v108, 0
    v_mov_b32 v109, 0
    v_mov_b32 v110, 0
    v_mov_b32 v111, 0
    v_mov_b32 v112, 0
    v_mov_b32 v113, 0
    v_mov_b32 v114, 0
    v_mov_b32 v115, 0
    v_mov_b32 v116, 0
    v_mov_b32 v117, 0
    v_mov_b32 v118, 0
    v_mov_b32 v119, 0
    v_mov_b32 v120, 0
    v_mov_b32 v121, 0
    v_mov_b32 v122, 0
    v_mov_b32 v123, 0
    v_mov_b32 v124, 0
    v_mov_b32 v125, 0
    v_mov_b32 v126, 0
    v_mov_b32 v127, 0
    v_mov_b32 v128, 0
    v_mov_b32 v129, 0
    v_mov_b32 v130, 0
    v_mov_b32 v131, 0
    v_mov_b32 v132, 0
    v_mov_b32 v133, 0
    v_mov_b32 v134, 0
    v_mov_b32 v135, 0
    v_mov_b32 v136, 0
    v_mov_b32 v137, 0
    v_mov_b32 v138, 0
    v_mov_b32 v139, 0
    buffer_load_dwordx4 v[12:15], v1, s[12:15], 0 offen offset:0
    buffer_load_dwordx4 v[16:19], v1, s[12:15], 0 offen offset:16
    buffer_load_dwordx4 v[20:23], v1, s[12:15], 0 offen offset:32
    buffer_load_dwordx4 v[24:27], v1, s[12:15], 0 offen offset:48
    s_mov_b32 s32, 0x0
    buffer_load_dwordx4 v[44:47], v2, s[16:19], s32 offen offset:0
    buffer_load_dwordx4 v[48:51], v2, s[16:19], s32 offen offset:16
    buffer_load_dwordx4 v[28:31], v1, s[12:15], 0 offen offset:128
    buffer_load_dwordx4 v[32:35], v1, s[12:15], 0 offen offset:144
    buffer_load_dwordx4 v[36:39], v1, s[12:15], 0 offen offset:160
    buffer_load_dwordx4 v[40:43], v1, s[12:15], 0 offen offset:176
    s_mov_b32 s32, 0x36000
    buffer_load_dwordx4 v[52:55], v2, s[16:19], s32 offen offset:0
    buffer_load_dwordx4 v[56:59], v2, s[16:19], s32 offen offset:16
    s_waitcnt vmcnt(6)
    ds_write_b128 v3, v[12:15] offset:0
    ds_write_b128 v3, v[16:19] offset:16
    ds_write_b128 v3, v[20:23] offset:32
    ds_write_b128 v3, v[24:27] offset:48
    ds_write_b128 v4, v[44:47] offset:0
    ds_write_b128 v4, v[48:51] offset:16
    s_waitcnt lgkmcnt(0)
    s_barrier
    buffer_load_dwordx4 v[12:15], v1, s[12:15], 0 offen offset:256
    buffer_load_dwordx4 v[16:19], v1, s[12:15], 0 offen offset:272
    buffer_load_dwordx4 v[20:23], v1, s[12:15], 0 offen offset:288
    buffer_load_dwordx4 v[24:27], v1, s[12:15], 0 offen offset:304
    s_mov_b32 s32, 0x6c000
    buffer_load_dwordx4 v[44:47], v2, s[16:19], s32 offen offset:0
    buffer_load_dwordx4 v[48:51], v2, s[16:19], s32 offen offset:16
    ds_read_b128 v[60:63], v5 offset:0
    ds_read_b64_tr_b16 v[76:77], v6 offset:0
    ds_read_b64_tr_b16 v[78:79], v6 offset:768
    ds_read_b64_tr_b16 v[80:81], v6 offset:64
    ds_read_b64_tr_b16 v[82:83], v6 offset:832
    ds_read_b128 v[64:67], v5 offset:32
    ds_read_b64_tr_b16 v[84:85], v6 offset:3072
    ds_read_b64_tr_b16 v[86:87], v6 offset:3840
    ds_read_b64_tr_b16 v[88:89], v6 offset:3136
    ds_read_b64_tr_b16 v[90:91], v6 offset:3904
    ds_read_b128 v[68:71], v5 offset:64
    ds_read_b64_tr_b16 v[92:93], v6 offset:6144
    ds_read_b64_tr_b16 v[94:95], v6 offset:6912
    ds_read_b64_tr_b16 v[96:97], v6 offset:6208
    ds_read_b64_tr_b16 v[98:99], v6 offset:6976
    ds_read_b128 v[72:75], v5 offset:96
    ds_read_b64_tr_b16 v[100:101], v6 offset:9216
    ds_read_b64_tr_b16 v[102:103], v6 offset:9984
    ds_read_b64_tr_b16 v[104:105], v6 offset:9280
    ds_read_b64_tr_b16 v[106:107], v6 offset:10048
    s_waitcnt lgkmcnt(15)
    v_mfma_f32_32x32x16_bf16 v[108:123], v[76:79], v[60:63], v[108:123]
    v_mfma_f32_32x32x16_bf16 v[124:139], v[80:83], v[60:63], v[124:139]
    s_waitcnt lgkmcnt(10)
    v_mfma_f32_32x32x16_bf16 v[108:123], v[84:87], v[64:67], v[108:123]
    v_mfma_f32_32x32x16_bf16 v[124:139], v[88:91], v[64:67], v[124:139]
    s_waitcnt lgkmcnt(5)
    v_mfma_f32_32x32x16_bf16 v[108:123], v[92:95], v[68:71], v[108:123]
    v_mfma_f32_32x32x16_bf16 v[124:139], v[96:99], v[68:71], v[124:139]
    s_waitcnt lgkmcnt(0)
    v_mfma_f32_32x32x16_bf16 v[108:123], v[100:103], v[72:75], v[108:123]
    v_mfma_f32_32x32x16_bf16 v[124:139], v[104:107], v[72:75], v[124:139]
    s_waitcnt vmcnt(6)
    ds_write_b128 v3, v[28:31] offset:30720
    ds_write_b128 v3, v[32:35] offset:30736
    ds_write_b128 v3, v[36:39] offset:30752
    ds_write_b128 v3, v[40:43] offset:30768
    ds_write_b128 v4, v[52:55] offset:30720
    ds_write_b128 v4, v[56:59] offset:30736
    s_waitcnt lgkmcnt(0)
    s_barrier
    buffer_load_dwordx4 v[28:31], v1, s[12:15], 0 offen offset:384
    buffer_load_dwordx4 v[32:35], v1, s[12:15], 0 offen offset:400
    buffer_load_dwordx4 v[36:39], v1, s[12:15], 0 offen offset:416
    buffer_load_dwordx4 v[40:43], v1, s[12:15], 0 offen offset:432
    s_mov_b32 s32, 0xa2000
    buffer_load_dwordx4 v[52:55], v2, s[16:19], s32 offen offset:0
    buffer_load_dwordx4 v[56:59], v2, s[16:19], s32 offen offset:16
    ds_read_b128 v[60:63], v5 offset:30720
    ds_read_b64_tr_b16 v[76:77], v6 offset:30720
    ds_read_b64_tr_b16 v[78:79], v6 offset:31488
    ds_read_b64_tr_b16 v[80:81], v6 offset:30784
    ds_read_b64_tr_b16 v[82:83], v6 offset:31552
    ds_read_b128 v[64:67], v5 offset:30752
    ds_read_b64_tr_b16 v[84:85], v6 offset:33792
    ds_read_b64_tr_b16 v[86:87], v6 offset:34560
    ds_read_b64_tr_b16 v[88:89], v6 offset:33856
    ds_read_b64_tr_b16 v[90:91], v6 offset:34624
    ds_read_b128 v[68:71], v5 offset:30784
    ds_read_b64_tr_b16 v[92:93], v6 offset:36864
    ds_read_b64_tr_b16 v[94:95], v6 offset:37632
    ds_read_b64_tr_b16 v[96:97], v6 offset:36928
    ds_read_b64_tr_b16 v[98:99], v6 offset:37696
    ds_read_b128 v[72:75], v5 offset:30816
    ds_read_b64_tr_b16 v[100:101], v6 offset:39936
    ds_read_b64_tr_b16 v[102:103], v6 offset:40704
    ds_read_b64_tr_b16 v[104:105], v6 offset:40000
    ds_read_b64_tr_b16 v[106:107], v6 offset:40768
    s_waitcnt lgkmcnt(15)
    v_mfma_f32_32x32x16_bf16 v[108:123], v[76:79], v[60:63], v[108:123]
    v_mfma_f32_32x32x16_bf16 v[124:139], v[80:83], v[60:63], v[124:139]
    s_waitcnt lgkmcnt(10)
    v_mfma_f32_32x32x16_bf16 v[108:123], v[84:87], v[64:67], v[108:123]
    v_mfma_f32_32x32x16_bf16 v[124:139], v[88:91], v[64:67], v[124:139]
    s_waitcnt lgkmcnt(5)
    v_mfma_f32_32x32x16_bf16 v[108:123], v[92:95], v[68:71], v[108:123]
    v_mfma_f32_32x32x16_bf16 v[124:139], v[96:99], v[68:71], v[124:139]
    s_waitcnt lgkmcnt(0)
    v_mfma_f32_32x32x16_bf16 v[108:123], v[100:103], v[72:75], v[108:123]
    v_mfma_f32_32x32x16_bf16 v[124:139], v[104:107], v[72:75], v[124:139]
    s_waitcnt vmcnt(6)
    ds_write_b128 v3, v[12:15] offset:0
    ds_write_b128 v3, v[16:19] offset:16
    ds_write_b128 v3, v[20:23] offset:32
    ds_write_b128 v3, v[24:27] offset:48
    ds_write_b128 v4, v[44:47] offset:0
    ds_write_b128 v4, v[48:51] offset:16
    s_waitcnt lgkmcnt(0)
    s_barrier
    buffer_load_dwordx4 v[12:15], v1, s[12:15], 0 offen offset:512
    buffer_load_dwordx4 v[16:19], v1, s[12:15], 0 offen offset:528
    buffer_load_dwordx4 v[20:23], v1, s[12:15], 0 offen offset:544
    buffer_load_dwordx4 v[24:27], v1, s[12:15], 0 offen offset:560
    s_mov_b32 s32, 0xd8000
    buffer_load_dwordx4 v[44:47], v2, s[16:19], s32 offen offset:0
    buffer_load_dwordx4 v[48:51], v2, s[16:19], s32 offen offset:16
    ds_read_b128 v[60:63], v5 offset:0
    ds_read_b64_tr_b16 v[76:77], v6 offset:0
    ds_read_b64_tr_b16 v[78:79], v6 offset:768
    ds_read_b64_tr_b16 v[80:81], v6 offset:64
    ds_read_b64_tr_b16 v[82:83], v6 offset:832
    ds_read_b128 v[64:67], v5 offset:32
    ds_read_b64_tr_b16 v[84:85], v6 offset:3072
    ds_read_b64_tr_b16 v[86:87], v6 offset:3840
    ds_read_b64_tr_b16 v[88:89], v6 offset:3136
    ds_read_b64_tr_b16 v[90:91], v6 offset:3904
    ds_read_b128 v[68:71], v5 offset:64
    ds_read_b64_tr_b16 v[92:93], v6 offset:6144
    ds_read_b64_tr_b16 v[94:95], v6 offset:6912
    ds_read_b64_tr_b16 v[96:97], v6 offset:6208
    ds_read_b64_tr_b16 v[98:99], v6 offset:6976
    ds_read_b128 v[72:75], v5 offset:96
    ds_read_b64_tr_b16 v[100:101], v6 offset:9216
    ds_read_b64_tr_b16 v[102:103], v6 offset:9984
    ds_read_b64_tr_b16 v[104:105], v6 offset:9280
    ds_read_b64_tr_b16 v[106:107], v6 offset:10048
    s_waitcnt lgkmcnt(15)
    v_mfma_f32_32x32x16_bf16 v[108:123], v[76:79], v[60:63], v[108:123]
    v_mfma_f32_32x32x16_bf16 v[124:139], v[80:83], v[60:63], v[124:139]
    s_waitcnt lgkmcnt(10)
    v_mfma_f32_32x32x16_bf16 v[108:123], v[84:87], v[64:67], v[108:123]
    v_mfma_f32_32x32x16_bf16 v[124:139], v[88:91], v[64:67], v[124:139]
    s_waitcnt lgkmcnt(5)
    v_mfma_f32_32x32x16_bf16 v[108:123], v[92:95], v[68:71], v[108:123]
    v_mfma_f32_32x32x16_bf16 v[124:139], v[96:99], v[68:71], v[124:139]
    s_waitcnt lgkmcnt(0)
    v_mfma_f32_32x32x16_bf16 v[108:123], v[100:103], v[72:75], v[108:123]
    v_mfma_f32_32x32x16_bf16 v[124:139], v[104:107], v[72:75], v[124:139]
    s_waitcnt vmcnt(6)
    ds_write_b128 v3, v[28:31] offset:30720
    ds_write_b128 v3, v[32:35] offset:30736
    ds_write_b128 v3, v[36:39] offset:30752
    ds_write_b128 v3, v[40:43] offset:30768
    ds_write_b128 v4, v[52:55] offset:30720
    ds_write_b128 v4, v[56:59] offset:30736
    s_waitcnt lgkmcnt(0)
    s_barrier
    buffer_load_dwordx4 v[28:31], v1, s[12:15], 0 offen offset:640
    buffer_load_dwordx4 v[32:35], v1, s[12:15], 0 offen offset:656
    buffer_load_dwordx4 v[36:39], v1, s[12:15], 0 offen offset:672
    buffer_load_dwordx4 v[40:43], v1, s[12:15], 0 offen offset:688
    s_mov_b32 s32, 0x10e000
    buffer_load_dwordx4 v[52:55], v2, s[16:19], s32 offen offset:0
    buffer_load_dwordx4 v[56:59], v2, s[16:19], s32 offen offset:16
    ds_read_b128 v[60:63], v5 offset:30720
    ds_read_b64_tr_b16 v[76:77], v6 offset:30720
    ds_read_b64_tr_b16 v[78:79], v6 offset:31488
    ds_read_b64_tr_b16 v[80:81], v6 offset:30784
    ds_read_b64_tr_b16 v[82:83], v6 offset:31552
    ds_read_b128 v[64:67], v5 offset:30752
    ds_read_b64_tr_b16 v[84:85], v6 offset:33792
    ds_read_b64_tr_b16 v[86:87], v6 offset:34560
    ds_read_b64_tr_b16 v[88:89], v6 offset:33856
    ds_read_b64_tr_b16 v[90:91], v6 offset:34624
    ds_read_b128 v[68:71], v5 offset:30784
    ds_read_b64_tr_b16 v[92:93], v6 offset:36864
    ds_read_b64_tr_b16 v[94:95], v6 offset:37632
    ds_read_b64_tr_b16 v[96:97], v6 offset:36928
    ds_read_b64_tr_b16 v[98:99], v6 offset:37696
    ds_read_b128 v[72:75], v5 offset:30816
    ds_read_b64_tr_b16 v[100:101], v6 offset:39936
    ds_read_b64_tr_b16 v[102:103], v6 offset:40704
    ds_read_b64_tr_b16 v[104:105], v6 offset:40000
    ds_read_b64_tr_b16 v[106:107], v6 offset:40768
    s_waitcnt lgkmcnt(15)
    v_mfma_f32_32x32x16_bf16 v[108:123], v[76:79], v[60:63], v[108:123]
    v_mfma_f32_32x32x16_bf16 v[124:139], v[80:83], v[60:63], v[124:139]
    s_waitcnt lgkmcnt(10)
    v_mfma_f32_32x32x16_bf16 v[108:123], v[84:87], v[64:67], v[108:123]
    v_mfma_f32_32x32x16_bf16 v[124:139], v[88:91], v[64:67], v[124:139]
    s_waitcnt lgkmcnt(5)
    v_mfma_f32_32x32x16_bf16 v[108:123], v[92:95], v[68:71], v[108:123]
    v_mfma_f32_32x32x16_bf16 v[124:139], v[96:99], v[68:71], v[124:139]
    s_waitcnt lgkmcnt(0)
    v_mfma_f32_32x32x16_bf16 v[108:123], v[100:103], v[72:75], v[108:123]
    v_mfma_f32_32x32x16_bf16 v[124:139], v[104:107], v[72:75], v[124:139]
    s_waitcnt vmcnt(6)
    ds_write_b128 v3, v[12:15] offset:0
    ds_write_b128 v3, v[16:19] offset:16
    ds_write_b128 v3, v[20:23] offset:32
    ds_write_b128 v3, v[24:27] offset:48
    ds_write_b128 v4, v[44:47] offset:0
    ds_write_b128 v4, v[48:51] offset:16
    s_waitcnt lgkmcnt(0)
    s_barrier
    buffer_load_dwordx4 v[12:15], v1, s[12:15], 0 offen offset:768
    buffer_load_dwordx4 v[16:19], v1, s[12:15], 0 offen offset:784
    buffer_load_dwordx4 v[20:23], v1, s[12:15], 0 offen offset:800
    buffer_load_dwordx4 v[24:27], v1, s[12:15], 0 offen offset:816
    s_mov_b32 s32, 0x144000
    buffer_load_dwordx4 v[44:47], v2, s[16:19], s32 offen offset:0
    buffer_load_dwordx4 v[48:51], v2, s[16:19], s32 offen offset:16
    ds_read_b128 v[60:63], v5 offset:0
    ds_read_b64_tr_b16 v[76:77], v6 offset:0
    ds_read_b64_tr_b16 v[78:79], v6 offset:768
    ds_read_b64_tr_b16 v[80:81], v6 offset:64
    ds_read_b64_tr_b16 v[82:83], v6 offset:832
    ds_read_b128 v[64:67], v5 offset:32
    ds_read_b64_tr_b16 v[84:85], v6 offset:3072
    ds_read_b64_tr_b16 v[86:87], v6 offset:3840
    ds_read_b64_tr_b16 v[88:89], v6 offset:3136
    ds_read_b64_tr_b16 v[90:91], v6 offset:3904
    ds_read_b128 v[68:71], v5 offset:64
    ds_read_b64_tr_b16 v[92:93], v6 offset:6144
    ds_read_b64_tr_b16 v[94:95], v6 offset:6912
    ds_read_b64_tr_b16 v[96:97], v6 offset:6208
    ds_read_b64_tr_b16 v[98:99], v6 offset:6976
    ds_read_b128 v[72:75], v5 offset:96
    ds_read_b64_tr_b16 v[100:101], v6 offset:9216
    ds_read_b64_tr_b16 v[102:103], v6 offset:9984
    ds_read_b64_tr_b16 v[104:105], v6 offset:9280
    ds_read_b64_tr_b16 v[106:107], v6 offset:10048
    s_waitcnt lgkmcnt(15)
    v_mfma_f32_32x32x16_bf16 v[108:123], v[76:79], v[60:63], v[108:123]
    v_mfma_f32_32x32x16_bf16 v[124:139], v[80:83], v[60:63], v[124:139]
    s_waitcnt lgkmcnt(10)
    v_mfma_f32_32x32x16_bf16 v[108:123], v[84:87], v[64:67], v[108:123]
    v_mfma_f32_32x32x16_bf16 v[124:139], v[88:91], v[64:67], v[124:139]
    s_waitcnt lgkmcnt(5)
    v_mfma_f32_32x32x16_bf16 v[108:123], v[92:95], v[68:71], v[108:123]
    v_mfma_f32_32x32x16_bf16 v[124:139], v[96:99], v[68:71], v[124:139]
    s_waitcnt lgkmcnt(0)
    v_mfma_f32_32x32x16_bf16 v[108:123], v[100:103], v[72:75], v[108:123]
    v_mfma_f32_32x32x16_bf16 v[124:139], v[104:107], v[72:75], v[124:139]
    s_waitcnt vmcnt(6)
    ds_write_b128 v3, v[28:31] offset:30720
    ds_write_b128 v3, v[32:35] offset:30736
    ds_write_b128 v3, v[36:39] offset:30752
    ds_write_b128 v3, v[40:43] offset:30768
    ds_write_b128 v4, v[52:55] offset:30720
    ds_write_b128 v4, v[56:59] offset:30736
    s_waitcnt lgkmcnt(0)
    s_barrier
    buffer_load_dwordx4 v[28:31], v1, s[12:15], 0 offen offset:896
    buffer_load_dwordx4 v[32:35], v1, s[12:15], 0 offen offset:912
    buffer_load_dwordx4 v[36:39], v1, s[12:15], 0 offen offset:928
    buffer_load_dwordx4 v[40:43], v1, s[12:15], 0 offen offset:944
    s_mov_b32 s32, 0x17a000
    buffer_load_dwordx4 v[52:55], v2, s[16:19], s32 offen offset:0
    buffer_load_dwordx4 v[56:59], v2, s[16:19], s32 offen offset:16
    ds_read_b128 v[60:63], v5 offset:30720
    ds_read_b64_tr_b16 v[76:77], v6 offset:30720
    ds_read_b64_tr_b16 v[78:79], v6 offset:31488
    ds_read_b64_tr_b16 v[80:81], v6 offset:30784
    ds_read_b64_tr_b16 v[82:83], v6 offset:31552
    ds_read_b128 v[64:67], v5 offset:30752
    ds_read_b64_tr_b16 v[84:85], v6 offset:33792
    ds_read_b64_tr_b16 v[86:87], v6 offset:34560
    ds_read_b64_tr_b16 v[88:89], v6 offset:33856
    ds_read_b64_tr_b16 v[90:91], v6 offset:34624
    ds_read_b128 v[68:71], v5 offset:30784
    ds_read_b64_tr_b16 v[92:93], v6 offset:36864
    ds_read_b64_tr_b16 v[94:95], v6 offset:37632
    ds_read_b64_tr_b16 v[96:97], v6 offset:36928
    ds_read_b64_tr_b16 v[98:99], v6 offset:37696
    ds_read_b128 v[72:75], v5 offset:30816
    ds_read_b64_tr_b16 v[100:101], v6 offset:39936
    ds_read_b64_tr_b16 v[102:103], v6 offset:40704
    ds_read_b64_tr_b16 v[104:105], v6 offset:40000
    ds_read_b64_tr_b16 v[106:107], v6 offset:40768
    s_waitcnt lgkmcnt(15)
    v_mfma_f32_32x32x16_bf16 v[108:123], v[76:79], v[60:63], v[108:123]
    v_mfma_f32_32x32x16_bf16 v[124:139], v[80:83], v[60:63], v[124:139]
    s_waitcnt lgkmcnt(10)
    v_mfma_f32_32x32x16_bf16 v[108:123], v[84:87], v[64:67], v[108:123]
    v_mfma_f32_32x32x16_bf16 v[124:139], v[88:91], v[64:67], v[124:139]
    s_waitcnt lgkmcnt(5)
    v_mfma_f32_32x32x16_bf16 v[108:123], v[92:95], v[68:71], v[108:123]
    v_mfma_f32_32x32x16_bf16 v[124:139], v[96:99], v[68:71], v[124:139]
    s_waitcnt lgkmcnt(0)
    v_mfma_f32_32x32x16_bf16 v[108:123], v[100:103], v[72:75], v[108:123]
    v_mfma_f32_32x32x16_bf16 v[124:139], v[104:107], v[72:75], v[124:139]
    s_waitcnt vmcnt(6)
    ds_write_b128 v3, v[12:15] offset:0
    ds_write_b128 v3, v[16:19] offset:16
    ds_write_b128 v3, v[20:23] offset:32
    ds_write_b128 v3, v[24:27] offset:48
    ds_write_b128 v4, v[44:47] offset:0
    ds_write_b128 v4, v[48:51] offset:16
    s_waitcnt lgkmcnt(0)
    s_barrier
    buffer_load_dwordx4 v[12:15], v1, s[12:15], 0 offen offset:1024
    buffer_load_dwordx4 v[16:19], v1, s[12:15], 0 offen offset:1040
    buffer_load_dwordx4 v[20:23], v1, s[12:15], 0 offen offset:1056
    buffer_load_dwordx4 v[24:27], v1, s[12:15], 0 offen offset:1072
    s_mov_b32 s32, 0x1b0000
    buffer_load_dwordx4 v[44:47], v2, s[16:19], s32 offen offset:0
    buffer_load_dwordx4 v[48:51], v2, s[16:19], s32 offen offset:16
    ds_read_b128 v[60:63], v5 offset:0
    ds_read_b64_tr_b16 v[76:77], v6 offset:0
    ds_read_b64_tr_b16 v[78:79], v6 offset:768
    ds_read_b64_tr_b16 v[80:81], v6 offset:64
    ds_read_b64_tr_b16 v[82:83], v6 offset:832
    ds_read_b128 v[64:67], v5 offset:32
    ds_read_b64_tr_b16 v[84:85], v6 offset:3072
    ds_read_b64_tr_b16 v[86:87], v6 offset:3840
    ds_read_b64_tr_b16 v[88:89], v6 offset:3136
    ds_read_b64_tr_b16 v[90:91], v6 offset:3904
    ds_read_b128 v[68:71], v5 offset:64
    ds_read_b64_tr_b16 v[92:93], v6 offset:6144
    ds_read_b64_tr_b16 v[94:95], v6 offset:6912
    ds_read_b64_tr_b16 v[96:97], v6 offset:6208
    ds_read_b64_tr_b16 v[98:99], v6 offset:6976
    ds_read_b128 v[72:75], v5 offset:96
    ds_read_b64_tr_b16 v[100:101], v6 offset:9216
    ds_read_b64_tr_b16 v[102:103], v6 offset:9984
    ds_read_b64_tr_b16 v[104:105], v6 offset:9280
    ds_read_b64_tr_b16 v[106:107], v6 offset:10048
    s_waitcnt lgkmcnt(15)
    v_mfma_f32_32x32x16_bf16 v[108:123], v[76:79], v[60:63], v[108:123]
    v_mfma_f32_32x32x16_bf16 v[124:139], v[80:83], v[60:63], v[124:139]
    s_waitcnt lgkmcnt(10)
    v_mfma_f32_32x32x16_bf16 v[108:123], v[84:87], v[64:67], v[108:123]
    v_mfma_f32_32x32x16_bf16 v[124:139], v[88:91], v[64:67], v[124:139]
    s_waitcnt lgkmcnt(5)
    v_mfma_f32_32x32x16_bf16 v[108:123], v[92:95], v[68:71], v[108:123]
    v_mfma_f32_32x32x16_bf16 v[124:139], v[96:99], v[68:71], v[124:139]
    s_waitcnt lgkmcnt(0)
    v_mfma_f32_32x32x16_bf16 v[108:123], v[100:103], v[72:75], v[108:123]
    v_mfma_f32_32x32x16_bf16 v[124:139], v[104:107], v[72:75], v[124:139]
    s_waitcnt vmcnt(6)
    ds_write_b128 v3, v[28:31] offset:30720
    ds_write_b128 v3, v[32:35] offset:30736
    ds_write_b128 v3, v[36:39] offset:30752
    ds_write_b128 v3, v[40:43] offset:30768
    ds_write_b128 v4, v[52:55] offset:30720
    ds_write_b128 v4, v[56:59] offset:30736
    s_waitcnt lgkmcnt(0)
    s_barrier
    ds_read_b128 v[60:63], v5 offset:30720
    ds_read_b64_tr_b16 v[76:77], v6 offset:30720
    ds_read_b64_tr_b16 v[78:79], v6 offset:31488
    ds_read_b64_tr_b16 v[80:81], v6 offset:30784
    ds_read_b64_tr_b16 v[82:83], v6 offset:31552
    ds_read_b128 v[64:67], v5 offset:30752
    ds_read_b64_tr_b16 v[84:85], v6 offset:33792
    ds_read_b64_tr_b16 v[86:87], v6 offset:34560
    ds_read_b64_tr_b16 v[88:89], v6 offset:33856
    ds_read_b64_tr_b16 v[90:91], v6 offset:34624
    ds_read_b128 v[68:71], v5 offset:30784
    ds_read_b64_tr_b16 v[92:93], v6 offset:36864
    ds_read_b64_tr_b16 v[94:95], v6 offset:37632
    ds_read_b64_tr_b16 v[96:97], v6 offset:36928
    ds_read_b64_tr_b16 v[98:99], v6 offset:37696
    ds_read_b128 v[72:75], v5 offset:30816
    ds_read_b64_tr_b16 v[100:101], v6 offset:39936
    ds_read_b64_tr_b16 v[102:103], v6 offset:40704
    ds_read_b64_tr_b16 v[104:105], v6 offset:40000
    ds_read_b64_tr_b16 v[106:107], v6 offset:40768
    s_waitcnt lgkmcnt(15)
    v_mfma_f32_32x32x16_bf16 v[108:123], v[76:79], v[60:63], v[108:123]
    v_mfma_f32_32x32x16_bf16 v[124:139], v[80:83], v[60:63], v[124:139]
    s_waitcnt lgkmcnt(10)
    v_mfma_f32_32x32x16_bf16 v[108:123], v[84:87], v[64:67], v[108:123]
    v_mfma_f32_32x32x16_bf16 v[124:139], v[88:91], v[64:67], v[124:139]
    s_waitcnt lgkmcnt(5)
    v_mfma_f32_32x32x16_bf16 v[108:123], v[92:95], v[68:71], v[108:123]
    v_mfma_f32_32x32x16_bf16 v[124:139], v[96:99], v[68:71], v[124:139]
    s_waitcnt lgkmcnt(0)
    v_mfma_f32_32x32x16_bf16 v[108:123], v[100:103], v[72:75], v[108:123]
    v_mfma_f32_32x32x16_bf16 v[124:139], v[104:107], v[72:75], v[124:139]
    s_waitcnt vmcnt(0)
    ds_write_b128 v3, v[12:15] offset:0
    ds_write_b128 v3, v[16:19] offset:16
    ds_write_b128 v3, v[20:23] offset:32
    ds_write_b128 v3, v[24:27] offset:48
    ds_write_b128 v4, v[44:47] offset:0
    ds_write_b128 v4, v[48:51] offset:16
    s_waitcnt lgkmcnt(0)
    s_barrier
    ds_read_b128 v[60:63], v5 offset:0
    ds_read_b64_tr_b16 v[76:77], v6 offset:0
    ds_read_b64_tr_b16 v[78:79], v6 offset:768
    ds_read_b64_tr_b16 v[80:81], v6 offset:64
    ds_read_b64_tr_b16 v[82:83], v6 offset:832
    ds_read_b128 v[64:67], v5 offset:32
    ds_read_b64_tr_b16 v[84:85], v6 offset:3072
    ds_read_b64_tr_b16 v[86:87], v6 offset:3840
    ds_read_b64_tr_b16 v[88:89], v6 offset:3136
    ds_read_b64_tr_b16 v[90:91], v6 offset:3904
    ds_read_b128 v[68:71], v5 offset:64
    ds_read_b64_tr_b16 v[92:93], v6 offset:6144
    ds_read_b64_tr_b16 v[94:95], v6 offset:6912
    ds_read_b64_tr_b16 v[96:97], v6 offset:6208
    ds_read_b64_tr_b16 v[98:99], v6 offset:6976
    ds_read_b128 v[72:75], v5 offset:96
    ds_read_b64_tr_b16 v[100:101], v6 offset:9216
    ds_read_b64_tr_b16 v[102:103], v6 offset:9984
    ds_read_b64_tr_b16 v[104:105], v6 offset:9280
    ds_read_b64_tr_b16 v[106:107], v6 offset:10048
    s_waitcnt lgkmcnt(15)
    v_mfma_f32_32x32x16_bf16 v[108:123], v[76:79], v[60:63], v[108:123]
    v_mfma_f32_32x32x16_bf16 v[124:139], v[80:83], v[60:63], v[124:139]
    s_waitcnt lgkmcnt(10)
    v_mfma_f32_32x32x16_bf16 v[108:123], v[84:87], v[64:67], v[108:123]
    v_mfma_f32_32x32x16_bf16 v[124:139], v[88:91], v[64:67], v[124:139]
    s_waitcnt lgkmcnt(5)
    v_mfma_f32_32x32x16_bf16 v[108:123], v[92:95], v[68:71], v[108:123]
    v_mfma_f32_32x32x16_bf16 v[124:139], v[96:99], v[68:71], v[124:139]
    s_waitcnt lgkmcnt(0)
    v_mfma_f32_32x32x16_bf16 v[108:123], v[100:103], v[72:75], v[108:123]
    v_mfma_f32_32x32x16_bf16 v[124:139], v[104:107], v[72:75], v[124:139]
    s_nop 7
    s_nop 7
    v_lshrrev_b32 v7, 6, v0
    v_lshlrev_b32 v7, 5, v7
    v_and_b32 v8, 31, v0
    v_add3_u32 v7, v7, v8, s30
    v_mul_u32_u24 v1, 3456, v7
    v_bfe_u32 v8, v0, 5, 1
    v_lshlrev_b32 v8, 3, v8
    v_add3_u32 v1, v1, v8, s31
    v_cvt_pk_bf16_f32 v76, v108, v109
    v_cvt_pk_bf16_f32 v77, v110, v111
    buffer_store_dwordx2 v[76:77], v1, s[20:23], 0 offen offset:0
    v_cvt_pk_bf16_f32 v78, v112, v113
    v_cvt_pk_bf16_f32 v79, v114, v115
    buffer_store_dwordx2 v[78:79], v1, s[20:23], 0 offen offset:16
    v_cvt_pk_bf16_f32 v80, v116, v117
    v_cvt_pk_bf16_f32 v81, v118, v119
    buffer_store_dwordx2 v[80:81], v1, s[20:23], 0 offen offset:32
    v_cvt_pk_bf16_f32 v82, v120, v121
    v_cvt_pk_bf16_f32 v83, v122, v123
    buffer_store_dwordx2 v[82:83], v1, s[20:23], 0 offen offset:48
    v_cvt_pk_bf16_f32 v84, v124, v125
    v_cvt_pk_bf16_f32 v85, v126, v127
    buffer_store_dwordx2 v[84:85], v1, s[20:23], 0 offen offset:64
    v_cvt_pk_bf16_f32 v86, v128, v129
    v_cvt_pk_bf16_f32 v87, v130, v131
    buffer_store_dwordx2 v[86:87], v1, s[20:23], 0 offen offset:80
    v_cvt_pk_bf16_f32 v88, v132, v133
    v_cvt_pk_bf16_f32 v89, v134, v135
    buffer_store_dwordx2 v[88:89], v1, s[20:23], 0 offen offset:96
    v_cvt_pk_bf16_f32 v90, v136, v137
    v_cvt_pk_bf16_f32 v91, v138, v139
    buffer_store_dwordx2 v[90:91], v1, s[20:23], 0 offen offset:112
qkva_kernel_done:
    s_endpgm
.globl qkvb_kernel
.p2align 8
.type qkvb_kernel,@function
qkvb_kernel:
    s_load_dwordx2 s[4:5], s[0:1], 72
    s_load_dwordx2 s[6:7], s[0:1], 40
    s_load_dwordx2 s[8:9], s[0:1], 72
    s_cmp_ge_u32 s2, 432
    s_cbranch_scc1 qkvb_kernel_done
    s_waitcnt lgkmcnt(0)
    s_add_u32 s8, s8, 0x240000
    s_addc_u32 s9, s9, 0
    s_mov_b32 s12, s4
    s_and_b32 s13, s5, 0xffff
    s_mov_b32 s14, 0x240000
    s_mov_b32 s15, 0x20000
    s_mov_b32 s16, s6
    s_and_b32 s17, s7, 0xffff
    s_mov_b32 s18, 0x1e6000
    s_mov_b32 s19, 0x20000
    s_mov_b32 s20, s8
    s_and_b32 s21, s9, 0xffff
    s_mov_b32 s22, 0x6c0000
    s_mov_b32 s23, 0x20000
    s_mov_b32 s30, 0x97b425f
    s_mul_hi_u32 s28, s2, s30
    s_mul_i32 s30, s28, 27
    s_sub_u32 s29, s2, s30
    s_lshl_b32 s30, s28, 7
    v_lshrrev_b32 v7, 1, v0
    v_add_u32 v8, s30, v7
    v_mul_u32_u24 v1, 1152, v8
    v_and_b32 v8, 1, v0
    v_lshlrev_b32 v8, 6, v8
    v_add_u32 v1, v1, v8
    v_mul_u32_u24 v3, 144, v7
    v_add_u32 v3, v3, v8
    v_lshrrev_b32 v7, 2, v0
    v_mul_u32_u24 v2, 3456, v7
    v_and_b32 v8, 3, v0
    v_lshlrev_b32 v8, 5, v8
    v_add_u32 v2, v2, v8
    s_lshl_b32 s31, s29, 7
    v_add_u32 v2, s31, v2
    v_mul_u32_u24 v4, 192, v7
    v_add_u32 v4, v4, v8
    v_add_u32 v4, 18432, v4
    v_lshrrev_b32 v7, 6, v0
    v_lshlrev_b32 v7, 5, v7
    v_and_b32 v8, 31, v0
    v_add_u32 v7, v7, v8
    v_mul_u32_u24 v5, 144, v7
    v_bfe_u32 v8, v0, 5, 1
    v_lshlrev_b32 v8, 4, v8
    v_add_u32 v5, v5, v8
    v_bfe_u32 v7, v0, 5, 1
    v_lshlrev_b32 v7, 3, v7
    v_bfe_u32 v8, v0, 2, 2
    v_add_u32 v7, v7, v8
    v_mul_u32_u24 v6, 192, v7
    v_bfe_u32 v7, v0, 4, 1
    v_lshlrev_b32 v7, 5, v7
    v_and_b32 v8, 3, v0
    v_lshlrev_b32 v8, 3, v8
    v_add3_u32 v6, v6, v7, v8
    v_add_u32 v6, 18432, v6
    v_mov_b32 v108, 0
    v_mov_b32 v109, 0
    v_mov_b32 v110, 0
    v_mov_b32 v111, 0
    v_mov_b32 v112, 0
    v_mov_b32 v113, 0
    v_mov_b32 v114, 0
    v_mov_b32 v115, 0
    v_mov_b32 v116, 0
    v_mov_b32 v117, 0
    v_mov_b32 v118, 0
    v_mov_b32 v119, 0
    v_mov_b32 v120, 0
    v_mov_b32 v121, 0
    v_mov_b32 v122, 0
    v_mov_b32 v123, 0
    v_mov_b32 v124, 0
    v_mov_b32 v125, 0
    v_mov_b32 v126, 0
    v_mov_b32 v127, 0
    v_mov_b32 v128, 0
    v_mov_b32 v129, 0
    v_mov_b32 v130, 0
    v_mov_b32 v131, 0
    v_mov_b32 v132, 0
    v_mov_b32 v133, 0
    v_mov_b32 v134, 0
    v_mov_b32 v135, 0
    v_mov_b32 v136, 0
    v_mov_b32 v137, 0
    v_mov_b32 v138, 0
    v_mov_b32 v139, 0
    buffer_load_dwordx4 v[12:15], v1, s[12:15], 0 offen offset:0
    buffer_load_dwordx4 v[16:19], v1, s[12:15], 0 offen offset:16
    buffer_load_dwordx4 v[20:23], v1, s[12:15], 0 offen offset:32
    buffer_load_dwordx4 v[24:27], v1, s[12:15], 0 offen offset:48
    s_mov_b32 s32, 0x0
    buffer_load_dwordx4 v[44:47], v2, s[16:19], s32 offen offset:0
    buffer_load_dwordx4 v[48:51], v2, s[16:19], s32 offen offset:16
    buffer_load_dwordx4 v[28:31], v1, s[12:15], 0 offen offset:128
    buffer_load_dwordx4 v[32:35], v1, s[12:15], 0 offen offset:144
    buffer_load_dwordx4 v[36:39], v1, s[12:15], 0 offen offset:160
    buffer_load_dwordx4 v[40:43], v1, s[12:15], 0 offen offset:176
    s_mov_b32 s32, 0x36000
    buffer_load_dwordx4 v[52:55], v2, s[16:19], s32 offen offset:0
    buffer_load_dwordx4 v[56:59], v2, s[16:19], s32 offen offset:16
    s_waitcnt vmcnt(6)
    ds_write_b128 v3, v[12:15] offset:0
    ds_write_b128 v3, v[16:19] offset:16
    ds_write_b128 v3, v[20:23] offset:32
    ds_write_b128 v3, v[24:27] offset:48
    ds_write_b128 v4, v[44:47] offset:0
    ds_write_b128 v4, v[48:51] offset:16
    s_waitcnt lgkmcnt(0)
    s_barrier
    buffer_load_dwordx4 v[12:15], v1, s[12:15], 0 offen offset:256
    buffer_load_dwordx4 v[16:19], v1, s[12:15], 0 offen offset:272
    buffer_load_dwordx4 v[20:23], v1, s[12:15], 0 offen offset:288
    buffer_load_dwordx4 v[24:27], v1, s[12:15], 0 offen offset:304
    s_mov_b32 s32, 0x6c000
    buffer_load_dwordx4 v[44:47], v2, s[16:19], s32 offen offset:0
    buffer_load_dwordx4 v[48:51], v2, s[16:19], s32 offen offset:16
    ds_read_b128 v[60:63], v5 offset:0
    ds_read_b64_tr_b16 v[76:77], v6 offset:0
    ds_read_b64_tr_b16 v[78:79], v6 offset:768
    ds_read_b64_tr_b16 v[80:81], v6 offset:64
    ds_read_b64_tr_b16 v[82:83], v6 offset:832
    ds_read_b128 v[64:67], v5 offset:32
    ds_read_b64_tr_b16 v[84:85], v6 offset:3072
    ds_read_b64_tr_b16 v[86:87], v6 offset:3840
    ds_read_b64_tr_b16 v[88:89], v6 offset:3136
    ds_read_b64_tr_b16 v[90:91], v6 offset:3904
    ds_read_b128 v[68:71], v5 offset:64
    ds_read_b64_tr_b16 v[92:93], v6 offset:6144
    ds_read_b64_tr_b16 v[94:95], v6 offset:6912
    ds_read_b64_tr_b16 v[96:97], v6 offset:6208
    ds_read_b64_tr_b16 v[98:99], v6 offset:6976
    ds_read_b128 v[72:75], v5 offset:96
    ds_read_b64_tr_b16 v[100:101], v6 offset:9216
    ds_read_b64_tr_b16 v[102:103], v6 offset:9984
    ds_read_b64_tr_b16 v[104:105], v6 offset:9280
    ds_read_b64_tr_b16 v[106:107], v6 offset:10048
    s_waitcnt lgkmcnt(15)
    v_mfma_f32_32x32x16_bf16 v[108:123], v[76:79], v[60:63], v[108:123]
    v_mfma_f32_32x32x16_bf16 v[124:139], v[80:83], v[60:63], v[124:139]
    s_waitcnt lgkmcnt(10)
    v_mfma_f32_32x32x16_bf16 v[108:123], v[84:87], v[64:67], v[108:123]
    v_mfma_f32_32x32x16_bf16 v[124:139], v[88:91], v[64:67], v[124:139]
    s_waitcnt lgkmcnt(5)
    v_mfma_f32_32x32x16_bf16 v[108:123], v[92:95], v[68:71], v[108:123]
    v_mfma_f32_32x32x16_bf16 v[124:139], v[96:99], v[68:71], v[124:139]
    s_waitcnt lgkmcnt(0)
    v_mfma_f32_32x32x16_bf16 v[108:123], v[100:103], v[72:75], v[108:123]
    v_mfma_f32_32x32x16_bf16 v[124:139], v[104:107], v[72:75], v[124:139]
    s_waitcnt vmcnt(6)
    ds_write_b128 v3, v[28:31] offset:30720
    ds_write_b128 v3, v[32:35] offset:30736
    ds_write_b128 v3, v[36:39] offset:30752
    ds_write_b128 v3, v[40:43] offset:30768
    ds_write_b128 v4, v[52:55] offset:30720
    ds_write_b128 v4, v[56:59] offset:30736
    s_waitcnt lgkmcnt(0)
    s_barrier
    buffer_load_dwordx4 v[28:31], v1, s[12:15], 0 offen offset:384
    buffer_load_dwordx4 v[32:35], v1, s[12:15], 0 offen offset:400
    buffer_load_dwordx4 v[36:39], v1, s[12:15], 0 offen offset:416
    buffer_load_dwordx4 v[40:43], v1, s[12:15], 0 offen offset:432
    s_mov_b32 s32, 0xa2000
    buffer_load_dwordx4 v[52:55], v2, s[16:19], s32 offen offset:0
    buffer_load_dwordx4 v[56:59], v2, s[16:19], s32 offen offset:16
    ds_read_b128 v[60:63], v5 offset:30720
    ds_read_b64_tr_b16 v[76:77], v6 offset:30720
    ds_read_b64_tr_b16 v[78:79], v6 offset:31488
    ds_read_b64_tr_b16 v[80:81], v6 offset:30784
    ds_read_b64_tr_b16 v[82:83], v6 offset:31552
    ds_read_b128 v[64:67], v5 offset:30752
    ds_read_b64_tr_b16 v[84:85], v6 offset:33792
    ds_read_b64_tr_b16 v[86:87], v6 offset:34560
    ds_read_b64_tr_b16 v[88:89], v6 offset:33856
    ds_read_b64_tr_b16 v[90:91], v6 offset:34624
    ds_read_b128 v[68:71], v5 offset:30784
    ds_read_b64_tr_b16 v[92:93], v6 offset:36864
    ds_read_b64_tr_b16 v[94:95], v6 offset:37632
    ds_read_b64_tr_b16 v[96:97], v6 offset:36928
    ds_read_b64_tr_b16 v[98:99], v6 offset:37696
    ds_read_b128 v[72:75], v5 offset:30816
    ds_read_b64_tr_b16 v[100:101], v6 offset:39936
    ds_read_b64_tr_b16 v[102:103], v6 offset:40704
    ds_read_b64_tr_b16 v[104:105], v6 offset:40000
    ds_read_b64_tr_b16 v[106:107], v6 offset:40768
    s_waitcnt lgkmcnt(15)
    v_mfma_f32_32x32x16_bf16 v[108:123], v[76:79], v[60:63], v[108:123]
    v_mfma_f32_32x32x16_bf16 v[124:139], v[80:83], v[60:63], v[124:139]
    s_waitcnt lgkmcnt(10)
    v_mfma_f32_32x32x16_bf16 v[108:123], v[84:87], v[64:67], v[108:123]
    v_mfma_f32_32x32x16_bf16 v[124:139], v[88:91], v[64:67], v[124:139]
    s_waitcnt lgkmcnt(5)
    v_mfma_f32_32x32x16_bf16 v[108:123], v[92:95], v[68:71], v[108:123]
    v_mfma_f32_32x32x16_bf16 v[124:139], v[96:99], v[68:71], v[124:139]
    s_waitcnt lgkmcnt(0)
    v_mfma_f32_32x32x16_bf16 v[108:123], v[100:103], v[72:75], v[108:123]
    v_mfma_f32_32x32x16_bf16 v[124:139], v[104:107], v[72:75], v[124:139]
    s_waitcnt vmcnt(6)
    ds_write_b128 v3, v[12:15] offset:0
    ds_write_b128 v3, v[16:19] offset:16
    ds_write_b128 v3, v[20:23] offset:32
    ds_write_b128 v3, v[24:27] offset:48
    ds_write_b128 v4, v[44:47] offset:0
    ds_write_b128 v4, v[48:51] offset:16
    s_waitcnt lgkmcnt(0)
    s_barrier
    buffer_load_dwordx4 v[12:15], v1, s[12:15], 0 offen offset:512
    buffer_load_dwordx4 v[16:19], v1, s[12:15], 0 offen offset:528
    buffer_load_dwordx4 v[20:23], v1, s[12:15], 0 offen offset:544
    buffer_load_dwordx4 v[24:27], v1, s[12:15], 0 offen offset:560
    s_mov_b32 s32, 0xd8000
    buffer_load_dwordx4 v[44:47], v2, s[16:19], s32 offen offset:0
    buffer_load_dwordx4 v[48:51], v2, s[16:19], s32 offen offset:16
    ds_read_b128 v[60:63], v5 offset:0
    ds_read_b64_tr_b16 v[76:77], v6 offset:0
    ds_read_b64_tr_b16 v[78:79], v6 offset:768
    ds_read_b64_tr_b16 v[80:81], v6 offset:64
    ds_read_b64_tr_b16 v[82:83], v6 offset:832
    ds_read_b128 v[64:67], v5 offset:32
    ds_read_b64_tr_b16 v[84:85], v6 offset:3072
    ds_read_b64_tr_b16 v[86:87], v6 offset:3840
    ds_read_b64_tr_b16 v[88:89], v6 offset:3136
    ds_read_b64_tr_b16 v[90:91], v6 offset:3904
    ds_read_b128 v[68:71], v5 offset:64
    ds_read_b64_tr_b16 v[92:93], v6 offset:6144
    ds_read_b64_tr_b16 v[94:95], v6 offset:6912
    ds_read_b64_tr_b16 v[96:97], v6 offset:6208
    ds_read_b64_tr_b16 v[98:99], v6 offset:6976
    ds_read_b128 v[72:75], v5 offset:96
    ds_read_b64_tr_b16 v[100:101], v6 offset:9216
    ds_read_b64_tr_b16 v[102:103], v6 offset:9984
    ds_read_b64_tr_b16 v[104:105], v6 offset:9280
    ds_read_b64_tr_b16 v[106:107], v6 offset:10048
    s_waitcnt lgkmcnt(15)
    v_mfma_f32_32x32x16_bf16 v[108:123], v[76:79], v[60:63], v[108:123]
    v_mfma_f32_32x32x16_bf16 v[124:139], v[80:83], v[60:63], v[124:139]
    s_waitcnt lgkmcnt(10)
    v_mfma_f32_32x32x16_bf16 v[108:123], v[84:87], v[64:67], v[108:123]
    v_mfma_f32_32x32x16_bf16 v[124:139], v[88:91], v[64:67], v[124:139]
    s_waitcnt lgkmcnt(5)
    v_mfma_f32_32x32x16_bf16 v[108:123], v[92:95], v[68:71], v[108:123]
    v_mfma_f32_32x32x16_bf16 v[124:139], v[96:99], v[68:71], v[124:139]
    s_waitcnt lgkmcnt(0)
    v_mfma_f32_32x32x16_bf16 v[108:123], v[100:103], v[72:75], v[108:123]
    v_mfma_f32_32x32x16_bf16 v[124:139], v[104:107], v[72:75], v[124:139]
    s_waitcnt vmcnt(6)
    ds_write_b128 v3, v[28:31] offset:30720
    ds_write_b128 v3, v[32:35] offset:30736
    ds_write_b128 v3, v[36:39] offset:30752
    ds_write_b128 v3, v[40:43] offset:30768
    ds_write_b128 v4, v[52:55] offset:30720
    ds_write_b128 v4, v[56:59] offset:30736
    s_waitcnt lgkmcnt(0)
    s_barrier
    buffer_load_dwordx4 v[28:31], v1, s[12:15], 0 offen offset:640
    buffer_load_dwordx4 v[32:35], v1, s[12:15], 0 offen offset:656
    buffer_load_dwordx4 v[36:39], v1, s[12:15], 0 offen offset:672
    buffer_load_dwordx4 v[40:43], v1, s[12:15], 0 offen offset:688
    s_mov_b32 s32, 0x10e000
    buffer_load_dwordx4 v[52:55], v2, s[16:19], s32 offen offset:0
    buffer_load_dwordx4 v[56:59], v2, s[16:19], s32 offen offset:16
    ds_read_b128 v[60:63], v5 offset:30720
    ds_read_b64_tr_b16 v[76:77], v6 offset:30720
    ds_read_b64_tr_b16 v[78:79], v6 offset:31488
    ds_read_b64_tr_b16 v[80:81], v6 offset:30784
    ds_read_b64_tr_b16 v[82:83], v6 offset:31552
    ds_read_b128 v[64:67], v5 offset:30752
    ds_read_b64_tr_b16 v[84:85], v6 offset:33792
    ds_read_b64_tr_b16 v[86:87], v6 offset:34560
    ds_read_b64_tr_b16 v[88:89], v6 offset:33856
    ds_read_b64_tr_b16 v[90:91], v6 offset:34624
    ds_read_b128 v[68:71], v5 offset:30784
    ds_read_b64_tr_b16 v[92:93], v6 offset:36864
    ds_read_b64_tr_b16 v[94:95], v6 offset:37632
    ds_read_b64_tr_b16 v[96:97], v6 offset:36928
    ds_read_b64_tr_b16 v[98:99], v6 offset:37696
    ds_read_b128 v[72:75], v5 offset:30816
    ds_read_b64_tr_b16 v[100:101], v6 offset:39936
    ds_read_b64_tr_b16 v[102:103], v6 offset:40704
    ds_read_b64_tr_b16 v[104:105], v6 offset:40000
    ds_read_b64_tr_b16 v[106:107], v6 offset:40768
    s_waitcnt lgkmcnt(15)
    v_mfma_f32_32x32x16_bf16 v[108:123], v[76:79], v[60:63], v[108:123]
    v_mfma_f32_32x32x16_bf16 v[124:139], v[80:83], v[60:63], v[124:139]
    s_waitcnt lgkmcnt(10)
    v_mfma_f32_32x32x16_bf16 v[108:123], v[84:87], v[64:67], v[108:123]
    v_mfma_f32_32x32x16_bf16 v[124:139], v[88:91], v[64:67], v[124:139]
    s_waitcnt lgkmcnt(5)
    v_mfma_f32_32x32x16_bf16 v[108:123], v[92:95], v[68:71], v[108:123]
    v_mfma_f32_32x32x16_bf16 v[124:139], v[96:99], v[68:71], v[124:139]
    s_waitcnt lgkmcnt(0)
    v_mfma_f32_32x32x16_bf16 v[108:123], v[100:103], v[72:75], v[108:123]
    v_mfma_f32_32x32x16_bf16 v[124:139], v[104:107], v[72:75], v[124:139]
    s_waitcnt vmcnt(6)
    ds_write_b128 v3, v[12:15] offset:0
    ds_write_b128 v3, v[16:19] offset:16
    ds_write_b128 v3, v[20:23] offset:32
    ds_write_b128 v3, v[24:27] offset:48
    ds_write_b128 v4, v[44:47] offset:0
    ds_write_b128 v4, v[48:51] offset:16
    s_waitcnt lgkmcnt(0)
    s_barrier
    buffer_load_dwordx4 v[12:15], v1, s[12:15], 0 offen offset:768
    buffer_load_dwordx4 v[16:19], v1, s[12:15], 0 offen offset:784
    buffer_load_dwordx4 v[20:23], v1, s[12:15], 0 offen offset:800
    buffer_load_dwordx4 v[24:27], v1, s[12:15], 0 offen offset:816
    s_mov_b32 s32, 0x144000
    buffer_load_dwordx4 v[44:47], v2, s[16:19], s32 offen offset:0
    buffer_load_dwordx4 v[48:51], v2, s[16:19], s32 offen offset:16
    ds_read_b128 v[60:63], v5 offset:0
    ds_read_b64_tr_b16 v[76:77], v6 offset:0
    ds_read_b64_tr_b16 v[78:79], v6 offset:768
    ds_read_b64_tr_b16 v[80:81], v6 offset:64
    ds_read_b64_tr_b16 v[82:83], v6 offset:832
    ds_read_b128 v[64:67], v5 offset:32
    ds_read_b64_tr_b16 v[84:85], v6 offset:3072
    ds_read_b64_tr_b16 v[86:87], v6 offset:3840
    ds_read_b64_tr_b16 v[88:89], v6 offset:3136
    ds_read_b64_tr_b16 v[90:91], v6 offset:3904
    ds_read_b128 v[68:71], v5 offset:64
    ds_read_b64_tr_b16 v[92:93], v6 offset:6144
    ds_read_b64_tr_b16 v[94:95], v6 offset:6912
    ds_read_b64_tr_b16 v[96:97], v6 offset:6208
    ds_read_b64_tr_b16 v[98:99], v6 offset:6976
    ds_read_b128 v[72:75], v5 offset:96
    ds_read_b64_tr_b16 v[100:101], v6 offset:9216
    ds_read_b64_tr_b16 v[102:103], v6 offset:9984
    ds_read_b64_tr_b16 v[104:105], v6 offset:9280
    ds_read_b64_tr_b16 v[106:107], v6 offset:10048
    s_waitcnt lgkmcnt(15)
    v_mfma_f32_32x32x16_bf16 v[108:123], v[76:79], v[60:63], v[108:123]
    v_mfma_f32_32x32x16_bf16 v[124:139], v[80:83], v[60:63], v[124:139]
    s_waitcnt lgkmcnt(10)
    v_mfma_f32_32x32x16_bf16 v[108:123], v[84:87], v[64:67], v[108:123]
    v_mfma_f32_32x32x16_bf16 v[124:139], v[88:91], v[64:67], v[124:139]
    s_waitcnt lgkmcnt(5)
    v_mfma_f32_32x32x16_bf16 v[108:123], v[92:95], v[68:71], v[108:123]
    v_mfma_f32_32x32x16_bf16 v[124:139], v[96:99], v[68:71], v[124:139]
    s_waitcnt lgkmcnt(0)
    v_mfma_f32_32x32x16_bf16 v[108:123], v[100:103], v[72:75], v[108:123]
    v_mfma_f32_32x32x16_bf16 v[124:139], v[104:107], v[72:75], v[124:139]
    s_waitcnt vmcnt(6)
    ds_write_b128 v3, v[28:31] offset:30720
    ds_write_b128 v3, v[32:35] offset:30736
    ds_write_b128 v3, v[36:39] offset:30752
    ds_write_b128 v3, v[40:43] offset:30768
    ds_write_b128 v4, v[52:55] offset:30720
    ds_write_b128 v4, v[56:59] offset:30736
    s_waitcnt lgkmcnt(0)
    s_barrier
    buffer_load_dwordx4 v[28:31], v1, s[12:15], 0 offen offset:896
    buffer_load_dwordx4 v[32:35], v1, s[12:15], 0 offen offset:912
    buffer_load_dwordx4 v[36:39], v1, s[12:15], 0 offen offset:928
    buffer_load_dwordx4 v[40:43], v1, s[12:15], 0 offen offset:944
    s_mov_b32 s32, 0x17a000
    buffer_load_dwordx4 v[52:55], v2, s[16:19], s32 offen offset:0
    buffer_load_dwordx4 v[56:59], v2, s[16:19], s32 offen offset:16
    ds_read_b128 v[60:63], v5 offset:30720
    ds_read_b64_tr_b16 v[76:77], v6 offset:30720
    ds_read_b64_tr_b16 v[78:79], v6 offset:31488
    ds_read_b64_tr_b16 v[80:81], v6 offset:30784
    ds_read_b64_tr_b16 v[82:83], v6 offset:31552
    ds_read_b128 v[64:67], v5 offset:30752
    ds_read_b64_tr_b16 v[84:85], v6 offset:33792
    ds_read_b64_tr_b16 v[86:87], v6 offset:34560
    ds_read_b64_tr_b16 v[88:89], v6 offset:33856
    ds_read_b64_tr_b16 v[90:91], v6 offset:34624
    ds_read_b128 v[68:71], v5 offset:30784
    ds_read_b64_tr_b16 v[92:93], v6 offset:36864
    ds_read_b64_tr_b16 v[94:95], v6 offset:37632
    ds_read_b64_tr_b16 v[96:97], v6 offset:36928
    ds_read_b64_tr_b16 v[98:99], v6 offset:37696
    ds_read_b128 v[72:75], v5 offset:30816
    ds_read_b64_tr_b16 v[100:101], v6 offset:39936
    ds_read_b64_tr_b16 v[102:103], v6 offset:40704
    ds_read_b64_tr_b16 v[104:105], v6 offset:40000
    ds_read_b64_tr_b16 v[106:107], v6 offset:40768
    s_waitcnt lgkmcnt(15)
    v_mfma_f32_32x32x16_bf16 v[108:123], v[76:79], v[60:63], v[108:123]
    v_mfma_f32_32x32x16_bf16 v[124:139], v[80:83], v[60:63], v[124:139]
    s_waitcnt lgkmcnt(10)
    v_mfma_f32_32x32x16_bf16 v[108:123], v[84:87], v[64:67], v[108:123]
    v_mfma_f32_32x32x16_bf16 v[124:139], v[88:91], v[64:67], v[124:139]
    s_waitcnt lgkmcnt(5)
    v_mfma_f32_32x32x16_bf16 v[108:123], v[92:95], v[68:71], v[108:123]
    v_mfma_f32_32x32x16_bf16 v[124:139], v[96:99], v[68:71], v[124:139]
    s_waitcnt lgkmcnt(0)
    v_mfma_f32_32x32x16_bf16 v[108:123], v[100:103], v[72:75], v[108:123]
    v_mfma_f32_32x32x16_bf16 v[124:139], v[104:107], v[72:75], v[124:139]
    s_waitcnt vmcnt(6)
    ds_write_b128 v3, v[12:15] offset:0
    ds_write_b128 v3, v[16:19] offset:16
    ds_write_b128 v3, v[20:23] offset:32
    ds_write_b128 v3, v[24:27] offset:48
    ds_write_b128 v4, v[44:47] offset:0
    ds_write_b128 v4, v[48:51] offset:16
    s_waitcnt lgkmcnt(0)
    s_barrier
    buffer_load_dwordx4 v[12:15], v1, s[12:15], 0 offen offset:1024
    buffer_load_dwordx4 v[16:19], v1, s[12:15], 0 offen offset:1040
    buffer_load_dwordx4 v[20:23], v1, s[12:15], 0 offen offset:1056
    buffer_load_dwordx4 v[24:27], v1, s[12:15], 0 offen offset:1072
    s_mov_b32 s32, 0x1b0000
    buffer_load_dwordx4 v[44:47], v2, s[16:19], s32 offen offset:0
    buffer_load_dwordx4 v[48:51], v2, s[16:19], s32 offen offset:16
    ds_read_b128 v[60:63], v5 offset:0
    ds_read_b64_tr_b16 v[76:77], v6 offset:0
    ds_read_b64_tr_b16 v[78:79], v6 offset:768
    ds_read_b64_tr_b16 v[80:81], v6 offset:64
    ds_read_b64_tr_b16 v[82:83], v6 offset:832
    ds_read_b128 v[64:67], v5 offset:32
    ds_read_b64_tr_b16 v[84:85], v6 offset:3072
    ds_read_b64_tr_b16 v[86:87], v6 offset:3840
    ds_read_b64_tr_b16 v[88:89], v6 offset:3136
    ds_read_b64_tr_b16 v[90:91], v6 offset:3904
    ds_read_b128 v[68:71], v5 offset:64
    ds_read_b64_tr_b16 v[92:93], v6 offset:6144
    ds_read_b64_tr_b16 v[94:95], v6 offset:6912
    ds_read_b64_tr_b16 v[96:97], v6 offset:6208
    ds_read_b64_tr_b16 v[98:99], v6 offset:6976
    ds_read_b128 v[72:75], v5 offset:96
    ds_read_b64_tr_b16 v[100:101], v6 offset:9216
    ds_read_b64_tr_b16 v[102:103], v6 offset:9984
    ds_read_b64_tr_b16 v[104:105], v6 offset:9280
    ds_read_b64_tr_b16 v[106:107], v6 offset:10048
    s_waitcnt lgkmcnt(15)
    v_mfma_f32_32x32x16_bf16 v[108:123], v[76:79], v[60:63], v[108:123]
    v_mfma_f32_32x32x16_bf16 v[124:139], v[80:83], v[60:63], v[124:139]
    s_waitcnt lgkmcnt(10)
    v_mfma_f32_32x32x16_bf16 v[108:123], v[84:87], v[64:67], v[108:123]
    v_mfma_f32_32x32x16_bf16 v[124:139], v[88:91], v[64:67], v[124:139]
    s_waitcnt lgkmcnt(5)
    v_mfma_f32_32x32x16_bf16 v[108:123], v[92:95], v[68:71], v[108:123]
    v_mfma_f32_32x32x16_bf16 v[124:139], v[96:99], v[68:71], v[124:139]
    s_waitcnt lgkmcnt(0)
    v_mfma_f32_32x32x16_bf16 v[108:123], v[100:103], v[72:75], v[108:123]
    v_mfma_f32_32x32x16_bf16 v[124:139], v[104:107], v[72:75], v[124:139]
    s_waitcnt vmcnt(6)
    ds_write_b128 v3, v[28:31] offset:30720
    ds_write_b128 v3, v[32:35] offset:30736
    ds_write_b128 v3, v[36:39] offset:30752
    ds_write_b128 v3, v[40:43] offset:30768
    ds_write_b128 v4, v[52:55] offset:30720
    ds_write_b128 v4, v[56:59] offset:30736
    s_waitcnt lgkmcnt(0)
    s_barrier
    ds_read_b128 v[60:63], v5 offset:30720
    ds_read_b64_tr_b16 v[76:77], v6 offset:30720
    ds_read_b64_tr_b16 v[78:79], v6 offset:31488
    ds_read_b64_tr_b16 v[80:81], v6 offset:30784
    ds_read_b64_tr_b16 v[82:83], v6 offset:31552
    ds_read_b128 v[64:67], v5 offset:30752
    ds_read_b64_tr_b16 v[84:85], v6 offset:33792
    ds_read_b64_tr_b16 v[86:87], v6 offset:34560
    ds_read_b64_tr_b16 v[88:89], v6 offset:33856
    ds_read_b64_tr_b16 v[90:91], v6 offset:34624
    ds_read_b128 v[68:71], v5 offset:30784
    ds_read_b64_tr_b16 v[92:93], v6 offset:36864
    ds_read_b64_tr_b16 v[94:95], v6 offset:37632
    ds_read_b64_tr_b16 v[96:97], v6 offset:36928
    ds_read_b64_tr_b16 v[98:99], v6 offset:37696
    ds_read_b128 v[72:75], v5 offset:30816
    ds_read_b64_tr_b16 v[100:101], v6 offset:39936
    ds_read_b64_tr_b16 v[102:103], v6 offset:40704
    ds_read_b64_tr_b16 v[104:105], v6 offset:40000
    ds_read_b64_tr_b16 v[106:107], v6 offset:40768
    s_waitcnt lgkmcnt(15)
    v_mfma_f32_32x32x16_bf16 v[108:123], v[76:79], v[60:63], v[108:123]
    v_mfma_f32_32x32x16_bf16 v[124:139], v[80:83], v[60:63], v[124:139]
    s_waitcnt lgkmcnt(10)
    v_mfma_f32_32x32x16_bf16 v[108:123], v[84:87], v[64:67], v[108:123]
    v_mfma_f32_32x32x16_bf16 v[124:139], v[88:91], v[64:67], v[124:139]
    s_waitcnt lgkmcnt(5)
    v_mfma_f32_32x32x16_bf16 v[108:123], v[92:95], v[68:71], v[108:123]
    v_mfma_f32_32x32x16_bf16 v[124:139], v[96:99], v[68:71], v[124:139]
    s_waitcnt lgkmcnt(0)
    v_mfma_f32_32x32x16_bf16 v[108:123], v[100:103], v[72:75], v[108:123]
    v_mfma_f32_32x32x16_bf16 v[124:139], v[104:107], v[72:75], v[124:139]
    s_waitcnt vmcnt(0)
    ds_write_b128 v3, v[12:15] offset:0
    ds_write_b128 v3, v[16:19] offset:16
    ds_write_b128 v3, v[20:23] offset:32
    ds_write_b128 v3, v[24:27] offset:48
    ds_write_b128 v4, v[44:47] offset:0
    ds_write_b128 v4, v[48:51] offset:16
    s_waitcnt lgkmcnt(0)
    s_barrier
    ds_read_b128 v[60:63], v5 offset:0
    ds_read_b64_tr_b16 v[76:77], v6 offset:0
    ds_read_b64_tr_b16 v[78:79], v6 offset:768
    ds_read_b64_tr_b16 v[80:81], v6 offset:64
    ds_read_b64_tr_b16 v[82:83], v6 offset:832
    ds_read_b128 v[64:67], v5 offset:32
    ds_read_b64_tr_b16 v[84:85], v6 offset:3072
    ds_read_b64_tr_b16 v[86:87], v6 offset:3840
    ds_read_b64_tr_b16 v[88:89], v6 offset:3136
    ds_read_b64_tr_b16 v[90:91], v6 offset:3904
    ds_read_b128 v[68:71], v5 offset:64
    ds_read_b64_tr_b16 v[92:93], v6 offset:6144
    ds_read_b64_tr_b16 v[94:95], v6 offset:6912
    ds_read_b64_tr_b16 v[96:97], v6 offset:6208
    ds_read_b64_tr_b16 v[98:99], v6 offset:6976
    ds_read_b128 v[72:75], v5 offset:96
    ds_read_b64_tr_b16 v[100:101], v6 offset:9216
    ds_read_b64_tr_b16 v[102:103], v6 offset:9984
    ds_read_b64_tr_b16 v[104:105], v6 offset:9280
    ds_read_b64_tr_b16 v[106:107], v6 offset:10048
    s_waitcnt lgkmcnt(15)
    v_mfma_f32_32x32x16_bf16 v[108:123], v[76:79], v[60:63], v[108:123]
    v_mfma_f32_32x32x16_bf16 v[124:139], v[80:83], v[60:63], v[124:139]
    s_waitcnt lgkmcnt(10)
    v_mfma_f32_32x32x16_bf16 v[108:123], v[84:87], v[64:67], v[108:123]
    v_mfma_f32_32x32x16_bf16 v[124:139], v[88:91], v[64:67], v[124:139]
    s_waitcnt lgkmcnt(5)
    v_mfma_f32_32x32x16_bf16 v[108:123], v[92:95], v[68:71], v[108:123]
    v_mfma_f32_32x32x16_bf16 v[124:139], v[96:99], v[68:71], v[124:139]
    s_waitcnt lgkmcnt(0)
    v_mfma_f32_32x32x16_bf16 v[108:123], v[100:103], v[72:75], v[108:123]
    v_mfma_f32_32x32x16_bf16 v[124:139], v[104:107], v[72:75], v[124:139]
    s_nop 7
    s_nop 7
    v_lshrrev_b32 v7, 6, v0
    v_lshlrev_b32 v7, 5, v7
    v_and_b32 v8, 31, v0
    v_add3_u32 v7, v7, v8, s30
    v_mul_u32_u24 v1, 3456, v7
    v_bfe_u32 v8, v0, 5, 1
    v_lshlrev_b32 v8, 3, v8
    v_add3_u32 v1, v1, v8, s31
    v_cvt_pk_bf16_f32 v76, v108, v109
    v_cvt_pk_bf16_f32 v77, v110, v111
    buffer_store_dwordx2 v[76:77], v1, s[20:23], 0 offen offset:0
    v_cvt_pk_bf16_f32 v78, v112, v113
    v_cvt_pk_bf16_f32 v79, v114, v115
    buffer_store_dwordx2 v[78:79], v1, s[20:23], 0 offen offset:16
    v_cvt_pk_bf16_f32 v80, v116, v117
    v_cvt_pk_bf16_f32 v81, v118, v119
    buffer_store_dwordx2 v[80:81], v1, s[20:23], 0 offen offset:32
    v_cvt_pk_bf16_f32 v82, v120, v121
    v_cvt_pk_bf16_f32 v83, v122, v123
    buffer_store_dwordx2 v[82:83], v1, s[20:23], 0 offen offset:48
    v_cvt_pk_bf16_f32 v84, v124, v125
    v_cvt_pk_bf16_f32 v85, v126, v127
    buffer_store_dwordx2 v[84:85], v1, s[20:23], 0 offen offset:64
    v_cvt_pk_bf16_f32 v86, v128, v129
    v_cvt_pk_bf16_f32 v87, v130, v131
    buffer_store_dwordx2 v[86:87], v1, s[20:23], 0 offen offset:80
    v_cvt_pk_bf16_f32 v88, v132, v133
    v_cvt_pk_bf16_f32 v89, v134, v135
    buffer_store_dwordx2 v[88:89], v1, s[20:23], 0 offen offset:96
    v_cvt_pk_bf16_f32 v90, v136, v137
    v_cvt_pk_bf16_f32 v91, v138, v139
    buffer_store_dwordx2 v[90:91], v1, s[20:23], 0 offen offset:112
qkvb_kernel_done:
    s_endpgm
.globl kvred_kernel
.p2align 8
.type kvred_kernel,@function
kvred_kernel:
    s_load_dwordx2 s[4:5], s[0:1], 72
    s_load_dwordx2 s[6:7], s[0:1], 16
    s_load_dwordx2 s[8:9], s[0:1], 72
    s_cmp_ge_u32 s2, 256
    s_cbranch_scc1 kvred_kernel_done
    s_waitcnt lgkmcnt(0)
    s_add_u32 s4, s4, 0x240000
    s_addc_u32 s5, s5, 0
    s_add_u32 s8, s8, 0x1200000
    s_addc_u32 s9, s9, 0
    s_mov_b32 s12, s4
    s_and_b32 s13, s5, 0xffff
    s_mov_b32 s14, 0x6c0000
    s_mov_b32 s15, 0x20000
    s_mov_b32 s20, s8
    s_and_b32 s21, s9, 0xffff
    s_mov_b32 s22, 0x200000
    s_mov_b32 s23, 0x20000
    s_lshr_b32 s46, s2, 3
    s_and_b32 s47, s2, 7
    s_mul_i32 s24, s46, 36
    s_mov_b32 s16, s6
    s_and_b32 s17, s7, 0xffff
    s_mov_b32 s18, 0x5100
    s_mov_b32 s19, 0x20000
    v_and_b32 v1, 31, v0
    v_bfe_u32 v2, v0, 5, 1
    v_lshlrev_b32 v2, 3, v2
    s_mul_i32 s40, s46, 648
    v_add_u32 v3, 0, v2
    v_cmp_gt_u32 vcc, 18, v3
    v_mul_u32_u24 v3, 36, v3
    v_lshl_add_u32 v3, v1, 1, v3
    v_add_u32 v3, s40, v3
    s_mov_b64 s[42:43], vcc
    v_cmp_gt_u32 vcc, 18, v1
    s_and_b64 vcc, vcc, s[42:43]
    s_nop 1
    v_cndmask_b32 v3, -16, v3, vcc
    buffer_load_ushort v20, v3, s[16:19], 0 offen
    v_add_u32 v3, 1, v2
    v_cmp_gt_u32 vcc, 18, v3
    v_mul_u32_u24 v3, 36, v3
    v_lshl_add_u32 v3, v1, 1, v3
    v_add_u32 v3, s40, v3
    s_mov_b64 s[42:43], vcc
    v_cmp_gt_u32 vcc, 18, v1
    s_and_b64 vcc, vcc, s[42:43]
    s_nop 1
    v_cndmask_b32 v3, -16, v3, vcc
    buffer_load_ushort v21, v3, s[16:19], 0 offen
    v_add_u32 v3, 2, v2
    v_cmp_gt_u32 vcc, 18, v3
    v_mul_u32_u24 v3, 36, v3
    v_lshl_add_u32 v3, v1, 1, v3
    v_add_u32 v3, s40, v3
    s_mov_b64 s[42:43], vcc
    v_cmp_gt_u32 vcc, 18, v1
    s_and_b64 vcc, vcc, s[42:43]
    s_nop 1
    v_cndmask_b32 v3, -16, v3, vcc
    buffer_load_ushort v22, v3, s[16:19], 0 offen
    v_add_u32 v3, 3, v2
    v_cmp_gt_u32 vcc, 18, v3
    v_mul_u32_u24 v3, 36, v3
    v_lshl_add_u32 v3, v1, 1, v3
    v_add_u32 v3, s40, v3
    s_mov_b64 s[42:43], vcc
    v_cmp_gt_u32 vcc, 18, v1
    s_and_b64 vcc, vcc, s[42:43]
    s_nop 1
    v_cndmask_b32 v3, -16, v3, vcc
    buffer_load_ushort v23, v3, s[16:19], 0 offen
    v_add_u32 v3, 4, v2
    v_cmp_gt_u32 vcc, 18, v3
    v_mul_u32_u24 v3, 36, v3
    v_lshl_add_u32 v3, v1, 1, v3
    v_add_u32 v3, s40, v3
    s_mov_b64 s[42:43], vcc
    v_cmp_gt_u32 vcc, 18, v1
    s_and_b64 vcc, vcc, s[42:43]
    s_nop 1
    v_cndmask_b32 v3, -16, v3, vcc
    buffer_load_ushort v24, v3, s[16:19], 0 offen
    v_add_u32 v3, 5, v2
    v_cmp_gt_u32 vcc, 18, v3
    v_mul_u32_u24 v3, 36, v3
    v_lshl_add_u32 v3, v1, 1, v3
    v_add_u32 v3, s40, v3
    s_mov_b64 s[42:43], vcc
    v_cmp_gt_u32 vcc, 18, v1
    s_and_b64 vcc, vcc, s[42:43]
    s_nop 1
    v_cndmask_b32 v3, -16, v3, vcc
    buffer_load_ushort v25, v3, s[16:19], 0 offen
    v_add_u32 v3, 6, v2
    v_cmp_gt_u32 vcc, 18, v3
    v_mul_u32_u24 v3, 36, v3
    v_lshl_add_u32 v3, v1, 1, v3
    v_add_u32 v3, s40, v3
    s_mov_b64 s[42:43], vcc
    v_cmp_gt_u32 vcc, 18, v1
    s_and_b64 vcc, vcc, s[42:43]
    s_nop 1
    v_cndmask_b32 v3, -16, v3, vcc
    buffer_load_ushort v26, v3, s[16:19], 0 offen
    v_add_u32 v3, 7, v2
    v_cmp_gt_u32 vcc, 18, v3
    v_mul_u32_u24 v3, 36, v3
    v_lshl_add_u32 v3, v1, 1, v3
    v_add_u32 v3, s40, v3
    s_mov_b64 s[42:43], vcc
    v_cmp_gt_u32 vcc, 18, v1
    s_and_b64 vcc, vcc, s[42:43]
    s_nop 1
    v_cndmask_b32 v3, -16, v3, vcc
    buffer_load_ushort v27, v3, s[16:19], 0 offen
    v_add_u32 v3, 16, v2
    v_cmp_gt_u32 vcc, 18, v3
    v_mul_u32_u24 v3, 36, v3
    v_lshl_add_u32 v3, v1, 1, v3
    v_add_u32 v3, s40, v3
    s_mov_b64 s[42:43], vcc
    v_cmp_gt_u32 vcc, 18, v1
    s_and_b64 vcc, vcc, s[42:43]
    s_nop 1
    v_cndmask_b32 v3, -16, v3, vcc
    buffer_load_ushort v28, v3, s[16:19], 0 offen
    v_add_u32 v3, 17, v2
    v_cmp_gt_u32 vcc, 18, v3
    v_mul_u32_u24 v3, 36, v3
    v_lshl_add_u32 v3, v1, 1, v3
    v_add_u32 v3, s40, v3
    s_mov_b64 s[42:43], vcc
    v_cmp_gt_u32 vcc, 18, v1
    s_and_b64 vcc, vcc, s[42:43]
    s_nop 1
    v_cndmask_b32 v3, -16, v3, vcc
    buffer_load_ushort v29, v3, s[16:19], 0 offen
    v_add_u32 v3, 18, v2
    v_cmp_gt_u32 vcc, 18, v3
    v_mul_u32_u24 v3, 36, v3
    v_lshl_add_u32 v3, v1, 1, v3
    v_add_u32 v3, s40, v3
    s_mov_b64 s[42:43], vcc
    v_cmp_gt_u32 vcc, 18, v1
    s_and_b64 vcc, vcc, s[42:43]
    s_nop 1
    v_cndmask_b32 v3, -16, v3, vcc
    buffer_load_ushort v30, v3, s[16:19], 0 offen
    v_add_u32 v3, 19, v2
    v_cmp_gt_u32 vcc, 18, v3
    v_mul_u32_u24 v3, 36, v3
    v_lshl_add_u32 v3, v1, 1, v3
    v_add_u32 v3, s40, v3
    s_mov_b64 s[42:43], vcc
    v_cmp_gt_u32 vcc, 18, v1
    s_and_b64 vcc, vcc, s[42:43]
    s_nop 1
    v_cndmask_b32 v3, -16, v3, vcc
    buffer_load_ushort v31, v3, s[16:19], 0 offen
    v_add_u32 v3, 20, v2
    v_cmp_gt_u32 vcc, 18, v3
    v_mul_u32_u24 v3, 36, v3
    v_lshl_add_u32 v3, v1, 1, v3
    v_add_u32 v3, s40, v3
    s_mov_b64 s[42:43], vcc
    v_cmp_gt_u32 vcc, 18, v1
    s_and_b64 vcc, vcc, s[42:43]
    s_nop 1
    v_cndmask_b32 v3, -16, v3, vcc
    buffer_load_ushort v32, v3, s[16:19], 0 offen
    v_add_u32 v3, 21, v2
    v_cmp_gt_u32 vcc, 18, v3
    v_mul_u32_u24 v3, 36, v3
    v_lshl_add_u32 v3, v1, 1, v3
    v_add_u32 v3, s40, v3
    s_mov_b64 s[42:43], vcc
    v_cmp_gt_u32 vcc, 18, v1
    s_and_b64 vcc, vcc, s[42:43]
    s_nop 1
    v_cndmask_b32 v3, -16, v3, vcc
    buffer_load_ushort v33, v3, s[16:19], 0 offen
    v_add_u32 v3, 22, v2
    v_cmp_gt_u32 vcc, 18, v3
    v_mul_u32_u24 v3, 36, v3
    v_lshl_add_u32 v3, v1, 1, v3
    v_add_u32 v3, s40, v3
    s_mov_b64 s[42:43], vcc
    v_cmp_gt_u32 vcc, 18, v1
    s_and_b64 vcc, vcc, s[42:43]
    s_nop 1
    v_cndmask_b32 v3, -16, v3, vcc
    buffer_load_ushort v34, v3, s[16:19], 0 offen
    v_add_u32 v3, 23, v2
    v_cmp_gt_u32 vcc, 18, v3
    v_mul_u32_u24 v3, 36, v3
    v_lshl_add_u32 v3, v1, 1, v3
    v_add_u32 v3, s40, v3
    s_mov_b64 s[42:43], vcc
    v_cmp_gt_u32 vcc, 18, v1
    s_and_b64 vcc, vcc, s[42:43]
    s_nop 1
    v_cndmask_b32 v3, -16, v3, vcc
    buffer_load_ushort v35, v3, s[16:19], 0 offen
    s_waitcnt vmcnt(0)
    v_lshl_or_b32 v12, v21, 16, v20
    v_lshl_or_b32 v13, v23, 16, v22
    v_lshl_or_b32 v14, v25, 16, v24
    v_lshl_or_b32 v15, v27, 16, v26
    v_lshl_or_b32 v16, v29, 16, v28
    v_lshl_or_b32 v17, v31, 16, v30
    v_lshl_or_b32 v18, v33, 16, v32
    v_lshl_or_b32 v19, v35, 16, v34
    v_and_b32 v1, 63, v0
    v_cmp_gt_u32 s[26:27], 32, v1
    v_lshrrev_b32 v5, 6, v0
    v_mul_u32_u24 v5, 8192, v5
    v_mov_b32 v52, 0
    v_mov_b32 v53, 0
    v_mov_b32 v54, 0
    v_mov_b32 v55, 0
    v_lshlrev_b32 v2, 4, v1
    v_add_u32 v2, v2, v5
    ds_write_b128 v2, v[52:55] offset:0
    ds_write_b128 v2, v[52:55] offset:1024
    ds_write_b128 v2, v[52:55] offset:2048
    ds_write_b128 v2, v[52:55] offset:3072
    ds_write_b128 v2, v[52:55] offset:4096
    ds_write_b128 v2, v[52:55] offset:5120
    ds_write_b128 v2, v[52:55] offset:6144
    ds_write_b128 v2, v[52:55] offset:7168
    s_waitcnt lgkmcnt(0)
    v_and_b32 v2, 31, v0
    v_lshlrev_b32 v2, 6, v2
    v_add_u32 v2, v2, v5
    v_mov_b32 v3, 0x3f80
    ds_write_b32 v2, v3 offset:6180
    v_lshrrev_b32 v2, 6, v0
    v_lshlrev_b32 v2, 5, v2
    v_and_b32 v3, 31, v0
    s_lshl_b32 s48, s47, 8
    v_add3_u32 v2, v2, v3, s48
    v_mul_u32_u24 v4, 3456, v2
    v_bfe_u32 v3, v0, 5, 1
    v_lshlrev_b32 v3, 4, v3
    v_add3_u32 v4, v4, v3, s24
    v_and_b32 v2, 31, v0
    v_mul_u32_u24 v6, 192, v2
    v_bfe_u32 v3, v0, 5, 1
    v_lshlrev_b32 v3, 3, v3
    v_add3_u32 v6, v6, v3, v5
    v_lshlrev_b32 v9, 6, v2
    v_lshlrev_b32 v3, 1, v3
    v_add3_u32 v9, v9, v3, v5
    v_bfe_u32 v1, v0, 5, 1
    v_lshlrev_b32 v1, 3, v1
    v_bfe_u32 v2, v0, 2, 2
    v_add_u32 v1, v1, v2
    v_bfe_u32 v2, v0, 4, 1
    v_lshlrev_b32 v2, 5, v2
    v_and_b32 v3, 3, v0
    v_lshlrev_b32 v3, 3, v3
    v_add_u32 v2, v2, v3
    v_mul_u32_u24 v7, 192, v1
    v_add3_u32 v7, v7, v2, v5
    v_lshlrev_b32 v8, 6, v1
    v_add3_u32 v8, v8, v2, v5
    v_mov_b32 v100, 0
    v_mov_b32 v101, 0
    v_mov_b32 v102, 0
    v_mov_b32 v103, 0
    v_mov_b32 v104, 0
    v_mov_b32 v105, 0
    v_mov_b32 v106, 0
    v_mov_b32 v107, 0
    v_mov_b32 v108, 0
    v_mov_b32 v109, 0
    v_mov_b32 v110, 0
    v_mov_b32 v111, 0
    v_mov_b32 v112, 0
    v_mov_b32 v113, 0
    v_mov_b32 v114, 0
    v_mov_b32 v115, 0
    v_mov_b32 v116, 0
    v_mov_b32 v117, 0
    v_mov_b32 v118, 0
    v_mov_b32 v119, 0
    v_mov_b32 v120, 0
    v_mov_b32 v121, 0
    v_mov_b32 v122, 0
    v_mov_b32 v123, 0
    v_mov_b32 v124, 0
    v_mov_b32 v125, 0
    v_mov_b32 v126, 0
    v_mov_b32 v127, 0
    v_mov_b32 v128, 0
    v_mov_b32 v129, 0
    v_mov_b32 v130, 0
    v_mov_b32 v131, 0
    v_mov_b32 v41, 0
    v_mov_b32 v42, 0
    v_mov_b32 v43, 0
    s_mov_b32 s28, 0x0
    buffer_load_dword v36, v4, s[12:15], s28 offen offset:1152
    buffer_load_dword v37, v4, s[12:15], s28 offen offset:1156
    buffer_load_dword v38, v4, s[12:15], s28 offen offset:1160
    buffer_load_dword v39, v4, s[12:15], s28 offen offset:1164
    buffer_load_dword v40, v4, s[12:15], s28 offen offset:1184
    buffer_load_dword v44, v4, s[12:15], s28 offen offset:2304
    buffer_load_dword v45, v4, s[12:15], s28 offen offset:2308
    buffer_load_dword v46, v4, s[12:15], s28 offen offset:2312
    buffer_load_dword v47, v4, s[12:15], s28 offen offset:2316
    buffer_load_dword v48, v4, s[12:15], s28 offen offset:2336
    s_waitcnt vmcnt(0)
    v_cndmask_b32 v40, 0, v40, s[26:27]
    ds_write_b128 v9, v[44:47] offset:6144
    s_mov_b64 s[30:31], exec
    s_mov_b64 exec, s[26:27]
    ds_write_b32 v9, v48 offset:6176
    s_mov_b64 exec, s[30:31]
    s_nop 1
    v_mfma_f32_32x32x16_bf16 v[52:67], v[12:15], v[36:39], 0
    v_mfma_f32_32x32x16_bf16 v[52:67], v[16:19], v[40:43], v[52:67]
    s_nop 7
    s_nop 3
    v_cndmask_b32 v68, v52, v60, s[26:27]
    v_cndmask_b32 v69, v52, v61, s[26:27]
    v_max3_f32 v1, v68, v69, v52
    v_min3_f32 v2, v68, v69, v52
    v_max3_f32 v1, v1, v53, v54
    v_min3_f32 v2, v2, v53, v54
    v_max3_f32 v1, v1, v55, v56
    v_min3_f32 v2, v2, v55, v56
    v_max3_f32 v1, v1, v57, v58
    v_min3_f32 v2, v2, v57, v58
    v_max_f32 v1, v1, v59
    v_min_f32 v2, v2, v59
    v_mov_b32 v68, v1
    v_mov_b32 v69, v2
    s_nop 1
    v_permlane32_swap_b32 v1, v68
    v_permlane32_swap_b32 v2, v69
    v_max_f32 v1, v1, v68
    v_min_f32 v2, v2, v69
    s_mov_b32 s44, 0x3fb8aa3b
    v_sub_f32 v68, v52, v1
    v_sub_f32 v78, v2, v52
    v_mul_f32 v68, s44, v68
    v_mul_f32 v78, s44, v78
    v_exp_f32 v68, v68
    v_exp_f32 v78, v78
    v_sub_f32 v69, v53, v1
    v_sub_f32 v79, v2, v53
    v_mul_f32 v69, s44, v69
    v_mul_f32 v79, s44, v79
    v_exp_f32 v69, v69
    v_exp_f32 v79, v79
    v_sub_f32 v70, v54, v1
    v_sub_f32 v80, v2, v54
    v_mul_f32 v70, s44, v70
    v_mul_f32 v80, s44, v80
    v_exp_f32 v70, v70
    v_exp_f32 v80, v80
    v_sub_f32 v71, v55, v1
    v_sub_f32 v81, v2, v55
    v_mul_f32 v71, s44, v71
    v_mul_f32 v81, s44, v81
    v_exp_f32 v71, v71
    v_exp_f32 v81, v81
    v_sub_f32 v72, v56, v1
    v_sub_f32 v82, v2, v56
    v_mul_f32 v72, s44, v72
    v_mul_f32 v82, s44, v82
    v_exp_f32 v72, v72
    v_exp_f32 v82, v82
    v_sub_f32 v73, v57, v1
    v_sub_f32 v83, v2, v57
    v_mul_f32 v73, s44, v73
    v_mul_f32 v83, s44, v83
    v_exp_f32 v73, v73
    v_exp_f32 v83, v83
    v_sub_f32 v74, v58, v1
    v_sub_f32 v84, v2, v58
    v_mul_f32 v74, s44, v74
    v_mul_f32 v84, s44, v84
    v_exp_f32 v74, v74
    v_exp_f32 v84, v84
    v_sub_f32 v75, v59, v1
    v_sub_f32 v85, v2, v59
    v_mul_f32 v75, s44, v75
    v_mul_f32 v85, s44, v85
    v_exp_f32 v75, v75
    v_exp_f32 v85, v85
    v_sub_f32 v76, v60, v1
    v_sub_f32 v86, v2, v60
    v_mul_f32 v76, s44, v76
    v_mul_f32 v86, s44, v86
    v_exp_f32 v76, v76
    v_exp_f32 v86, v86
    v_sub_f32 v77, v61, v1
    v_sub_f32 v87, v2, v61
    v_mul_f32 v77, s44, v77
    v_mul_f32 v87, s44, v87
    v_exp_f32 v77, v77
    v_exp_f32 v87, v87
    s_nop 0
    v_cndmask_b32 v76, 0, v76, s[26:27]
    v_cndmask_b32 v86, 0, v86, s[26:27]
    v_cndmask_b32 v77, 0, v77, s[26:27]
    v_cndmask_b32 v87, 0, v87, s[26:27]
    v_add_f32 v1, v68, v69
    v_add_f32 v2, v78, v79
    v_add_f32 v1, v1, v70
    v_add_f32 v2, v2, v80
    v_add_f32 v1, v1, v71
    v_add_f32 v2, v2, v81
    v_add_f32 v1, v1, v72
    v_add_f32 v2, v2, v82
    v_add_f32 v1, v1, v73
    v_add_f32 v2, v2, v83
    v_add_f32 v1, v1, v74
    v_add_f32 v2, v2, v84
    v_add_f32 v1, v1, v75
    v_add_f32 v2, v2, v85
    v_add_f32 v1, v1, v76
    v_add_f32 v2, v2, v86
    v_add_f32 v1, v1, v77
    v_add_f32 v2, v2, v87
    v_mov_b32 v3, v1
    v_mov_b32 v52, v2
    s_nop 1
    v_permlane32_swap_b32 v1, v3
    v_permlane32_swap_b32 v2, v52
    v_add_f32 v1, v1, v3
    v_add_f32 v2, v2, v52
    v_rcp_f32 v1, v1
    v_rcp_f32 v2, v2
    s_nop 0
    v_mul_f32 v68, v68, v1
    v_mul_f32 v78, v78, v2
    v_mul_f32 v69, v69, v1
    v_mul_f32 v79, v79, v2
    v_mul_f32 v70, v70, v1
    v_mul_f32 v80, v80, v2
    v_mul_f32 v71, v71, v1
    v_mul_f32 v81, v81, v2
    v_mul_f32 v72, v72, v1
    v_mul_f32 v82, v82, v2
    v_mul_f32 v73, v73, v1
    v_mul_f32 v83, v83, v2
    v_mul_f32 v74, v74, v1
    v_mul_f32 v84, v84, v2
    v_mul_f32 v75, v75, v1
    v_mul_f32 v85, v85, v2
    v_mul_f32 v76, v76, v1
    v_mul_f32 v86, v86, v2
    v_mul_f32 v77, v77, v1
    v_mul_f32 v87, v87, v2
    v_cvt_pk_bf16_f32 v52, v68, v69
    v_cvt_pk_bf16_f32 v53, v70, v71
    v_cvt_pk_bf16_f32 v54, v72, v73
    v_cvt_pk_bf16_f32 v55, v74, v75
    v_cvt_pk_bf16_f32 v56, v76, v77
    ds_write_b32 v6, v52 offset:0
    ds_write_b32 v6, v53 offset:4
    ds_write_b32 v6, v54 offset:16
    ds_write_b32 v6, v55 offset:20
    ds_write_b32 v6, v56 offset:32
    v_cvt_pk_bf16_f32 v52, v78, v79
    v_cvt_pk_bf16_f32 v53, v80, v81
    v_cvt_pk_bf16_f32 v54, v82, v83
    v_cvt_pk_bf16_f32 v55, v84, v85
    v_cvt_pk_bf16_f32 v56, v86, v87
    ds_write_b32 v6, v52 offset:64
    ds_write_b32 v6, v53 offset:68
    ds_write_b32 v6, v54 offset:80
    ds_write_b32 v6, v55 offset:84
    ds_write_b32 v6, v56 offset:96
    s_waitcnt lgkmcnt(0)
    ds_read_b64_tr_b16 v[96:97], v8 offset:6144
    ds_read_b64_tr_b16 v[98:99], v8 offset:6400
    ds_read_b64_tr_b16 v[88:89], v7 offset:0
    ds_read_b64_tr_b16 v[90:91], v7 offset:768
    ds_read_b64_tr_b16 v[92:93], v7 offset:64
    ds_read_b64_tr_b16 v[94:95], v7 offset:832
    s_waitcnt lgkmcnt(0)
    v_mfma_f32_32x32x16_bf16 v[100:115], v[88:91], v[96:99], v[100:115]
    v_mfma_f32_32x32x16_bf16 v[116:131], v[92:95], v[96:99], v[116:131]
    s_nop 7
    s_nop 3
    ds_read_b64_tr_b16 v[96:97], v8 offset:7168
    ds_read_b64_tr_b16 v[98:99], v8 offset:7424
    ds_read_b64_tr_b16 v[88:89], v7 offset:3072
    ds_read_b64_tr_b16 v[90:91], v7 offset:3840
    ds_read_b64_tr_b16 v[92:93], v7 offset:3136
    ds_read_b64_tr_b16 v[94:95], v7 offset:3904
    s_waitcnt lgkmcnt(0)
    v_mfma_f32_32x32x16_bf16 v[100:115], v[88:91], v[96:99], v[100:115]
    v_mfma_f32_32x32x16_bf16 v[116:131], v[92:95], v[96:99], v[116:131]
    s_nop 7
    s_nop 3
    s_nop 7
    s_nop 7
    s_barrier
    v_and_b32 v1, 63, v0
    v_lshlrev_b32 v1, 2, v1
    v_add_u32 v2, v1, v5
    ds_write_b32 v2, v100 offset:0
    ds_write_b32 v2, v101 offset:256
    ds_write_b32 v2, v102 offset:512
    ds_write_b32 v2, v103 offset:768
    ds_write_b32 v2, v104 offset:1024
    ds_write_b32 v2, v105 offset:1280
    ds_write_b32 v2, v106 offset:1536
    ds_write_b32 v2, v107 offset:1792
    ds_write_b32 v2, v108 offset:2048
    ds_write_b32 v2, v109 offset:2304
    ds_write_b32 v2, v110 offset:2560
    ds_write_b32 v2, v111 offset:2816
    ds_write_b32 v2, v112 offset:3072
    ds_write_b32 v2, v113 offset:3328
    ds_write_b32 v2, v114 offset:3584
    ds_write_b32 v2, v115 offset:3840
    ds_write_b32 v2, v116 offset:4096
    ds_write_b32 v2, v117 offset:4352
    ds_write_b32 v2, v118 offset:4608
    ds_write_b32 v2, v119 offset:4864
    ds_write_b32 v2, v120 offset:5120
    ds_write_b32 v2, v121 offset:5376
    ds_write_b32 v2, v122 offset:5632
    ds_write_b32 v2, v123 offset:5888
    ds_write_b32 v2, v124 offset:6144
    ds_write_b32 v2, v125 offset:6400
    ds_write_b32 v2, v126 offset:6656
    ds_write_b32 v2, v127 offset:6912
    ds_write_b32 v2, v128 offset:7168
    ds_write_b32 v2, v129 offset:7424
    ds_write_b32 v2, v130 offset:7680
    ds_write_b32 v2, v131 offset:7936
    s_waitcnt lgkmcnt(0)
    s_barrier
    v_cmp_gt_u32 vcc, 64, v0
    s_and_saveexec_b64 s[30:31], vcc
    s_cbranch_execz kvred_kernel_done
    ds_read_b32 v13, v1 offset:8192
    ds_read_b32 v14, v1 offset:16384
    ds_read_b32 v15, v1 offset:24576
    ds_read_b32 v16, v1 offset:32768
    ds_read_b32 v17, v1 offset:40960
    ds_read_b32 v18, v1 offset:49152
    ds_read_b32 v19, v1 offset:57344
    s_waitcnt lgkmcnt(0)
    v_add_f32 v100, v100, v13
    v_add_f32 v100, v100, v14
    v_add_f32 v100, v100, v15
    v_add_f32 v100, v100, v16
    v_add_f32 v100, v100, v17
    v_add_f32 v100, v100, v18
    v_add_f32 v100, v100, v19
    ds_read_b32 v13, v1 offset:8448
    ds_read_b32 v14, v1 offset:16640
    ds_read_b32 v15, v1 offset:24832
    ds_read_b32 v16, v1 offset:33024
    ds_read_b32 v17, v1 offset:41216
    ds_read_b32 v18, v1 offset:49408
    ds_read_b32 v19, v1 offset:57600
    s_waitcnt lgkmcnt(0)
    v_add_f32 v101, v101, v13
    v_add_f32 v101, v101, v14
    v_add_f32 v101, v101, v15
    v_add_f32 v101, v101, v16
    v_add_f32 v101, v101, v17
    v_add_f32 v101, v101, v18
    v_add_f32 v101, v101, v19
    ds_read_b32 v13, v1 offset:8704
    ds_read_b32 v14, v1 offset:16896
    ds_read_b32 v15, v1 offset:25088
    ds_read_b32 v16, v1 offset:33280
    ds_read_b32 v17, v1 offset:41472
    ds_read_b32 v18, v1 offset:49664
    ds_read_b32 v19, v1 offset:57856
    s_waitcnt lgkmcnt(0)
    v_add_f32 v102, v102, v13
    v_add_f32 v102, v102, v14
    v_add_f32 v102, v102, v15
    v_add_f32 v102, v102, v16
    v_add_f32 v102, v102, v17
    v_add_f32 v102, v102, v18
    v_add_f32 v102, v102, v19
    ds_read_b32 v13, v1 offset:8960
    ds_read_b32 v14, v1 offset:17152
    ds_read_b32 v15, v1 offset:25344
    ds_read_b32 v16, v1 offset:33536
    ds_read_b32 v17, v1 offset:41728
    ds_read_b32 v18, v1 offset:49920
    ds_read_b32 v19, v1 offset:58112
    s_waitcnt lgkmcnt(0)
    v_add_f32 v103, v103, v13
    v_add_f32 v103, v103, v14
    v_add_f32 v103, v103, v15
    v_add_f32 v103, v103, v16
    v_add_f32 v103, v103, v17
    v_add_f32 v103, v103, v18
    v_add_f32 v103, v103, v19
    ds_read_b32 v13, v1 offset:9216
    ds_read_b32 v14, v1 offset:17408
    ds_read_b32 v15, v1 offset:25600
    ds_read_b32 v16, v1 offset:33792
    ds_read_b32 v17, v1 offset:41984
    ds_read_b32 v18, v1 offset:50176
    ds_read_b32 v19, v1 offset:58368
    s_waitcnt lgkmcnt(0)
    v_add_f32 v104, v104, v13
    v_add_f32 v104, v104, v14
    v_add_f32 v104, v104, v15
    v_add_f32 v104, v104, v16
    v_add_f32 v104, v104, v17
    v_add_f32 v104, v104, v18
    v_add_f32 v104, v104, v19
    ds_read_b32 v13, v1 offset:9472
    ds_read_b32 v14, v1 offset:17664
    ds_read_b32 v15, v1 offset:25856
    ds_read_b32 v16, v1 offset:34048
    ds_read_b32 v17, v1 offset:42240
    ds_read_b32 v18, v1 offset:50432
    ds_read_b32 v19, v1 offset:58624
    s_waitcnt lgkmcnt(0)
    v_add_f32 v105, v105, v13
    v_add_f32 v105, v105, v14
    v_add_f32 v105, v105, v15
    v_add_f32 v105, v105, v16
    v_add_f32 v105, v105, v17
    v_add_f32 v105, v105, v18
    v_add_f32 v105, v105, v19
    ds_read_b32 v13, v1 offset:9728
    ds_read_b32 v14, v1 offset:17920
    ds_read_b32 v15, v1 offset:26112
    ds_read_b32 v16, v1 offset:34304
    ds_read_b32 v17, v1 offset:42496
    ds_read_b32 v18, v1 offset:50688
    ds_read_b32 v19, v1 offset:58880
    s_waitcnt lgkmcnt(0)
    v_add_f32 v106, v106, v13
    v_add_f32 v106, v106, v14
    v_add_f32 v106, v106, v15
    v_add_f32 v106, v106, v16
    v_add_f32 v106, v106, v17
    v_add_f32 v106, v106, v18
    v_add_f32 v106, v106, v19
    ds_read_b32 v13, v1 offset:9984
    ds_read_b32 v14, v1 offset:18176
    ds_read_b32 v15, v1 offset:26368
    ds_read_b32 v16, v1 offset:34560
    ds_read_b32 v17, v1 offset:42752
    ds_read_b32 v18, v1 offset:50944
    ds_read_b32 v19, v1 offset:59136
    s_waitcnt lgkmcnt(0)
    v_add_f32 v107, v107, v13
    v_add_f32 v107, v107, v14
    v_add_f32 v107, v107, v15
    v_add_f32 v107, v107, v16
    v_add_f32 v107, v107, v17
    v_add_f32 v107, v107, v18
    v_add_f32 v107, v107, v19
    ds_read_b32 v13, v1 offset:10240
    ds_read_b32 v14, v1 offset:18432
    ds_read_b32 v15, v1 offset:26624
    ds_read_b32 v16, v1 offset:34816
    ds_read_b32 v17, v1 offset:43008
    ds_read_b32 v18, v1 offset:51200
    ds_read_b32 v19, v1 offset:59392
    s_waitcnt lgkmcnt(0)
    v_add_f32 v108, v108, v13
    v_add_f32 v108, v108, v14
    v_add_f32 v108, v108, v15
    v_add_f32 v108, v108, v16
    v_add_f32 v108, v108, v17
    v_add_f32 v108, v108, v18
    v_add_f32 v108, v108, v19
    ds_read_b32 v13, v1 offset:10496
    ds_read_b32 v14, v1 offset:18688
    ds_read_b32 v15, v1 offset:26880
    ds_read_b32 v16, v1 offset:35072
    ds_read_b32 v17, v1 offset:43264
    ds_read_b32 v18, v1 offset:51456
    ds_read_b32 v19, v1 offset:59648
    s_waitcnt lgkmcnt(0)
    v_add_f32 v109, v109, v13
    v_add_f32 v109, v109, v14
    v_add_f32 v109, v109, v15
    v_add_f32 v109, v109, v16
    v_add_f32 v109, v109, v17
    v_add_f32 v109, v109, v18
    v_add_f32 v109, v109, v19
    ds_read_b32 v13, v1 offset:10752
    ds_read_b32 v14, v1 offset:18944
    ds_read_b32 v15, v1 offset:27136
    ds_read_b32 v16, v1 offset:35328
    ds_read_b32 v17, v1 offset:43520
    ds_read_b32 v18, v1 offset:51712
    ds_read_b32 v19, v1 offset:59904
    s_waitcnt lgkmcnt(0)
    v_add_f32 v110, v110, v13
    v_add_f32 v110, v110, v14
    v_add_f32 v110, v110, v15
    v_add_f32 v110, v110, v16
    v_add_f32 v110, v110, v17
    v_add_f32 v110, v110, v18
    v_add_f32 v110, v110, v19
    ds_read_b32 v13, v1 offset:11008
    ds_read_b32 v14, v1 offset:19200
    ds_read_b32 v15, v1 offset:27392
    ds_read_b32 v16, v1 offset:35584
    ds_read_b32 v17, v1 offset:43776
    ds_read_b32 v18, v1 offset:51968
    ds_read_b32 v19, v1 offset:60160
    s_waitcnt lgkmcnt(0)
    v_add_f32 v111, v111, v13
    v_add_f32 v111, v111, v14
    v_add_f32 v111, v111, v15
    v_add_f32 v111, v111, v16
    v_add_f32 v111, v111, v17
    v_add_f32 v111, v111, v18
    v_add_f32 v111, v111, v19
    ds_read_b32 v13, v1 offset:11264
    ds_read_b32 v14, v1 offset:19456
    ds_read_b32 v15, v1 offset:27648
    ds_read_b32 v16, v1 offset:35840
    ds_read_b32 v17, v1 offset:44032
    ds_read_b32 v18, v1 offset:52224
    ds_read_b32 v19, v1 offset:60416
    s_waitcnt lgkmcnt(0)
    v_add_f32 v112, v112, v13
    v_add_f32 v112, v112, v14
    v_add_f32 v112, v112, v15
    v_add_f32 v112, v112, v16
    v_add_f32 v112, v112, v17
    v_add_f32 v112, v112, v18
    v_add_f32 v112, v112, v19
    ds_read_b32 v13, v1 offset:11520
    ds_read_b32 v14, v1 offset:19712
    ds_read_b32 v15, v1 offset:27904
    ds_read_b32 v16, v1 offset:36096
    ds_read_b32 v17, v1 offset:44288
    ds_read_b32 v18, v1 offset:52480
    ds_read_b32 v19, v1 offset:60672
    s_waitcnt lgkmcnt(0)
    v_add_f32 v113, v113, v13
    v_add_f32 v113, v113, v14
    v_add_f32 v113, v113, v15
    v_add_f32 v113, v113, v16
    v_add_f32 v113, v113, v17
    v_add_f32 v113, v113, v18
    v_add_f32 v113, v113, v19
    ds_read_b32 v13, v1 offset:11776
    ds_read_b32 v14, v1 offset:19968
    ds_read_b32 v15, v1 offset:28160
    ds_read_b32 v16, v1 offset:36352
    ds_read_b32 v17, v1 offset:44544
    ds_read_b32 v18, v1 offset:52736
    ds_read_b32 v19, v1 offset:60928
    s_waitcnt lgkmcnt(0)
    v_add_f32 v114, v114, v13
    v_add_f32 v114, v114, v14
    v_add_f32 v114, v114, v15
    v_add_f32 v114, v114, v16
    v_add_f32 v114, v114, v17
    v_add_f32 v114, v114, v18
    v_add_f32 v114, v114, v19
    ds_read_b32 v13, v1 offset:12032
    ds_read_b32 v14, v1 offset:20224
    ds_read_b32 v15, v1 offset:28416
    ds_read_b32 v16, v1 offset:36608
    ds_read_b32 v17, v1 offset:44800
    ds_read_b32 v18, v1 offset:52992
    ds_read_b32 v19, v1 offset:61184
    s_waitcnt lgkmcnt(0)
    v_add_f32 v115, v115, v13
    v_add_f32 v115, v115, v14
    v_add_f32 v115, v115, v15
    v_add_f32 v115, v115, v16
    v_add_f32 v115, v115, v17
    v_add_f32 v115, v115, v18
    v_add_f32 v115, v115, v19
    ds_read_b32 v13, v1 offset:12288
    ds_read_b32 v14, v1 offset:20480
    ds_read_b32 v15, v1 offset:28672
    ds_read_b32 v16, v1 offset:36864
    ds_read_b32 v17, v1 offset:45056
    ds_read_b32 v18, v1 offset:53248
    ds_read_b32 v19, v1 offset:61440
    s_waitcnt lgkmcnt(0)
    v_add_f32 v116, v116, v13
    v_add_f32 v116, v116, v14
    v_add_f32 v116, v116, v15
    v_add_f32 v116, v116, v16
    v_add_f32 v116, v116, v17
    v_add_f32 v116, v116, v18
    v_add_f32 v116, v116, v19
    ds_read_b32 v13, v1 offset:12544
    ds_read_b32 v14, v1 offset:20736
    ds_read_b32 v15, v1 offset:28928
    ds_read_b32 v16, v1 offset:37120
    ds_read_b32 v17, v1 offset:45312
    ds_read_b32 v18, v1 offset:53504
    ds_read_b32 v19, v1 offset:61696
    s_waitcnt lgkmcnt(0)
    v_add_f32 v117, v117, v13
    v_add_f32 v117, v117, v14
    v_add_f32 v117, v117, v15
    v_add_f32 v117, v117, v16
    v_add_f32 v117, v117, v17
    v_add_f32 v117, v117, v18
    v_add_f32 v117, v117, v19
    ds_read_b32 v13, v1 offset:12800
    ds_read_b32 v14, v1 offset:20992
    ds_read_b32 v15, v1 offset:29184
    ds_read_b32 v16, v1 offset:37376
    ds_read_b32 v17, v1 offset:45568
    ds_read_b32 v18, v1 offset:53760
    ds_read_b32 v19, v1 offset:61952
    s_waitcnt lgkmcnt(0)
    v_add_f32 v118, v118, v13
    v_add_f32 v118, v118, v14
    v_add_f32 v118, v118, v15
    v_add_f32 v118, v118, v16
    v_add_f32 v118, v118, v17
    v_add_f32 v118, v118, v18
    v_add_f32 v118, v118, v19
    ds_read_b32 v13, v1 offset:13056
    ds_read_b32 v14, v1 offset:21248
    ds_read_b32 v15, v1 offset:29440
    ds_read_b32 v16, v1 offset:37632
    ds_read_b32 v17, v1 offset:45824
    ds_read_b32 v18, v1 offset:54016
    ds_read_b32 v19, v1 offset:62208
    s_waitcnt lgkmcnt(0)
    v_add_f32 v119, v119, v13
    v_add_f32 v119, v119, v14
    v_add_f32 v119, v119, v15
    v_add_f32 v119, v119, v16
    v_add_f32 v119, v119, v17
    v_add_f32 v119, v119, v18
    v_add_f32 v119, v119, v19
    ds_read_b32 v13, v1 offset:13312
    ds_read_b32 v14, v1 offset:21504
    ds_read_b32 v15, v1 offset:29696
    ds_read_b32 v16, v1 offset:37888
    ds_read_b32 v17, v1 offset:46080
    ds_read_b32 v18, v1 offset:54272
    ds_read_b32 v19, v1 offset:62464
    s_waitcnt lgkmcnt(0)
    v_add_f32 v120, v120, v13
    v_add_f32 v120, v120, v14
    v_add_f32 v120, v120, v15
    v_add_f32 v120, v120, v16
    v_add_f32 v120, v120, v17
    v_add_f32 v120, v120, v18
    v_add_f32 v120, v120, v19
    ds_read_b32 v13, v1 offset:13568
    ds_read_b32 v14, v1 offset:21760
    ds_read_b32 v15, v1 offset:29952
    ds_read_b32 v16, v1 offset:38144
    ds_read_b32 v17, v1 offset:46336
    ds_read_b32 v18, v1 offset:54528
    ds_read_b32 v19, v1 offset:62720
    s_waitcnt lgkmcnt(0)
    v_add_f32 v121, v121, v13
    v_add_f32 v121, v121, v14
    v_add_f32 v121, v121, v15
    v_add_f32 v121, v121, v16
    v_add_f32 v121, v121, v17
    v_add_f32 v121, v121, v18
    v_add_f32 v121, v121, v19
    ds_read_b32 v13, v1 offset:13824
    ds_read_b32 v14, v1 offset:22016
    ds_read_b32 v15, v1 offset:30208
    ds_read_b32 v16, v1 offset:38400
    ds_read_b32 v17, v1 offset:46592
    ds_read_b32 v18, v1 offset:54784
    ds_read_b32 v19, v1 offset:62976
    s_waitcnt lgkmcnt(0)
    v_add_f32 v122, v122, v13
    v_add_f32 v122, v122, v14
    v_add_f32 v122, v122, v15
    v_add_f32 v122, v122, v16
    v_add_f32 v122, v122, v17
    v_add_f32 v122, v122, v18
    v_add_f32 v122, v122, v19
    ds_read_b32 v13, v1 offset:14080
    ds_read_b32 v14, v1 offset:22272
    ds_read_b32 v15, v1 offset:30464
    ds_read_b32 v16, v1 offset:38656
    ds_read_b32 v17, v1 offset:46848
    ds_read_b32 v18, v1 offset:55040
    ds_read_b32 v19, v1 offset:63232
    s_waitcnt lgkmcnt(0)
    v_add_f32 v123, v123, v13
    v_add_f32 v123, v123, v14
    v_add_f32 v123, v123, v15
    v_add_f32 v123, v123, v16
    v_add_f32 v123, v123, v17
    v_add_f32 v123, v123, v18
    v_add_f32 v123, v123, v19
    ds_read_b32 v13, v1 offset:14336
    ds_read_b32 v14, v1 offset:22528
    ds_read_b32 v15, v1 offset:30720
    ds_read_b32 v16, v1 offset:38912
    ds_read_b32 v17, v1 offset:47104
    ds_read_b32 v18, v1 offset:55296
    ds_read_b32 v19, v1 offset:63488
    s_waitcnt lgkmcnt(0)
    v_add_f32 v124, v124, v13
    v_add_f32 v124, v124, v14
    v_add_f32 v124, v124, v15
    v_add_f32 v124, v124, v16
    v_add_f32 v124, v124, v17
    v_add_f32 v124, v124, v18
    v_add_f32 v124, v124, v19
    ds_read_b32 v13, v1 offset:14592
    ds_read_b32 v14, v1 offset:22784
    ds_read_b32 v15, v1 offset:30976
    ds_read_b32 v16, v1 offset:39168
    ds_read_b32 v17, v1 offset:47360
    ds_read_b32 v18, v1 offset:55552
    ds_read_b32 v19, v1 offset:63744
    s_waitcnt lgkmcnt(0)
    v_add_f32 v125, v125, v13
    v_add_f32 v125, v125, v14
    v_add_f32 v125, v125, v15
    v_add_f32 v125, v125, v16
    v_add_f32 v125, v125, v17
    v_add_f32 v125, v125, v18
    v_add_f32 v125, v125, v19
    ds_read_b32 v13, v1 offset:14848
    ds_read_b32 v14, v1 offset:23040
    ds_read_b32 v15, v1 offset:31232
    ds_read_b32 v16, v1 offset:39424
    ds_read_b32 v17, v1 offset:47616
    ds_read_b32 v18, v1 offset:55808
    ds_read_b32 v19, v1 offset:64000
    s_waitcnt lgkmcnt(0)
    v_add_f32 v126, v126, v13
    v_add_f32 v126, v126, v14
    v_add_f32 v126, v126, v15
    v_add_f32 v126, v126, v16
    v_add_f32 v126, v126, v17
    v_add_f32 v126, v126, v18
    v_add_f32 v126, v126, v19
    ds_read_b32 v13, v1 offset:15104
    ds_read_b32 v14, v1 offset:23296
    ds_read_b32 v15, v1 offset:31488
    ds_read_b32 v16, v1 offset:39680
    ds_read_b32 v17, v1 offset:47872
    ds_read_b32 v18, v1 offset:56064
    ds_read_b32 v19, v1 offset:64256
    s_waitcnt lgkmcnt(0)
    v_add_f32 v127, v127, v13
    v_add_f32 v127, v127, v14
    v_add_f32 v127, v127, v15
    v_add_f32 v127, v127, v16
    v_add_f32 v127, v127, v17
    v_add_f32 v127, v127, v18
    v_add_f32 v127, v127, v19
    ds_read_b32 v13, v1 offset:15360
    ds_read_b32 v14, v1 offset:23552
    ds_read_b32 v15, v1 offset:31744
    ds_read_b32 v16, v1 offset:39936
    ds_read_b32 v17, v1 offset:48128
    ds_read_b32 v18, v1 offset:56320
    ds_read_b32 v19, v1 offset:64512
    s_waitcnt lgkmcnt(0)
    v_add_f32 v128, v128, v13
    v_add_f32 v128, v128, v14
    v_add_f32 v128, v128, v15
    v_add_f32 v128, v128, v16
    v_add_f32 v128, v128, v17
    v_add_f32 v128, v128, v18
    v_add_f32 v128, v128, v19
    ds_read_b32 v13, v1 offset:15616
    ds_read_b32 v14, v1 offset:23808
    ds_read_b32 v15, v1 offset:32000
    ds_read_b32 v16, v1 offset:40192
    ds_read_b32 v17, v1 offset:48384
    ds_read_b32 v18, v1 offset:56576
    ds_read_b32 v19, v1 offset:64768
    s_waitcnt lgkmcnt(0)
    v_add_f32 v129, v129, v13
    v_add_f32 v129, v129, v14
    v_add_f32 v129, v129, v15
    v_add_f32 v129, v129, v16
    v_add_f32 v129, v129, v17
    v_add_f32 v129, v129, v18
    v_add_f32 v129, v129, v19
    ds_read_b32 v13, v1 offset:15872
    ds_read_b32 v14, v1 offset:24064
    ds_read_b32 v15, v1 offset:32256
    ds_read_b32 v16, v1 offset:40448
    ds_read_b32 v17, v1 offset:48640
    ds_read_b32 v18, v1 offset:56832
    ds_read_b32 v19, v1 offset:65024
    s_waitcnt lgkmcnt(0)
    v_add_f32 v130, v130, v13
    v_add_f32 v130, v130, v14
    v_add_f32 v130, v130, v15
    v_add_f32 v130, v130, v16
    v_add_f32 v130, v130, v17
    v_add_f32 v130, v130, v18
    v_add_f32 v130, v130, v19
    ds_read_b32 v13, v1 offset:16128
    ds_read_b32 v14, v1 offset:24320
    ds_read_b32 v15, v1 offset:32512
    ds_read_b32 v16, v1 offset:40704
    ds_read_b32 v17, v1 offset:48896
    ds_read_b32 v18, v1 offset:57088
    ds_read_b32 v19, v1 offset:65280
    s_waitcnt lgkmcnt(0)
    v_add_f32 v131, v131, v13
    v_add_f32 v131, v131, v14
    v_add_f32 v131, v131, v15
    v_add_f32 v131, v131, v16
    v_add_f32 v131, v131, v17
    v_add_f32 v131, v131, v18
    v_add_f32 v131, v131, v19
    v_lshlrev_b32 v1, 4, v0
    s_lshl_b32 s28, s2, 13
    buffer_store_dwordx4 v[100:103], v1, s[20:23], s28 offen offset:0
    buffer_store_dwordx4 v[104:107], v1, s[20:23], s28 offen offset:1024
    buffer_store_dwordx4 v[108:111], v1, s[20:23], s28 offen offset:2048
    buffer_store_dwordx4 v[112:115], v1, s[20:23], s28 offen offset:3072
    v_add_u32 v1, 0x1000, v1
    buffer_store_dwordx4 v[116:119], v1, s[20:23], s28 offen offset:0
    buffer_store_dwordx4 v[120:123], v1, s[20:23], s28 offen offset:1024
    buffer_store_dwordx4 v[124:127], v1, s[20:23], s28 offen offset:2048
    buffer_store_dwordx4 v[128:131], v1, s[20:23], s28 offen offset:3072
kvred_kernel_done:
    s_endpgm
.globl apply_kernel
.p2align 8
.type apply_kernel,@function
apply_kernel:
    s_load_dwordx2 s[4:5], s[0:1], 72
    s_load_dwordx2 s[6:7], s[0:1], 16
    s_load_dwordx2 s[8:9], s[0:1], 72
    s_load_dwordx2 s[10:11], s[0:1], 72
    s_cmp_ge_u32 s2, 512
    s_cbranch_scc1 apply_kernel_done
    s_waitcnt lgkmcnt(0)
    s_add_u32 s4, s4, 0x240000
    s_addc_u32 s5, s5, 0
    s_add_u32 s8, s8, 0x1200000
    s_addc_u32 s9, s9, 0
    s_add_u32 s10, s10, 0x900000
    s_addc_u32 s11, s11, 0
    s_mov_b32 s12, s4
    s_and_b32 s13, s5, 0xffff
    s_mov_b32 s14, 0x6c0000
    s_mov_b32 s15, 0x20000
    s_mov_b32 s16, s6
    s_and_b32 s17, s7, 0xffff
    s_mov_b32 s18, 0x5100
    s_mov_b32 s19, 0x20000
    s_mov_b32 s20, s8
    s_and_b32 s21, s9, 0xffff
    s_mov_b32 s22, 0x200000
    s_mov_b32 s23, 0x20000
    s_mov_b32 s28, s10
    s_and_b32 s29, s11, 0xffff
    s_mov_b32 s30, 0x240000
    s_mov_b32 s31, 0x20000
    s_lshr_b32 s32, s2, 4
    s_and_b32 s33, s2, 15
    s_mul_i32 s24, s32, 36
    v_and_b32 v1, 31, v0
    v_bfe_u32 v2, v0, 5, 1
    v_lshlrev_b32 v2, 3, v2
    s_mul_i32 s40, s32, 648
    v_add_u32 v3, 0, v2
    v_cmp_gt_u32 vcc, 18, v3
    v_mul_u32_u24 v3, 36, v3
    v_lshl_add_u32 v3, v1, 1, v3
    v_add_u32 v3, s40, v3
    s_mov_b64 s[42:43], vcc
    v_cmp_gt_u32 vcc, 18, v1
    s_and_b64 vcc, vcc, s[42:43]
    s_nop 1
    v_cndmask_b32 v3, -16, v3, vcc
    buffer_load_ushort v16, v3, s[16:19], 0 offen
    v_add_u32 v3, 1, v2
    v_cmp_gt_u32 vcc, 18, v3
    v_mul_u32_u24 v3, 36, v3
    v_lshl_add_u32 v3, v1, 1, v3
    v_add_u32 v3, s40, v3
    s_mov_b64 s[42:43], vcc
    v_cmp_gt_u32 vcc, 18, v1
    s_and_b64 vcc, vcc, s[42:43]
    s_nop 1
    v_cndmask_b32 v3, -16, v3, vcc
    buffer_load_ushort v17, v3, s[16:19], 0 offen
    v_add_u32 v3, 2, v2
    v_cmp_gt_u32 vcc, 18, v3
    v_mul_u32_u24 v3, 36, v3
    v_lshl_add_u32 v3, v1, 1, v3
    v_add_u32 v3, s40, v3
    s_mov_b64 s[42:43], vcc
    v_cmp_gt_u32 vcc, 18, v1
    s_and_b64 vcc, vcc, s[42:43]
    s_nop 1
    v_cndmask_b32 v3, -16, v3, vcc
    buffer_load_ushort v18, v3, s[16:19], 0 offen
    v_add_u32 v3, 3, v2
    v_cmp_gt_u32 vcc, 18, v3
    v_mul_u32_u24 v3, 36, v3
    v_lshl_add_u32 v3, v1, 1, v3
    v_add_u32 v3, s40, v3
    s_mov_b64 s[42:43], vcc
    v_cmp_gt_u32 vcc, 18, v1
    s_and_b64 vcc, vcc, s[42:43]
    s_nop 1
    v_cndmask_b32 v3, -16, v3, vcc
    buffer_load_ushort v19, v3, s[16:19], 0 offen
    v_add_u32 v3, 4, v2
    v_cmp_gt_u32 vcc, 18, v3
    v_mul_u32_u24 v3, 36, v3
    v_lshl_add_u32 v3, v1, 1, v3
    v_add_u32 v3, s40, v3
    s_mov_b64 s[42:43], vcc
    v_cmp_gt_u32 vcc, 18, v1
    s_and_b64 vcc, vcc, s[42:43]
    s_nop 1
    v_cndmask_b32 v3, -16, v3, vcc
    buffer_load_ushort v20, v3, s[16:19], 0 offen
    v_add_u32 v3, 5, v2
    v_cmp_gt_u32 vcc, 18, v3
    v_mul_u32_u24 v3, 36, v3
    v_lshl_add_u32 v3, v1, 1, v3
    v_add_u32 v3, s40, v3
    s_mov_b64 s[42:43], vcc
    v_cmp_gt_u32 vcc, 18, v1
    s_and_b64 vcc, vcc, s[42:43]
    s_nop 1
    v_cndmask_b32 v3, -16, v3, vcc
    buffer_load_ushort v21, v3, s[16:19], 0 offen
    v_add_u32 v3, 6, v2
    v_cmp_gt_u32 vcc, 18, v3
    v_mul_u32_u24 v3, 36, v3
    v_lshl_add_u32 v3, v1, 1, v3
    v_add_u32 v3, s40, v3
    s_mov_b64 s[42:43], vcc
    v_cmp_gt_u32 vcc, 18, v1
    s_and_b64 vcc, vcc, s[42:43]
    s_nop 1
    v_cndmask_b32 v3, -16, v3, vcc
    buffer_load_ushort v22, v3, s[16:19], 0 offen
    v_add_u32 v3, 7, v2
    v_cmp_gt_u32 vcc, 18, v3
    v_mul_u32_u24 v3, 36, v3
    v_lshl_add_u32 v3, v1, 1, v3
    v_add_u32 v3, s40, v3
    s_mov_b64 s[42:43], vcc
    v_cmp_gt_u32 vcc, 18, v1
    s_and_b64 vcc, vcc, s[42:43]
    s_nop 1
    v_cndmask_b32 v3, -16, v3, vcc
    buffer_load_ushort v23, v3, s[16:19], 0 offen
    v_add_u32 v3, 16, v2
    v_cmp_gt_u32 vcc, 18, v3
    v_mul_u32_u24 v3, 36, v3
    v_lshl_add_u32 v3, v1, 1, v3
    v_add_u32 v3, s40, v3
    s_mov_b64 s[42:43], vcc
    v_cmp_gt_u32 vcc, 18, v1
    s_and_b64 vcc, vcc, s[42:43]
    s_nop 1
    v_cndmask_b32 v3, -16, v3, vcc
    buffer_load_ushort v24, v3, s[16:19], 0 offen
    v_add_u32 v3, 17, v2
    v_cmp_gt_u32 vcc, 18, v3
    v_mul_u32_u24 v3, 36, v3
    v_lshl_add_u32 v3, v1, 1, v3
    v_add_u32 v3, s40, v3
    s_mov_b64 s[42:43], vcc
    v_cmp_gt_u32 vcc, 18, v1
    s_and_b64 vcc, vcc, s[42:43]
    s_nop 1
    v_cndmask_b32 v3, -16, v3, vcc
    buffer_load_ushort v25, v3, s[16:19], 0 offen
    v_add_u32 v3, 18, v2
    v_cmp_gt_u32 vcc, 18, v3
    v_mul_u32_u24 v3, 36, v3
    v_lshl_add_u32 v3, v1, 1, v3
    v_add_u32 v3, s40, v3
    s_mov_b64 s[42:43], vcc
    v_cmp_gt_u32 vcc, 18, v1
    s_and_b64 vcc, vcc, s[42:43]
    s_nop 1
    v_cndmask_b32 v3, -16, v3, vcc
    buffer_load_ushort v26, v3, s[16:19], 0 offen
    v_add_u32 v3, 19, v2
    v_cmp_gt_u32 vcc, 18, v3
    v_mul_u32_u24 v3, 36, v3
    v_lshl_add_u32 v3, v1, 1, v3
    v_add_u32 v3, s40, v3
    s_mov_b64 s[42:43], vcc
    v_cmp_gt_u32 vcc, 18, v1
    s_and_b64 vcc, vcc, s[42:43]
    s_nop 1
    v_cndmask_b32 v3, -16, v3, vcc
    buffer_load_ushort v27, v3, s[16:19], 0 offen
    v_add_u32 v3, 20, v2
    v_cmp_gt_u32 vcc, 18, v3
    v_mul_u32_u24 v3, 36, v3
    v_lshl_add_u32 v3, v1, 1, v3
    v_add_u32 v3, s40, v3
    s_mov_b64 s[42:43], vcc
    v_cmp_gt_u32 vcc, 18, v1
    s_and_b64 vcc, vcc, s[42:43]
    s_nop 1
    v_cndmask_b32 v3, -16, v3, vcc
    buffer_load_ushort v28, v3, s[16:19], 0 offen
    v_add_u32 v3, 21, v2
    v_cmp_gt_u32 vcc, 18, v3
    v_mul_u32_u24 v3, 36, v3
    v_lshl_add_u32 v3, v1, 1, v3
    v_add_u32 v3, s40, v3
    s_mov_b64 s[42:43], vcc
    v_cmp_gt_u32 vcc, 18, v1
    s_and_b64 vcc, vcc, s[42:43]
    s_nop 1
    v_cndmask_b32 v3, -16, v3, vcc
    buffer_load_ushort v29, v3, s[16:19], 0 offen
    v_add_u32 v3, 22, v2
    v_cmp_gt_u32 vcc, 18, v3
    v_mul_u32_u24 v3, 36, v3
    v_lshl_add_u32 v3, v1, 1, v3
    v_add_u32 v3, s40, v3
    s_mov_b64 s[42:43], vcc
    v_cmp_gt_u32 vcc, 18, v1
    s_and_b64 vcc, vcc, s[42:43]
    s_nop 1
    v_cndmask_b32 v3, -16, v3, vcc
    buffer_load_ushort v30, v3, s[16:19], 0 offen
    v_add_u32 v3, 23, v2
    v_cmp_gt_u32 vcc, 18, v3
    v_mul_u32_u24 v3, 36, v3
    v_lshl_add_u32 v3, v1, 1, v3
    v_add_u32 v3, s40, v3
    s_mov_b64 s[42:43], vcc
    v_cmp_gt_u32 vcc, 18, v1
    s_and_b64 vcc, vcc, s[42:43]
    s_nop 1
    v_cndmask_b32 v3, -16, v3, vcc
    buffer_load_ushort v31, v3, s[16:19], 0 offen
    s_waitcnt vmcnt(0)
    v_lshl_or_b32 v8, v17, 16, v16
    v_lshl_or_b32 v9, v19, 16, v18
    v_lshl_or_b32 v10, v21, 16, v20
    v_lshl_or_b32 v11, v23, 16, v22
    v_lshl_or_b32 v12, v25, 16, v24
    v_lshl_or_b32 v13, v27, 16, v26
    v_lshl_or_b32 v14, v29, 16, v28
    v_lshl_or_b32 v15, v31, 16, v30
    v_and_b32 v1, 63, v0
    v_cmp_gt_u32 s[26:27], 32, v1
    v_lshrrev_b32 v2, 6, v0
    v_lshlrev_b32 v2, 5, v2
    v_and_b32 v3, 31, v0
    s_lshl_b32 s34, s33, 7
    v_add3_u32 v2, v2, v3, s34
    v_mul_u32_u24 v4, 3456, v2
    v_bfe_u32 v3, v0, 5, 1
    v_lshlrev_b32 v3, 4, v3
    v_add3_u32 v4, v4, v3, s24
    v_mul_u32_u24 v5, 1152, v2
    v_lshrrev_b32 v3, 1, v3
    v_add3_u32 v5, v5, v3, s24
    buffer_load_dword v32, v4, s[12:15], 0 offen offset:0
    buffer_load_dword v33, v4, s[12:15], 0 offen offset:4
    buffer_load_dword v34, v4, s[12:15], 0 offen offset:8
    buffer_load_dword v35, v4, s[12:15], 0 offen offset:12
    buffer_load_dword v36, v4, s[12:15], 0 offen offset:32
    v_mov_b32 v37, 0
    v_mov_b32 v38, 0
    v_mov_b32 v39, 0
    v_lshlrev_b32 v1, 4, v1
    s_lshl_b32 s35, s32, 16
    v_add_u32 v2, 0x1000, v1
    v_lshrrev_b32 v188, 6, v0
    v_lshlrev_b32 v188, 14, v188
    v_add_u32 v1, v1, v188
    v_add_u32 v2, v2, v188
    buffer_load_dwordx4 v[124:127], v1, s[20:23], s35 offen offset:0
    buffer_load_dwordx4 v[128:131], v1, s[20:23], s35 offen offset:1024
    buffer_load_dwordx4 v[132:135], v1, s[20:23], s35 offen offset:2048
    buffer_load_dwordx4 v[136:139], v1, s[20:23], s35 offen offset:3072
    buffer_load_dwordx4 v[140:143], v2, s[20:23], s35 offen offset:0
    buffer_load_dwordx4 v[144:147], v2, s[20:23], s35 offen offset:1024
    buffer_load_dwordx4 v[148:151], v2, s[20:23], s35 offen offset:2048
    buffer_load_dwordx4 v[152:155], v2, s[20:23], s35 offen offset:3072
    s_add_u32 s35, s35, 0x2000
    buffer_load_dwordx4 v[156:159], v1, s[20:23], s35 offen offset:0
    buffer_load_dwordx4 v[160:163], v1, s[20:23], s35 offen offset:1024
    buffer_load_dwordx4 v[164:167], v1, s[20:23], s35 offen offset:2048
    buffer_load_dwordx4 v[168:171], v1, s[20:23], s35 offen offset:3072
    buffer_load_dwordx4 v[172:175], v2, s[20:23], s35 offen offset:0
    buffer_load_dwordx4 v[176:179], v2, s[20:23], s35 offen offset:1024
    buffer_load_dwordx4 v[180:183], v2, s[20:23], s35 offen offset:2048
    buffer_load_dwordx4 v[184:187], v2, s[20:23], s35 offen offset:3072
    s_add_u32 s35, s35, 0x2000
    s_waitcnt vmcnt(0)
    v_add_f32 v124, v124, v156
    v_add_f32 v125, v125, v157
    v_add_f32 v126, v126, v158
    v_add_f32 v127, v127, v159
    v_add_f32 v128, v128, v160
    v_add_f32 v129, v129, v161
    v_add_f32 v130, v130, v162
    v_add_f32 v131, v131, v163
    v_add_f32 v132, v132, v164
    v_add_f32 v133, v133, v165
    v_add_f32 v134, v134, v166
    v_add_f32 v135, v135, v167
    v_add_f32 v136, v136, v168
    v_add_f32 v137, v137, v169
    v_add_f32 v138, v138, v170
    v_add_f32 v139, v139, v171
    v_add_f32 v140, v140, v172
    v_add_f32 v141, v141, v173
    v_add_f32 v142, v142, v174
    v_add_f32 v143, v143, v175
    v_add_f32 v144, v144, v176
    v_add_f32 v145, v145, v177
    v_add_f32 v146, v146, v178
    v_add_f32 v147, v147, v179
    v_add_f32 v148, v148, v180
    v_add_f32 v149, v149, v181
    v_add_f32 v150, v150, v182
    v_add_f32 v151, v151, v183
    v_add_f32 v152, v152, v184
    v_add_f32 v153, v153, v185
    v_add_f32 v154, v154, v186
    v_add_f32 v155, v155, v187
    v_and_b32 v189, 63, v0
    v_lshlrev_b32 v189, 4, v189
    v_lshrrev_b32 v188, 1, v188
    v_add_u32 v188, v188, v189
    ds_write_b128 v188, v[124:127] offset:0
    ds_write_b128 v188, v[128:131] offset:1024
    ds_write_b128 v188, v[132:135] offset:2048
    ds_write_b128 v188, v[136:139] offset:3072
    ds_write_b128 v188, v[140:143] offset:4096
    ds_write_b128 v188, v[144:147] offset:5120
    ds_write_b128 v188, v[148:151] offset:6144
    ds_write_b128 v188, v[152:155] offset:7168
    s_waitcnt lgkmcnt(0)
    s_barrier
    ds_read_b128 v[124:127], v189 offset:0
    ds_read_b128 v[128:131], v189 offset:1024
    ds_read_b128 v[132:135], v189 offset:2048
    ds_read_b128 v[136:139], v189 offset:3072
    ds_read_b128 v[140:143], v189 offset:4096
    ds_read_b128 v[144:147], v189 offset:5120
    ds_read_b128 v[148:151], v189 offset:6144
    ds_read_b128 v[152:155], v189 offset:7168
    s_waitcnt lgkmcnt(0)
    ds_read_b128 v[156:159], v189 offset:8192
    ds_read_b128 v[160:163], v189 offset:9216
    ds_read_b128 v[164:167], v189 offset:10240
    ds_read_b128 v[168:171], v189 offset:11264
    ds_read_b128 v[172:175], v189 offset:12288
    ds_read_b128 v[176:179], v189 offset:13312
    ds_read_b128 v[180:183], v189 offset:14336
    ds_read_b128 v[184:187], v189 offset:15360
    s_waitcnt lgkmcnt(0)
    v_add_f32 v124, v124, v156
    v_add_f32 v125, v125, v157
    v_add_f32 v126, v126, v158
    v_add_f32 v127, v127, v159
    v_add_f32 v128, v128, v160
    v_add_f32 v129, v129, v161
    v_add_f32 v130, v130, v162
    v_add_f32 v131, v131, v163
    v_add_f32 v132, v132, v164
    v_add_f32 v133, v133, v165
    v_add_f32 v134, v134, v166
    v_add_f32 v135, v135, v167
    v_add_f32 v136, v136, v168
    v_add_f32 v137, v137, v169
    v_add_f32 v138, v138, v170
    v_add_f32 v139, v139, v171
    v_add_f32 v140, v140, v172
    v_add_f32 v141, v141, v173
    v_add_f32 v142, v142, v174
    v_add_f32 v143, v143, v175
    v_add_f32 v144, v144, v176
    v_add_f32 v145, v145, v177
    v_add_f32 v146, v146, v178
    v_add_f32 v147, v147, v179
    v_add_f32 v148, v148, v180
    v_add_f32 v149, v149, v181
    v_add_f32 v150, v150, v182
    v_add_f32 v151, v151, v183
    v_add_f32 v152, v152, v184
    v_add_f32 v153, v153, v185
    v_add_f32 v154, v154, v186
    v_add_f32 v155, v155, v187
    ds_read_b128 v[156:159], v189 offset:16384
    ds_read_b128 v[160:163], v189 offset:17408
    ds_read_b128 v[164:167], v189 offset:18432
    ds_read_b128 v[168:171], v189 offset:19456
    ds_read_b128 v[172:175], v189 offset:20480
    ds_read_b128 v[176:179], v189 offset:21504
    ds_read_b128 v[180:183], v189 offset:22528
    ds_read_b128 v[184:187], v189 offset:23552
    s_waitcnt lgkmcnt(0)
    v_add_f32 v124, v124, v156
    v_add_f32 v125, v125, v157
    v_add_f32 v126, v126, v158
    v_add_f32 v127, v127, v159
    v_add_f32 v128, v128, v160
    v_add_f32 v129, v129, v161
    v_add_f32 v130, v130, v162
    v_add_f32 v131, v131, v163
    v_add_f32 v132, v132, v164
    v_add_f32 v133, v133, v165
    v_add_f32 v134, v134, v166
    v_add_f32 v135, v135, v167
    v_add_f32 v136, v136, v168
    v_add_f32 v137, v137, v169
    v_add_f32 v138, v138, v170
    v_add_f32 v139, v139, v171
    v_add_f32 v140, v140, v172
    v_add_f32 v141, v141, v173
    v_add_f32 v142, v142, v174
    v_add_f32 v143, v143, v175
    v_add_f32 v144, v144, v176
    v_add_f32 v145, v145, v177
    v_add_f32 v146, v146, v178
    v_add_f32 v147, v147, v179
    v_add_f32 v148, v148, v180
    v_add_f32 v149, v149, v181
    v_add_f32 v150, v150, v182
    v_add_f32 v151, v151, v183
    v_add_f32 v152, v152, v184
    v_add_f32 v153, v153, v185
    v_add_f32 v154, v154, v186
    v_add_f32 v155, v155, v187
    ds_read_b128 v[156:159], v189 offset:24576
    ds_read_b128 v[160:163], v189 offset:25600
    ds_read_b128 v[164:167], v189 offset:26624
    ds_read_b128 v[168:171], v189 offset:27648
    ds_read_b128 v[172:175], v189 offset:28672
    ds_read_b128 v[176:179], v189 offset:29696
    ds_read_b128 v[180:183], v189 offset:30720
    ds_read_b128 v[184:187], v189 offset:31744
    s_waitcnt lgkmcnt(0)
    v_add_f32 v124, v124, v156
    v_add_f32 v125, v125, v157
    v_add_f32 v126, v126, v158
    v_add_f32 v127, v127, v159
    v_add_f32 v128, v128, v160
    v_add_f32 v129, v129, v161
    v_add_f32 v130, v130, v162
    v_add_f32 v131, v131, v163
    v_add_f32 v132, v132, v164
    v_add_f32 v133, v133, v165
    v_add_f32 v134, v134, v166
    v_add_f32 v135, v135, v167
    v_add_f32 v136, v136, v168
    v_add_f32 v137, v137, v169
    v_add_f32 v138, v138, v170
    v_add_f32 v139, v139, v171
    v_add_f32 v140, v140, v172
    v_add_f32 v141, v141, v173
    v_add_f32 v142, v142, v174
    v_add_f32 v143, v143, v175
    v_add_f32 v144, v144, v176
    v_add_f32 v145, v145, v177
    v_add_f32 v146, v146, v178
    v_add_f32 v147, v147, v179
    v_add_f32 v148, v148, v180
    v_add_f32 v149, v149, v181
    v_add_f32 v150, v150, v182
    v_add_f32 v151, v151, v183
    v_add_f32 v152, v152, v184
    v_add_f32 v153, v153, v185
    v_add_f32 v154, v154, v186
    v_add_f32 v155, v155, v187
    v_cvt_pk_bf16_f32 v76, v124, v125
    v_cvt_pk_bf16_f32 v77, v126, v127
    v_cvt_pk_bf16_f32 v78, v128, v129
    v_cvt_pk_bf16_f32 v79, v130, v131
    v_cvt_pk_bf16_f32 v80, v132, v133
    v_cvt_pk_bf16_f32 v81, v134, v135
    v_cvt_pk_bf16_f32 v82, v136, v137
    v_cvt_pk_bf16_f32 v83, v138, v139
    v_cvt_pk_bf16_f32 v84, v140, v141
    v_cvt_pk_bf16_f32 v85, v142, v143
    v_cvt_pk_bf16_f32 v86, v144, v145
    v_cvt_pk_bf16_f32 v87, v146, v147
    v_cvt_pk_bf16_f32 v88, v148, v149
    v_cvt_pk_bf16_f32 v89, v150, v151
    v_cvt_pk_bf16_f32 v90, v152, v153
    v_cvt_pk_bf16_f32 v91, v154, v155
    v_cndmask_b32 v36, 0, v36, s[26:27]
    s_nop 1
    v_mfma_f32_32x32x16_bf16 v[40:55], v[8:11], v[32:35], 0
    v_mfma_f32_32x32x16_bf16 v[40:55], v[12:15], v[36:39], v[40:55]
    s_nop 7
    s_nop 3
    v_cndmask_b32 v56, v40, v48, s[26:27]
    v_cndmask_b32 v57, v40, v49, s[26:27]
    v_max3_f32 v1, v56, v57, v40
    v_min3_f32 v2, v56, v57, v40
    v_max3_f32 v1, v1, v41, v42
    v_min3_f32 v2, v2, v41, v42
    v_max3_f32 v1, v1, v43, v44
    v_min3_f32 v2, v2, v43, v44
    v_max3_f32 v1, v1, v45, v46
    v_min3_f32 v2, v2, v45, v46
    v_max_f32 v1, v1, v47
    v_min_f32 v2, v2, v47
    v_mov_b32 v56, v1
    v_mov_b32 v57, v2
    s_nop 1
    v_permlane32_swap_b32 v1, v56
    v_permlane32_swap_b32 v2, v57
    v_max_f32 v1, v1, v56
    v_min_f32 v2, v2, v57
    s_mov_b32 s44, 0x3fb8aa3b
    v_sub_f32 v56, v40, v1
    v_sub_f32 v66, v2, v40
    v_mul_f32 v56, s44, v56
    v_mul_f32 v66, s44, v66
    v_exp_f32 v56, v56
    v_exp_f32 v66, v66
    v_sub_f32 v57, v41, v1
    v_sub_f32 v67, v2, v41
    v_mul_f32 v57, s44, v57
    v_mul_f32 v67, s44, v67
    v_exp_f32 v57, v57
    v_exp_f32 v67, v67
    v_sub_f32 v58, v42, v1
    v_sub_f32 v68, v2, v42
    v_mul_f32 v58, s44, v58
    v_mul_f32 v68, s44, v68
    v_exp_f32 v58, v58
    v_exp_f32 v68, v68
    v_sub_f32 v59, v43, v1
    v_sub_f32 v69, v2, v43
    v_mul_f32 v59, s44, v59
    v_mul_f32 v69, s44, v69
    v_exp_f32 v59, v59
    v_exp_f32 v69, v69
    v_sub_f32 v60, v44, v1
    v_sub_f32 v70, v2, v44
    v_mul_f32 v60, s44, v60
    v_mul_f32 v70, s44, v70
    v_exp_f32 v60, v60
    v_exp_f32 v70, v70
    v_sub_f32 v61, v45, v1
    v_sub_f32 v71, v2, v45
    v_mul_f32 v61, s44, v61
    v_mul_f32 v71, s44, v71
    v_exp_f32 v61, v61
    v_exp_f32 v71, v71
    v_sub_f32 v62, v46, v1
    v_sub_f32 v72, v2, v46
    v_mul_f32 v62, s44, v62
    v_mul_f32 v72, s44, v72
    v_exp_f32 v62, v62
    v_exp_f32 v72, v72
    v_sub_f32 v63, v47, v1
    v_sub_f32 v73, v2, v47
    v_mul_f32 v63, s44, v63
    v_mul_f32 v73, s44, v73
    v_exp_f32 v63, v63
    v_exp_f32 v73, v73
    v_sub_f32 v64, v48, v1
    v_sub_f32 v74, v2, v48
    v_mul_f32 v64, s44, v64
    v_mul_f32 v74, s44, v74
    v_exp_f32 v64, v64
    v_exp_f32 v74, v74
    v_sub_f32 v65, v49, v1
    v_sub_f32 v75, v2, v49
    v_mul_f32 v65, s44, v65
    v_mul_f32 v75, s44, v75
    v_exp_f32 v65, v65
    v_exp_f32 v75, v75
    s_nop 0
    v_cndmask_b32 v64, 0, v64, s[26:27]
    v_cndmask_b32 v74, 0, v74, s[26:27]
    v_cndmask_b32 v65, 0, v65, s[26:27]
    v_cndmask_b32 v75, 0, v75, s[26:27]
    v_add_f32 v1, v56, v57
    v_add_f32 v2, v66, v67
    v_add_f32 v1, v1, v58
    v_add_f32 v2, v2, v68
    v_add_f32 v1, v1, v59
    v_add_f32 v2, v2, v69
    v_add_f32 v1, v1, v60
    v_add_f32 v2, v2, v70
    v_add_f32 v1, v1, v61
    v_add_f32 v2, v2, v71
    v_add_f32 v1, v1, v62
    v_add_f32 v2, v2, v72
    v_add_f32 v1, v1, v63
    v_add_f32 v2, v2, v73
    v_add_f32 v1, v1, v64
    v_add_f32 v2, v2, v74
    v_add_f32 v1, v1, v65
    v_add_f32 v2, v2, v75
    v_mov_b32 v3, v1
    v_mov_b32 v40, v2
    s_nop 1
    v_permlane32_swap_b32 v1, v3
    v_permlane32_swap_b32 v2, v40
    v_add_f32 v1, v1, v3
    v_add_f32 v2, v2, v40
    v_rcp_f32 v1, v1
    v_rcp_f32 v2, v2
    s_nop 0
    v_mul_f32 v56, v56, v1
    v_mul_f32 v66, v66, v2
    v_mul_f32 v57, v57, v1
    v_mul_f32 v67, v67, v2
    v_mul_f32 v58, v58, v1
    v_mul_f32 v68, v68, v2
    v_mul_f32 v59, v59, v1
    v_mul_f32 v69, v69, v2
    v_mul_f32 v60, v60, v1
    v_mul_f32 v70, v70, v2
    v_mul_f32 v61, v61, v1
    v_mul_f32 v71, v71, v2
    v_mul_f32 v62, v62, v1
    v_mul_f32 v72, v72, v2
    v_mul_f32 v63, v63, v1
    v_mul_f32 v73, v73, v2
    v_mul_f32 v64, v64, v1
    v_mul_f32 v74, v74, v2
    v_mul_f32 v65, v65, v1
    v_mul_f32 v75, v75, v2
    v_cvt_pk_bf16_f32 v92, v56, v57
    v_cvt_pk_bf16_f32 v93, v58, v59
    v_cvt_pk_bf16_f32 v94, v60, v61
    v_cvt_pk_bf16_f32 v95, v62, v63
    v_cvt_pk_bf16_f32 v96, v64, v65
    v_mov_b32 v97, 0
    v_mov_b32 v98, 0
    v_mov_b32 v99, 0
    v_cvt_pk_bf16_f32 v100, v66, v67
    v_cvt_pk_bf16_f32 v101, v68, v69
    v_cvt_pk_bf16_f32 v102, v70, v71
    v_cvt_pk_bf16_f32 v103, v72, v73
    v_cvt_pk_bf16_f32 v104, v74, v75
    v_mov_b32 v105, 0
    v_mov_b32 v106, 0
    v_mov_b32 v107, 0
    s_waitcnt vmcnt(0)
    s_nop 1
    v_mfma_f32_32x32x16_bf16 v[108:123], v[76:79], v[92:95], 0
    v_mfma_f32_32x32x16_bf16 v[108:123], v[80:83], v[96:99], v[108:123]
    v_mfma_f32_32x32x16_bf16 v[108:123], v[84:87], v[100:103], v[108:123]
    v_mfma_f32_32x32x16_bf16 v[108:123], v[88:91], v[104:107], v[108:123]
    s_nop 7
    s_nop 7
    v_add_f32 v1, 0x358637bd, v118
    v_mov_b32 v2, v1
    s_nop 1
    v_permlane32_swap_b32 v1, v2
    v_rcp_f32 v1, v1
    s_nop 0
    v_mul_f32 v108, v108, v1
    v_mul_f32 v109, v109, v1
    v_mul_f32 v110, v110, v1
    v_mul_f32 v111, v111, v1
    v_mul_f32 v112, v112, v1
    v_mul_f32 v113, v113, v1
    v_mul_f32 v114, v114, v1
    v_mul_f32 v115, v115, v1
    v_mul_f32 v116, v116, v1
    v_mul_f32 v117, v117, v1
    v_cvt_pk_bf16_f32 v40, v108, v109
    v_cvt_pk_bf16_f32 v41, v110, v111
    v_cvt_pk_bf16_f32 v42, v112, v113
    v_cvt_pk_bf16_f32 v43, v114, v115
    v_cvt_pk_bf16_f32 v44, v116, v117
    buffer_store_dword v40, v5, s[28:31], 0 offen
    buffer_store_dword v41, v5, s[28:31], 0 offen offset:4
    buffer_store_dword v42, v5, s[28:31], 0 offen offset:16
    buffer_store_dword v43, v5, s[28:31], 0 offen offset:20
    s_mov_b64 exec, s[26:27]
    buffer_store_dword v44, v5, s[28:31], 0 offen offset:32
apply_kernel_done:
    s_endpgm
.globl attn_kernel
.p2align 8
.type attn_kernel,@function
attn_kernel:
    s_load_dwordx2 s[4:5], s[0:1], 72
    s_load_dwordx2 s[6:7], s[0:1], 72
    s_cmp_ge_u32 s2, 256
    s_cbranch_scc1 attn_kernel_done
    s_waitcnt lgkmcnt(0)
    s_add_u32 s4, s4, 0x240000
    s_addc_u32 s5, s5, 0
    s_add_u32 s6, s6, 0x900000
    s_addc_u32 s7, s7, 0
    s_mov_b32 s8, s4
    s_and_b32 s9, s5, 0xffff
    s_mov_b32 s10, 0x6c0000
    s_mov_b32 s11, 0x20000
    s_mov_b32 s12, s6
    s_and_b32 s13, s7, 0xffff
    s_mov_b32 s14, 0x240000
    s_mov_b32 s15, 0x20000
    s_lshr_b32 s16, s2, 3
    s_and_b32 s17, s2, 7
    s_mul_i32 s18, s16, 36
    v_lshrrev_b32 v1, 2, v0
    v_and_b32 v2, 3, v0
    v_mul_u32_u24 v5, 80, v1
    v_lshlrev_b32 v3, 2, v2
    v_add_u32 v5, v5, v3
    v_lshlrev_b32 v6, 6, v1
    v_add_u32 v6, v6, v3
    v_add_u32 v6, 10240, v6
    v_mov_b32 v9, 0
    v_mov_b32 v10, 0x3f80
    v_cmp_eq_u32 vcc, 0, v2
    s_nop 1
    v_cndmask_b32 v10, v9, v10, vcc
    ds_write_b32 v5, v9 offset:36
    ds_write_b32 v6, v10 offset:36
    ds_write_b32 v5, v9 offset:18468
    ds_write_b32 v6, v10 offset:18468
    v_min_u32 v3, 8, v3
    v_mul_u32_u24 v1, 80, v1
    v_add_u32 v1, v1, v3
    v_lshrrev_b32 v2, 2, v0
    v_lshlrev_b32 v2, 6, v2
    v_add_u32 v2, v2, v3
    ds_write_b32 v1, v9 offset:52
    ds_write_b32 v2, v9 offset:10292
    ds_write_b32 v1, v9 offset:18484
    ds_write_b32 v2, v9 offset:28724
    v_lshrrev_b32 v1, 2, v0
    v_mul_u32_u24 v4, 3456, v1
    v_and_b32 v2, 3, v0
    v_lshlrev_b32 v2, 2, v2
    v_add3_u32 v4, v4, v2, s18
    v_lshrrev_b32 v1, 6, v0
    v_lshlrev_b32 v1, 5, v1
    v_and_b32 v2, 31, v0
    s_lshl_b32 s19, s17, 8
    v_add3_u32 v1, v1, v2, s19
    v_mul_u32_u24 v3, 3456, v1
    v_bfe_u32 v2, v0, 5, 1
    v_lshlrev_b32 v2, 4, v2
    v_add3_u32 v3, v3, v2, s18
    buffer_load_dword v20, v3, s[8:11], 0 offen offset:0
    buffer_load_dword v21, v3, s[8:11], 0 offen offset:4
    buffer_load_dword v22, v3, s[8:11], 0 offen offset:8
    buffer_load_dword v23, v3, s[8:11], 0 offen offset:12
    buffer_load_dword v24, v3, s[8:11], 0 offen offset:32
    v_mov_b32 v25, 0
    v_mov_b32 v26, 0
    v_mov_b32 v27, 0
    v_mul_u32_u24 v204, 1152, v1
    v_add_u32 v204, s18, v204
    v_and_b32 v1, 31, v0
    v_mul_u32_u24 v7, 80, v1
    v_bfe_u32 v2, v0, 5, 1
    v_lshlrev_b32 v2, 4, v2
    v_add_u32 v7, v7, v2
    v_bfe_u32 v1, v0, 5, 1
    v_lshlrev_b32 v1, 2, v1
    v_bfe_u32 v2, v0, 2, 2
    v_add_u32 v1, v1, v2
    v_lshlrev_b32 v8, 6, v1
    v_bfe_u32 v1, v0, 4, 1
    v_lshlrev_b32 v1, 5, v1
    v_and_b32 v2, 3, v0
    v_lshlrev_b32 v2, 3, v2
    v_add3_u32 v8, v8, v1, v2
    v_add_u32 v8, 10240, v8
    v_mov_b32 v28, 0
    v_mov_b32 v29, 0
    v_mov_b32 v30, 0
    v_mov_b32 v31, 0
    v_mov_b32 v32, 0
    v_mov_b32 v33, 0
    v_mov_b32 v34, 0
    v_mov_b32 v35, 0
    v_mov_b32 v36, 0
    v_mov_b32 v37, 0
    v_mov_b32 v38, 0
    v_mov_b32 v39, 0
    v_mov_b32 v40, 0
    v_mov_b32 v41, 0
    v_mov_b32 v42, 0
    v_mov_b32 v43, 0
    v_mov_b32 v9, 0xff800000
    s_waitcnt vmcnt(0)
    v_cmp_gt_u32 vcc, 32, v0
    v_and_b32 v1, 63, v0
    v_cmp_gt_u32 vcc, 32, v1
    s_nop 1
    v_cndmask_b32 v24, 0, v24, vcc
    s_mov_b32 s20, 0x3eae1a93
    v_and_b32 v1, 3, v0
    v_lshlrev_b32 v1, 2, v1
    v_sub_u32 v205, v4, v1
    v_sub_u32 v206, v5, v1
    v_sub_u32 v207, v6, v1
    s_mov_b32 s21, 0x0
    buffer_load_dword v12, v4, s[8:11], s21 offen offset:1152
    buffer_load_dword v13, v4, s[8:11], s21 offen offset:1168
    buffer_load_dword v14, v205, s[8:11], s21 offen offset:1184
    buffer_load_dword v15, v4, s[8:11], s21 offen offset:2304
    buffer_load_dword v16, v4, s[8:11], s21 offen offset:2320
    buffer_load_dword v17, v205, s[8:11], s21 offen offset:2336
    s_waitcnt vmcnt(0)
    ds_write_b32 v5, v12 offset:0
    ds_write_b32 v5, v13 offset:16
    ds_write_b32 v206, v14 offset:32
    ds_write_b32 v6, v15 offset:0
    ds_write_b32 v6, v16 offset:16
    ds_write_b32 v207, v17 offset:32
    s_waitcnt lgkmcnt(0)
    s_barrier
    s_mov_b32 s21, 0x6c000
    buffer_load_dword v12, v4, s[8:11], s21 offen offset:1152
    buffer_load_dword v13, v4, s[8:11], s21 offen offset:1168
    buffer_load_dword v14, v205, s[8:11], s21 offen offset:1184
    buffer_load_dword v15, v4, s[8:11], s21 offen offset:2304
    buffer_load_dword v16, v4, s[8:11], s21 offen offset:2320
    buffer_load_dword v17, v205, s[8:11], s21 offen offset:2336
    ds_read_b128 v[140:143], v7 offset:0
    ds_read_b128 v[144:147], v7 offset:32
    ds_read_b128 v[148:151], v7 offset:2560
    ds_read_b128 v[152:155], v7 offset:2592
    ds_read_b128 v[156:159], v7 offset:5120
    ds_read_b128 v[160:163], v7 offset:5152
    ds_read_b128 v[164:167], v7 offset:7680
    ds_read_b128 v[168:171], v7 offset:7712
    s_waitcnt lgkmcnt(6)
    v_mfma_f32_32x32x16_bf16 v[44:59], v[140:143], v[20:23], 0
    v_mfma_f32_32x32x16_bf16 v[44:59], v[144:147], v[24:27], v[44:59]
    s_waitcnt lgkmcnt(4)
    v_mfma_f32_32x32x16_bf16 v[60:75], v[148:151], v[20:23], 0
    v_mfma_f32_32x32x16_bf16 v[60:75], v[152:155], v[24:27], v[60:75]
    s_waitcnt lgkmcnt(2)
    v_mfma_f32_32x32x16_bf16 v[76:91], v[156:159], v[20:23], 0
    v_mfma_f32_32x32x16_bf16 v[76:91], v[160:163], v[24:27], v[76:91]
    s_waitcnt lgkmcnt(0)
    v_mfma_f32_32x32x16_bf16 v[92:107], v[164:167], v[20:23], 0
    v_mfma_f32_32x32x16_bf16 v[92:107], v[168:171], v[24:27], v[92:107]
    ds_read_b64_tr_b16 v[172:173], v8 offset:0
    ds_read_b64_tr_b16 v[174:175], v8 offset:512
    ds_read_b64_tr_b16 v[176:177], v8 offset:1024
    ds_read_b64_tr_b16 v[178:179], v8 offset:1536
    ds_read_b64_tr_b16 v[180:181], v8 offset:2048
    ds_read_b64_tr_b16 v[182:183], v8 offset:2560
    ds_read_b64_tr_b16 v[184:185], v8 offset:3072
    ds_read_b64_tr_b16 v[186:187], v8 offset:3584
    ds_read_b64_tr_b16 v[188:189], v8 offset:4096
    ds_read_b64_tr_b16 v[190:191], v8 offset:4608
    ds_read_b64_tr_b16 v[192:193], v8 offset:5120
    ds_read_b64_tr_b16 v[194:195], v8 offset:5632
    ds_read_b64_tr_b16 v[196:197], v8 offset:6144
    ds_read_b64_tr_b16 v[198:199], v8 offset:6656
    ds_read_b64_tr_b16 v[200:201], v8 offset:7168
    ds_read_b64_tr_b16 v[202:203], v8 offset:7680
    s_nop 7
    s_nop 3
    v_max3_f32 v1, v44, v45, v46
    v_max3_f32 v1, v1, v47, v48
    v_max3_f32 v1, v1, v49, v50
    v_max3_f32 v1, v1, v51, v52
    v_max3_f32 v1, v1, v53, v54
    v_max3_f32 v1, v1, v55, v56
    v_max3_f32 v1, v1, v57, v58
    v_max3_f32 v1, v1, v59, v60
    v_max3_f32 v1, v1, v61, v62
    v_max3_f32 v1, v1, v63, v64
    v_max3_f32 v1, v1, v65, v66
    v_max3_f32 v1, v1, v67, v68
    v_max3_f32 v1, v1, v69, v70
    v_max3_f32 v1, v1, v71, v72
    v_max3_f32 v1, v1, v73, v74
    v_max3_f32 v1, v1, v75, v76
    v_max3_f32 v1, v1, v77, v78
    v_max3_f32 v1, v1, v79, v80
    v_max3_f32 v1, v1, v81, v82
    v_max3_f32 v1, v1, v83, v84
    v_max3_f32 v1, v1, v85, v86
    v_max3_f32 v1, v1, v87, v88
    v_max3_f32 v1, v1, v89, v90
    v_max3_f32 v1, v1, v91, v92
    v_max3_f32 v1, v1, v93, v94
    v_max3_f32 v1, v1, v95, v96
    v_max3_f32 v1, v1, v97, v98
    v_max3_f32 v1, v1, v99, v100
    v_max3_f32 v1, v1, v101, v102
    v_max3_f32 v1, v1, v103, v104
    v_max3_f32 v1, v1, v105, v106
    v_max_f32 v1, v1, v107
    v_mov_b32 v2, v1
    s_nop 1
    v_permlane32_swap_b32 v1, v2
    v_max3_f32 v1, v1, v2, v9
    v_sub_f32 v2, v9, v1
    v_mul_f32 v2, s20, v2
    v_exp_f32 v2, v2
    v_mov_b32 v9, v1
    v_mul_f32 v10, s20, v1
    v_mul_f32 v28, v28, v2
    v_mul_f32 v29, v29, v2
    v_mul_f32 v30, v30, v2
    v_mul_f32 v31, v31, v2
    v_mul_f32 v32, v32, v2
    v_mul_f32 v33, v33, v2
    v_mul_f32 v34, v34, v2
    v_mul_f32 v35, v35, v2
    v_mul_f32 v36, v36, v2
    v_mul_f32 v37, v37, v2
    v_mul_f32 v38, v38, v2
    v_mul_f32 v39, v39, v2
    v_mul_f32 v40, v40, v2
    v_mul_f32 v41, v41, v2
    v_mul_f32 v42, v42, v2
    v_mul_f32 v43, v43, v2
    s_waitcnt lgkmcnt(0)
    v_fma_f32 v44, v44, s20, -v10
    v_fma_f32 v45, v45, s20, -v10
    v_fma_f32 v46, v46, s20, -v10
    v_fma_f32 v47, v47, s20, -v10
    v_fma_f32 v48, v48, s20, -v10
    v_fma_f32 v49, v49, s20, -v10
    v_fma_f32 v50, v50, s20, -v10
    v_fma_f32 v51, v51, s20, -v10
    v_exp_f32 v44, v44
    v_exp_f32 v45, v45
    v_exp_f32 v46, v46
    v_exp_f32 v47, v47
    v_exp_f32 v48, v48
    v_exp_f32 v49, v49
    v_exp_f32 v50, v50
    v_exp_f32 v51, v51
    s_nop 0
    v_cvt_pk_bf16_f32 v108, v44, v45
    v_cvt_pk_bf16_f32 v109, v46, v47
    v_cvt_pk_bf16_f32 v110, v48, v49
    v_cvt_pk_bf16_f32 v111, v50, v51
    s_nop 1
    v_mfma_f32_32x32x16_bf16 v[28:43], v[172:175], v[108:111], v[28:43]
    v_fma_f32 v52, v52, s20, -v10
    v_fma_f32 v53, v53, s20, -v10
    v_fma_f32 v54, v54, s20, -v10
    v_fma_f32 v55, v55, s20, -v10
    v_fma_f32 v56, v56, s20, -v10
    v_fma_f32 v57, v57, s20, -v10
    v_fma_f32 v58, v58, s20, -v10
    v_fma_f32 v59, v59, s20, -v10
    v_exp_f32 v52, v52
    v_exp_f32 v53, v53
    v_exp_f32 v54, v54
    v_exp_f32 v55, v55
    v_exp_f32 v56, v56
    v_exp_f32 v57, v57
    v_exp_f32 v58, v58
    v_exp_f32 v59, v59
    s_nop 0
    v_cvt_pk_bf16_f32 v112, v52, v53
    v_cvt_pk_bf16_f32 v113, v54, v55
    v_cvt_pk_bf16_f32 v114, v56, v57
    v_cvt_pk_bf16_f32 v115, v58, v59
    s_nop 1
    v_mfma_f32_32x32x16_bf16 v[28:43], v[176:179], v[112:115], v[28:43]
    v_fma_f32 v60, v60, s20, -v10
    v_fma_f32 v61, v61, s20, -v10
    v_fma_f32 v62, v62, s20, -v10
    v_fma_f32 v63, v63, s20, -v10
    v_fma_f32 v64, v64, s20, -v10
    v_fma_f32 v65, v65, s20, -v10
    v_fma_f32 v66, v66, s20, -v10
    v_fma_f32 v67, v67, s20, -v10
    v_exp_f32 v60, v60
    v_exp_f32 v61, v61
    v_exp_f32 v62, v62
    v_exp_f32 v63, v63
    v_exp_f32 v64, v64
    v_exp_f32 v65, v65
    v_exp_f32 v66, v66
    v_exp_f32 v67, v67
    s_nop 0
    v_cvt_pk_bf16_f32 v116, v60, v61
    v_cvt_pk_bf16_f32 v117, v62, v63
    v_cvt_pk_bf16_f32 v118, v64, v65
    v_cvt_pk_bf16_f32 v119, v66, v67
    s_nop 1
    v_mfma_f32_32x32x16_bf16 v[28:43], v[180:183], v[116:119], v[28:43]
    v_fma_f32 v68, v68, s20, -v10
    v_fma_f32 v69, v69, s20, -v10
    v_fma_f32 v70, v70, s20, -v10
    v_fma_f32 v71, v71, s20, -v10
    v_fma_f32 v72, v72, s20, -v10
    v_fma_f32 v73, v73, s20, -v10
    v_fma_f32 v74, v74, s20, -v10
    v_fma_f32 v75, v75, s20, -v10
    v_exp_f32 v68, v68
    v_exp_f32 v69, v69
    v_exp_f32 v70, v70
    v_exp_f32 v71, v71
    v_exp_f32 v72, v72
    v_exp_f32 v73, v73
    v_exp_f32 v74, v74
    v_exp_f32 v75, v75
    s_nop 0
    v_cvt_pk_bf16_f32 v120, v68, v69
    v_cvt_pk_bf16_f32 v121, v70, v71
    v_cvt_pk_bf16_f32 v122, v72, v73
    v_cvt_pk_bf16_f32 v123, v74, v75
    s_nop 1
    v_mfma_f32_32x32x16_bf16 v[28:43], v[184:187], v[120:123], v[28:43]
    v_fma_f32 v76, v76, s20, -v10
    v_fma_f32 v77, v77, s20, -v10
    v_fma_f32 v78, v78, s20, -v10
    v_fma_f32 v79, v79, s20, -v10
    v_fma_f32 v80, v80, s20, -v10
    v_fma_f32 v81, v81, s20, -v10
    v_fma_f32 v82, v82, s20, -v10
    v_fma_f32 v83, v83, s20, -v10
    v_exp_f32 v76, v76
    v_exp_f32 v77, v77
    v_exp_f32 v78, v78
    v_exp_f32 v79, v79
    v_exp_f32 v80, v80
    v_exp_f32 v81, v81
    v_exp_f32 v82, v82
    v_exp_f32 v83, v83
    s_nop 0
    v_cvt_pk_bf16_f32 v124, v76, v77
    v_cvt_pk_bf16_f32 v125, v78, v79
    v_cvt_pk_bf16_f32 v126, v80, v81
    v_cvt_pk_bf16_f32 v127, v82, v83
    s_nop 1
    v_mfma_f32_32x32x16_bf16 v[28:43], v[188:191], v[124:127], v[28:43]
    v_fma_f32 v84, v84, s20, -v10
    v_fma_f32 v85, v85, s20, -v10
    v_fma_f32 v86, v86, s20, -v10
    v_fma_f32 v87, v87, s20, -v10
    v_fma_f32 v88, v88, s20, -v10
    v_fma_f32 v89, v89, s20, -v10
    v_fma_f32 v90, v90, s20, -v10
    v_fma_f32 v91, v91, s20, -v10
    v_exp_f32 v84, v84
    v_exp_f32 v85, v85
    v_exp_f32 v86, v86
    v_exp_f32 v87, v87
    v_exp_f32 v88, v88
    v_exp_f32 v89, v89
    v_exp_f32 v90, v90
    v_exp_f32 v91, v91
    s_nop 0
    v_cvt_pk_bf16_f32 v128, v84, v85
    v_cvt_pk_bf16_f32 v129, v86, v87
    v_cvt_pk_bf16_f32 v130, v88, v89
    v_cvt_pk_bf16_f32 v131, v90, v91
    s_nop 1
    v_mfma_f32_32x32x16_bf16 v[28:43], v[192:195], v[128:131], v[28:43]
    v_fma_f32 v92, v92, s20, -v10
    v_fma_f32 v93, v93, s20, -v10
    v_fma_f32 v94, v94, s20, -v10
    v_fma_f32 v95, v95, s20, -v10
    v_fma_f32 v96, v96, s20, -v10
    v_fma_f32 v97, v97, s20, -v10
    v_fma_f32 v98, v98, s20, -v10
    v_fma_f32 v99, v99, s20, -v10
    v_exp_f32 v92, v92
    v_exp_f32 v93, v93
    v_exp_f32 v94, v94
    v_exp_f32 v95, v95
    v_exp_f32 v96, v96
    v_exp_f32 v97, v97
    v_exp_f32 v98, v98
    v_exp_f32 v99, v99
    s_nop 0
    v_cvt_pk_bf16_f32 v132, v92, v93
    v_cvt_pk_bf16_f32 v133, v94, v95
    v_cvt_pk_bf16_f32 v134, v96, v97
    v_cvt_pk_bf16_f32 v135, v98, v99
    s_nop 1
    v_mfma_f32_32x32x16_bf16 v[28:43], v[196:199], v[132:135], v[28:43]
    v_fma_f32 v100, v100, s20, -v10
    v_fma_f32 v101, v101, s20, -v10
    v_fma_f32 v102, v102, s20, -v10
    v_fma_f32 v103, v103, s20, -v10
    v_fma_f32 v104, v104, s20, -v10
    v_fma_f32 v105, v105, s20, -v10
    v_fma_f32 v106, v106, s20, -v10
    v_fma_f32 v107, v107, s20, -v10
    v_exp_f32 v100, v100
    v_exp_f32 v101, v101
    v_exp_f32 v102, v102
    v_exp_f32 v103, v103
    v_exp_f32 v104, v104
    v_exp_f32 v105, v105
    v_exp_f32 v106, v106
    v_exp_f32 v107, v107
    s_nop 0
    v_cvt_pk_bf16_f32 v136, v100, v101
    v_cvt_pk_bf16_f32 v137, v102, v103
    v_cvt_pk_bf16_f32 v138, v104, v105
    v_cvt_pk_bf16_f32 v139, v106, v107
    s_nop 1
    v_mfma_f32_32x32x16_bf16 v[28:43], v[200:203], v[136:139], v[28:43]
    s_waitcnt vmcnt(0)
    ds_write_b32 v5, v12 offset:18432
    ds_write_b32 v5, v13 offset:18448
    ds_write_b32 v206, v14 offset:18464
    ds_write_b32 v6, v15 offset:18432
    ds_write_b32 v6, v16 offset:18448
    ds_write_b32 v207, v17 offset:18464
    s_waitcnt lgkmcnt(0)
    s_barrier
    s_mov_b32 s21, 0xd8000
    buffer_load_dword v12, v4, s[8:11], s21 offen offset:1152
    buffer_load_dword v13, v4, s[8:11], s21 offen offset:1168
    buffer_load_dword v14, v205, s[8:11], s21 offen offset:1184
    buffer_load_dword v15, v4, s[8:11], s21 offen offset:2304
    buffer_load_dword v16, v4, s[8:11], s21 offen offset:2320
    buffer_load_dword v17, v205, s[8:11], s21 offen offset:2336
    ds_read_b128 v[140:143], v7 offset:18432
    ds_read_b128 v[144:147], v7 offset:18464
    ds_read_b128 v[148:151], v7 offset:20992
    ds_read_b128 v[152:155], v7 offset:21024
    ds_read_b128 v[156:159], v7 offset:23552
    ds_read_b128 v[160:163], v7 offset:23584
    ds_read_b128 v[164:167], v7 offset:26112
    ds_read_b128 v[168:171], v7 offset:26144
    s_waitcnt lgkmcnt(6)
    v_mfma_f32_32x32x16_bf16 v[44:59], v[140:143], v[20:23], 0
    v_mfma_f32_32x32x16_bf16 v[44:59], v[144:147], v[24:27], v[44:59]
    s_waitcnt lgkmcnt(4)
    v_mfma_f32_32x32x16_bf16 v[60:75], v[148:151], v[20:23], 0
    v_mfma_f32_32x32x16_bf16 v[60:75], v[152:155], v[24:27], v[60:75]
    s_waitcnt lgkmcnt(2)
    v_mfma_f32_32x32x16_bf16 v[76:91], v[156:159], v[20:23], 0
    v_mfma_f32_32x32x16_bf16 v[76:91], v[160:163], v[24:27], v[76:91]
    s_waitcnt lgkmcnt(0)
    v_mfma_f32_32x32x16_bf16 v[92:107], v[164:167], v[20:23], 0
    v_mfma_f32_32x32x16_bf16 v[92:107], v[168:171], v[24:27], v[92:107]
    ds_read_b64_tr_b16 v[172:173], v8 offset:18432
    ds_read_b64_tr_b16 v[174:175], v8 offset:18944
    ds_read_b64_tr_b16 v[176:177], v8 offset:19456
    ds_read_b64_tr_b16 v[178:179], v8 offset:19968
    ds_read_b64_tr_b16 v[180:181], v8 offset:20480
    ds_read_b64_tr_b16 v[182:183], v8 offset:20992
    ds_read_b64_tr_b16 v[184:185], v8 offset:21504
    ds_read_b64_tr_b16 v[186:187], v8 offset:22016
    ds_read_b64_tr_b16 v[188:189], v8 offset:22528
    ds_read_b64_tr_b16 v[190:191], v8 offset:23040
    ds_read_b64_tr_b16 v[192:193], v8 offset:23552
    ds_read_b64_tr_b16 v[194:195], v8 offset:24064
    ds_read_b64_tr_b16 v[196:197], v8 offset:24576
    ds_read_b64_tr_b16 v[198:199], v8 offset:25088
    ds_read_b64_tr_b16 v[200:201], v8 offset:25600
    ds_read_b64_tr_b16 v[202:203], v8 offset:26112
    s_nop 7
    s_nop 3
    v_max3_f32 v1, v44, v45, v46
    v_max3_f32 v1, v1, v47, v48
    v_max3_f32 v1, v1, v49, v50
    v_max3_f32 v1, v1, v51, v52
    v_max3_f32 v1, v1, v53, v54
    v_max3_f32 v1, v1, v55, v56
    v_max3_f32 v1, v1, v57, v58
    v_max3_f32 v1, v1, v59, v60
    v_max3_f32 v1, v1, v61, v62
    v_max3_f32 v1, v1, v63, v64
    v_max3_f32 v1, v1, v65, v66
    v_max3_f32 v1, v1, v67, v68
    v_max3_f32 v1, v1, v69, v70
    v_max3_f32 v1, v1, v71, v72
    v_max3_f32 v1, v1, v73, v74
    v_max3_f32 v1, v1, v75, v76
    v_max3_f32 v1, v1, v77, v78
    v_max3_f32 v1, v1, v79, v80
    v_max3_f32 v1, v1, v81, v82
    v_max3_f32 v1, v1, v83, v84
    v_max3_f32 v1, v1, v85, v86
    v_max3_f32 v1, v1, v87, v88
    v_max3_f32 v1, v1, v89, v90
    v_max3_f32 v1, v1, v91, v92
    v_max3_f32 v1, v1, v93, v94
    v_max3_f32 v1, v1, v95, v96
    v_max3_f32 v1, v1, v97, v98
    v_max3_f32 v1, v1, v99, v100
    v_max3_f32 v1, v1, v101, v102
    v_max3_f32 v1, v1, v103, v104
    v_max3_f32 v1, v1, v105, v106
    v_max_f32 v1, v1, v107
    v_mov_b32 v2, v1
    s_nop 1
    v_permlane32_swap_b32 v1, v2
    v_max3_f32 v1, v1, v2, v9
    v_sub_f32 v2, v9, v1
    v_mul_f32 v2, s20, v2
    v_exp_f32 v2, v2
    v_mov_b32 v9, v1
    v_mul_f32 v10, s20, v1
    v_mul_f32 v28, v28, v2
    v_mul_f32 v29, v29, v2
    v_mul_f32 v30, v30, v2
    v_mul_f32 v31, v31, v2
    v_mul_f32 v32, v32, v2
    v_mul_f32 v33, v33, v2
    v_mul_f32 v34, v34, v2
    v_mul_f32 v35, v35, v2
    v_mul_f32 v36, v36, v2
    v_mul_f32 v37, v37, v2
    v_mul_f32 v38, v38, v2
    v_mul_f32 v39, v39, v2
    v_mul_f32 v40, v40, v2
    v_mul_f32 v41, v41, v2
    v_mul_f32 v42, v42, v2
    v_mul_f32 v43, v43, v2
    s_waitcnt lgkmcnt(0)
    v_fma_f32 v44, v44, s20, -v10
    v_fma_f32 v45, v45, s20, -v10
    v_fma_f32 v46, v46, s20, -v10
    v_fma_f32 v47, v47, s20, -v10
    v_fma_f32 v48, v48, s20, -v10
    v_fma_f32 v49, v49, s20, -v10
    v_fma_f32 v50, v50, s20, -v10
    v_fma_f32 v51, v51, s20, -v10
    v_exp_f32 v44, v44
    v_exp_f32 v45, v45
    v_exp_f32 v46, v46
    v_exp_f32 v47, v47
    v_exp_f32 v48, v48
    v_exp_f32 v49, v49
    v_exp_f32 v50, v50
    v_exp_f32 v51, v51
    s_nop 0
    v_cvt_pk_bf16_f32 v108, v44, v45
    v_cvt_pk_bf16_f32 v109, v46, v47
    v_cvt_pk_bf16_f32 v110, v48, v49
    v_cvt_pk_bf16_f32 v111, v50, v51
    s_nop 1
    v_mfma_f32_32x32x16_bf16 v[28:43], v[172:175], v[108:111], v[28:43]
    v_fma_f32 v52, v52, s20, -v10
    v_fma_f32 v53, v53, s20, -v10
    v_fma_f32 v54, v54, s20, -v10
    v_fma_f32 v55, v55, s20, -v10
    v_fma_f32 v56, v56, s20, -v10
    v_fma_f32 v57, v57, s20, -v10
    v_fma_f32 v58, v58, s20, -v10
    v_fma_f32 v59, v59, s20, -v10
    v_exp_f32 v52, v52
    v_exp_f32 v53, v53
    v_exp_f32 v54, v54
    v_exp_f32 v55, v55
    v_exp_f32 v56, v56
    v_exp_f32 v57, v57
    v_exp_f32 v58, v58
    v_exp_f32 v59, v59
    s_nop 0
    v_cvt_pk_bf16_f32 v112, v52, v53
    v_cvt_pk_bf16_f32 v113, v54, v55
    v_cvt_pk_bf16_f32 v114, v56, v57
    v_cvt_pk_bf16_f32 v115, v58, v59
    s_nop 1
    v_mfma_f32_32x32x16_bf16 v[28:43], v[176:179], v[112:115], v[28:43]
    v_fma_f32 v60, v60, s20, -v10
    v_fma_f32 v61, v61, s20, -v10
    v_fma_f32 v62, v62, s20, -v10
    v_fma_f32 v63, v63, s20, -v10
    v_fma_f32 v64, v64, s20, -v10
    v_fma_f32 v65, v65, s20, -v10
    v_fma_f32 v66, v66, s20, -v10
    v_fma_f32 v67, v67, s20, -v10
    v_exp_f32 v60, v60
    v_exp_f32 v61, v61
    v_exp_f32 v62, v62
    v_exp_f32 v63, v63
    v_exp_f32 v64, v64
    v_exp_f32 v65, v65
    v_exp_f32 v66, v66
    v_exp_f32 v67, v67
    s_nop 0
    v_cvt_pk_bf16_f32 v116, v60, v61
    v_cvt_pk_bf16_f32 v117, v62, v63
    v_cvt_pk_bf16_f32 v118, v64, v65
    v_cvt_pk_bf16_f32 v119, v66, v67
    s_nop 1
    v_mfma_f32_32x32x16_bf16 v[28:43], v[180:183], v[116:119], v[28:43]
    v_fma_f32 v68, v68, s20, -v10
    v_fma_f32 v69, v69, s20, -v10
    v_fma_f32 v70, v70, s20, -v10
    v_fma_f32 v71, v71, s20, -v10
    v_fma_f32 v72, v72, s20, -v10
    v_fma_f32 v73, v73, s20, -v10
    v_fma_f32 v74, v74, s20, -v10
    v_fma_f32 v75, v75, s20, -v10
    v_exp_f32 v68, v68
    v_exp_f32 v69, v69
    v_exp_f32 v70, v70
    v_exp_f32 v71, v71
    v_exp_f32 v72, v72
    v_exp_f32 v73, v73
    v_exp_f32 v74, v74
    v_exp_f32 v75, v75
    s_nop 0
    v_cvt_pk_bf16_f32 v120, v68, v69
    v_cvt_pk_bf16_f32 v121, v70, v71
    v_cvt_pk_bf16_f32 v122, v72, v73
    v_cvt_pk_bf16_f32 v123, v74, v75
    s_nop 1
    v_mfma_f32_32x32x16_bf16 v[28:43], v[184:187], v[120:123], v[28:43]
    v_fma_f32 v76, v76, s20, -v10
    v_fma_f32 v77, v77, s20, -v10
    v_fma_f32 v78, v78, s20, -v10
    v_fma_f32 v79, v79, s20, -v10
    v_fma_f32 v80, v80, s20, -v10
    v_fma_f32 v81, v81, s20, -v10
    v_fma_f32 v82, v82, s20, -v10
    v_fma_f32 v83, v83, s20, -v10
    v_exp_f32 v76, v76
    v_exp_f32 v77, v77
    v_exp_f32 v78, v78
    v_exp_f32 v79, v79
    v_exp_f32 v80, v80
    v_exp_f32 v81, v81
    v_exp_f32 v82, v82
    v_exp_f32 v83, v83
    s_nop 0
    v_cvt_pk_bf16_f32 v124, v76, v77
    v_cvt_pk_bf16_f32 v125, v78, v79
    v_cvt_pk_bf16_f32 v126, v80, v81
    v_cvt_pk_bf16_f32 v127, v82, v83
    s_nop 1
    v_mfma_f32_32x32x16_bf16 v[28:43], v[188:191], v[124:127], v[28:43]
    v_fma_f32 v84, v84, s20, -v10
    v_fma_f32 v85, v85, s20, -v10
    v_fma_f32 v86, v86, s20, -v10
    v_fma_f32 v87, v87, s20, -v10
    v_fma_f32 v88, v88, s20, -v10
    v_fma_f32 v89, v89, s20, -v10
    v_fma_f32 v90, v90, s20, -v10
    v_fma_f32 v91, v91, s20, -v10
    v_exp_f32 v84, v84
    v_exp_f32 v85, v85
    v_exp_f32 v86, v86
    v_exp_f32 v87, v87
    v_exp_f32 v88, v88
    v_exp_f32 v89, v89
    v_exp_f32 v90, v90
    v_exp_f32 v91, v91
    s_nop 0
    v_cvt_pk_bf16_f32 v128, v84, v85
    v_cvt_pk_bf16_f32 v129, v86, v87
    v_cvt_pk_bf16_f32 v130, v88, v89
    v_cvt_pk_bf16_f32 v131, v90, v91
    s_nop 1
    v_mfma_f32_32x32x16_bf16 v[28:43], v[192:195], v[128:131], v[28:43]
    v_fma_f32 v92, v92, s20, -v10
    v_fma_f32 v93, v93, s20, -v10
    v_fma_f32 v94, v94, s20, -v10
    v_fma_f32 v95, v95, s20, -v10
    v_fma_f32 v96, v96, s20, -v10
    v_fma_f32 v97, v97, s20, -v10
    v_fma_f32 v98, v98, s20, -v10
    v_fma_f32 v99, v99, s20, -v10
    v_exp_f32 v92, v92
    v_exp_f32 v93, v93
    v_exp_f32 v94, v94
    v_exp_f32 v95, v95
    v_exp_f32 v96, v96
    v_exp_f32 v97, v97
    v_exp_f32 v98, v98
    v_exp_f32 v99, v99
    s_nop 0
    v_cvt_pk_bf16_f32 v132, v92, v93
    v_cvt_pk_bf16_f32 v133, v94, v95
    v_cvt_pk_bf16_f32 v134, v96, v97
    v_cvt_pk_bf16_f32 v135, v98, v99
    s_nop 1
    v_mfma_f32_32x32x16_bf16 v[28:43], v[196:199], v[132:135], v[28:43]
    v_fma_f32 v100, v100, s20, -v10
    v_fma_f32 v101, v101, s20, -v10
    v_fma_f32 v102, v102, s20, -v10
    v_fma_f32 v103, v103, s20, -v10
    v_fma_f32 v104, v104, s20, -v10
    v_fma_f32 v105, v105, s20, -v10
    v_fma_f32 v106, v106, s20, -v10
    v_fma_f32 v107, v107, s20, -v10
    v_exp_f32 v100, v100
    v_exp_f32 v101, v101
    v_exp_f32 v102, v102
    v_exp_f32 v103, v103
    v_exp_f32 v104, v104
    v_exp_f32 v105, v105
    v_exp_f32 v106, v106
    v_exp_f32 v107, v107
    s_nop 0
    v_cvt_pk_bf16_f32 v136, v100, v101
    v_cvt_pk_bf16_f32 v137, v102, v103
    v_cvt_pk_bf16_f32 v138, v104, v105
    v_cvt_pk_bf16_f32 v139, v106, v107
    s_nop 1
    v_mfma_f32_32x32x16_bf16 v[28:43], v[200:203], v[136:139], v[28:43]
    s_waitcnt vmcnt(0)
    ds_write_b32 v5, v12 offset:0
    ds_write_b32 v5, v13 offset:16
    ds_write_b32 v206, v14 offset:32
    ds_write_b32 v6, v15 offset:0
    ds_write_b32 v6, v16 offset:16
    ds_write_b32 v207, v17 offset:32
    s_waitcnt lgkmcnt(0)
    s_barrier
    s_mov_b32 s21, 0x144000
    buffer_load_dword v12, v4, s[8:11], s21 offen offset:1152
    buffer_load_dword v13, v4, s[8:11], s21 offen offset:1168
    buffer_load_dword v14, v205, s[8:11], s21 offen offset:1184
    buffer_load_dword v15, v4, s[8:11], s21 offen offset:2304
    buffer_load_dword v16, v4, s[8:11], s21 offen offset:2320
    buffer_load_dword v17, v205, s[8:11], s21 offen offset:2336
    ds_read_b128 v[140:143], v7 offset:0
    ds_read_b128 v[144:147], v7 offset:32
    ds_read_b128 v[148:151], v7 offset:2560
    ds_read_b128 v[152:155], v7 offset:2592
    ds_read_b128 v[156:159], v7 offset:5120
    ds_read_b128 v[160:163], v7 offset:5152
    ds_read_b128 v[164:167], v7 offset:7680
    ds_read_b128 v[168:171], v7 offset:7712
    s_waitcnt lgkmcnt(6)
    v_mfma_f32_32x32x16_bf16 v[44:59], v[140:143], v[20:23], 0
    v_mfma_f32_32x32x16_bf16 v[44:59], v[144:147], v[24:27], v[44:59]
    s_waitcnt lgkmcnt(4)
    v_mfma_f32_32x32x16_bf16 v[60:75], v[148:151], v[20:23], 0
    v_mfma_f32_32x32x16_bf16 v[60:75], v[152:155], v[24:27], v[60:75]
    s_waitcnt lgkmcnt(2)
    v_mfma_f32_32x32x16_bf16 v[76:91], v[156:159], v[20:23], 0
    v_mfma_f32_32x32x16_bf16 v[76:91], v[160:163], v[24:27], v[76:91]
    s_waitcnt lgkmcnt(0)
    v_mfma_f32_32x32x16_bf16 v[92:107], v[164:167], v[20:23], 0
    v_mfma_f32_32x32x16_bf16 v[92:107], v[168:171], v[24:27], v[92:107]
    ds_read_b64_tr_b16 v[172:173], v8 offset:0
    ds_read_b64_tr_b16 v[174:175], v8 offset:512
    ds_read_b64_tr_b16 v[176:177], v8 offset:1024
    ds_read_b64_tr_b16 v[178:179], v8 offset:1536
    ds_read_b64_tr_b16 v[180:181], v8 offset:2048
    ds_read_b64_tr_b16 v[182:183], v8 offset:2560
    ds_read_b64_tr_b16 v[184:185], v8 offset:3072
    ds_read_b64_tr_b16 v[186:187], v8 offset:3584
    ds_read_b64_tr_b16 v[188:189], v8 offset:4096
    ds_read_b64_tr_b16 v[190:191], v8 offset:4608
    ds_read_b64_tr_b16 v[192:193], v8 offset:5120
    ds_read_b64_tr_b16 v[194:195], v8 offset:5632
    ds_read_b64_tr_b16 v[196:197], v8 offset:6144
    ds_read_b64_tr_b16 v[198:199], v8 offset:6656
    ds_read_b64_tr_b16 v[200:201], v8 offset:7168
    ds_read_b64_tr_b16 v[202:203], v8 offset:7680
    s_nop 7
    s_nop 3
    v_max3_f32 v1, v44, v45, v46
    v_max3_f32 v1, v1, v47, v48
    v_max3_f32 v1, v1, v49, v50
    v_max3_f32 v1, v1, v51, v52
    v_max3_f32 v1, v1, v53, v54
    v_max3_f32 v1, v1, v55, v56
    v_max3_f32 v1, v1, v57, v58
    v_max3_f32 v1, v1, v59, v60
    v_max3_f32 v1, v1, v61, v62
    v_max3_f32 v1, v1, v63, v64
    v_max3_f32 v1, v1, v65, v66
    v_max3_f32 v1, v1, v67, v68
    v_max3_f32 v1, v1, v69, v70
    v_max3_f32 v1, v1, v71, v72
    v_max3_f32 v1, v1, v73, v74
    v_max3_f32 v1, v1, v75, v76
    v_max3_f32 v1, v1, v77, v78
    v_max3_f32 v1, v1, v79, v80
    v_max3_f32 v1, v1, v81, v82
    v_max3_f32 v1, v1, v83, v84
    v_max3_f32 v1, v1, v85, v86
    v_max3_f32 v1, v1, v87, v88
    v_max3_f32 v1, v1, v89, v90
    v_max3_f32 v1, v1, v91, v92
    v_max3_f32 v1, v1, v93, v94
    v_max3_f32 v1, v1, v95, v96
    v_max3_f32 v1, v1, v97, v98
    v_max3_f32 v1, v1, v99, v100
    v_max3_f32 v1, v1, v101, v102
    v_max3_f32 v1, v1, v103, v104
    v_max3_f32 v1, v1, v105, v106
    v_max_f32 v1, v1, v107
    v_mov_b32 v2, v1
    s_nop 1
    v_permlane32_swap_b32 v1, v2
    v_max3_f32 v1, v1, v2, v9
    v_sub_f32 v2, v9, v1
    v_mul_f32 v2, s20, v2
    v_exp_f32 v2, v2
    v_mov_b32 v9, v1
    v_mul_f32 v10, s20, v1
    v_mul_f32 v28, v28, v2
    v_mul_f32 v29, v29, v2
    v_mul_f32 v30, v30, v2
    v_mul_f32 v31, v31, v2
    v_mul_f32 v32, v32, v2
    v_mul_f32 v33, v33, v2
    v_mul_f32 v34, v34, v2
    v_mul_f32 v35, v35, v2
    v_mul_f32 v36, v36, v2
    v_mul_f32 v37, v37, v2
    v_mul_f32 v38, v38, v2
    v_mul_f32 v39, v39, v2
    v_mul_f32 v40, v40, v2
    v_mul_f32 v41, v41, v2
    v_mul_f32 v42, v42, v2
    v_mul_f32 v43, v43, v2
    s_waitcnt lgkmcnt(0)
    v_fma_f32 v44, v44, s20, -v10
    v_fma_f32 v45, v45, s20, -v10
    v_fma_f32 v46, v46, s20, -v10
    v_fma_f32 v47, v47, s20, -v10
    v_fma_f32 v48, v48, s20, -v10
    v_fma_f32 v49, v49, s20, -v10
    v_fma_f32 v50, v50, s20, -v10
    v_fma_f32 v51, v51, s20, -v10
    v_exp_f32 v44, v44
    v_exp_f32 v45, v45
    v_exp_f32 v46, v46
    v_exp_f32 v47, v47
    v_exp_f32 v48, v48
    v_exp_f32 v49, v49
    v_exp_f32 v50, v50
    v_exp_f32 v51, v51
    s_nop 0
    v_cvt_pk_bf16_f32 v108, v44, v45
    v_cvt_pk_bf16_f32 v109, v46, v47
    v_cvt_pk_bf16_f32 v110, v48, v49
    v_cvt_pk_bf16_f32 v111, v50, v51
    s_nop 1
    v_mfma_f32_32x32x16_bf16 v[28:43], v[172:175], v[108:111], v[28:43]
    v_fma_f32 v52, v52, s20, -v10
    v_fma_f32 v53, v53, s20, -v10
    v_fma_f32 v54, v54, s20, -v10
    v_fma_f32 v55, v55, s20, -v10
    v_fma_f32 v56, v56, s20, -v10
    v_fma_f32 v57, v57, s20, -v10
    v_fma_f32 v58, v58, s20, -v10
    v_fma_f32 v59, v59, s20, -v10
    v_exp_f32 v52, v52
    v_exp_f32 v53, v53
    v_exp_f32 v54, v54
    v_exp_f32 v55, v55
    v_exp_f32 v56, v56
    v_exp_f32 v57, v57
    v_exp_f32 v58, v58
    v_exp_f32 v59, v59
    s_nop 0
    v_cvt_pk_bf16_f32 v112, v52, v53
    v_cvt_pk_bf16_f32 v113, v54, v55
    v_cvt_pk_bf16_f32 v114, v56, v57
    v_cvt_pk_bf16_f32 v115, v58, v59
    s_nop 1
    v_mfma_f32_32x32x16_bf16 v[28:43], v[176:179], v[112:115], v[28:43]
    v_fma_f32 v60, v60, s20, -v10
    v_fma_f32 v61, v61, s20, -v10
    v_fma_f32 v62, v62, s20, -v10
    v_fma_f32 v63, v63, s20, -v10
    v_fma_f32 v64, v64, s20, -v10
    v_fma_f32 v65, v65, s20, -v10
    v_fma_f32 v66, v66, s20, -v10
    v_fma_f32 v67, v67, s20, -v10
    v_exp_f32 v60, v60
    v_exp_f32 v61, v61
    v_exp_f32 v62, v62
    v_exp_f32 v63, v63
    v_exp_f32 v64, v64
    v_exp_f32 v65, v65
    v_exp_f32 v66, v66
    v_exp_f32 v67, v67
    s_nop 0
    v_cvt_pk_bf16_f32 v116, v60, v61
    v_cvt_pk_bf16_f32 v117, v62, v63
    v_cvt_pk_bf16_f32 v118, v64, v65
    v_cvt_pk_bf16_f32 v119, v66, v67
    s_nop 1
    v_mfma_f32_32x32x16_bf16 v[28:43], v[180:183], v[116:119], v[28:43]
    v_fma_f32 v68, v68, s20, -v10
    v_fma_f32 v69, v69, s20, -v10
    v_fma_f32 v70, v70, s20, -v10
    v_fma_f32 v71, v71, s20, -v10
    v_fma_f32 v72, v72, s20, -v10
    v_fma_f32 v73, v73, s20, -v10
    v_fma_f32 v74, v74, s20, -v10
    v_fma_f32 v75, v75, s20, -v10
    v_exp_f32 v68, v68
    v_exp_f32 v69, v69
    v_exp_f32 v70, v70
    v_exp_f32 v71, v71
    v_exp_f32 v72, v72
    v_exp_f32 v73, v73
    v_exp_f32 v74, v74
    v_exp_f32 v75, v75
    s_nop 0
    v_cvt_pk_bf16_f32 v120, v68, v69
    v_cvt_pk_bf16_f32 v121, v70, v71
    v_cvt_pk_bf16_f32 v122, v72, v73
    v_cvt_pk_bf16_f32 v123, v74, v75
    s_nop 1
    v_mfma_f32_32x32x16_bf16 v[28:43], v[184:187], v[120:123], v[28:43]
    v_fma_f32 v76, v76, s20, -v10
    v_fma_f32 v77, v77, s20, -v10
    v_fma_f32 v78, v78, s20, -v10
    v_fma_f32 v79, v79, s20, -v10
    v_fma_f32 v80, v80, s20, -v10
    v_fma_f32 v81, v81, s20, -v10
    v_fma_f32 v82, v82, s20, -v10
    v_fma_f32 v83, v83, s20, -v10
    v_exp_f32 v76, v76
    v_exp_f32 v77, v77
    v_exp_f32 v78, v78
    v_exp_f32 v79, v79
    v_exp_f32 v80, v80
    v_exp_f32 v81, v81
    v_exp_f32 v82, v82
    v_exp_f32 v83, v83
    s_nop 0
    v_cvt_pk_bf16_f32 v124, v76, v77
    v_cvt_pk_bf16_f32 v125, v78, v79
    v_cvt_pk_bf16_f32 v126, v80, v81
    v_cvt_pk_bf16_f32 v127, v82, v83
    s_nop 1
    v_mfma_f32_32x32x16_bf16 v[28:43], v[188:191], v[124:127], v[28:43]
    v_fma_f32 v84, v84, s20, -v10
    v_fma_f32 v85, v85, s20, -v10
    v_fma_f32 v86, v86, s20, -v10
    v_fma_f32 v87, v87, s20, -v10
    v_fma_f32 v88, v88, s20, -v10
    v_fma_f32 v89, v89, s20, -v10
    v_fma_f32 v90, v90, s20, -v10
    v_fma_f32 v91, v91, s20, -v10
    v_exp_f32 v84, v84
    v_exp_f32 v85, v85
    v_exp_f32 v86, v86
    v_exp_f32 v87, v87
    v_exp_f32 v88, v88
    v_exp_f32 v89, v89
    v_exp_f32 v90, v90
    v_exp_f32 v91, v91
    s_nop 0
    v_cvt_pk_bf16_f32 v128, v84, v85
    v_cvt_pk_bf16_f32 v129, v86, v87
    v_cvt_pk_bf16_f32 v130, v88, v89
    v_cvt_pk_bf16_f32 v131, v90, v91
    s_nop 1
    v_mfma_f32_32x32x16_bf16 v[28:43], v[192:195], v[128:131], v[28:43]
    v_fma_f32 v92, v92, s20, -v10
    v_fma_f32 v93, v93, s20, -v10
    v_fma_f32 v94, v94, s20, -v10
    v_fma_f32 v95, v95, s20, -v10
    v_fma_f32 v96, v96, s20, -v10
    v_fma_f32 v97, v97, s20, -v10
    v_fma_f32 v98, v98, s20, -v10
    v_fma_f32 v99, v99, s20, -v10
    v_exp_f32 v92, v92
    v_exp_f32 v93, v93
    v_exp_f32 v94, v94
    v_exp_f32 v95, v95
    v_exp_f32 v96, v96
    v_exp_f32 v97, v97
    v_exp_f32 v98, v98
    v_exp_f32 v99, v99
    s_nop 0
    v_cvt_pk_bf16_f32 v132, v92, v93
    v_cvt_pk_bf16_f32 v133, v94, v95
    v_cvt_pk_bf16_f32 v134, v96, v97
    v_cvt_pk_bf16_f32 v135, v98, v99
    s_nop 1
    v_mfma_f32_32x32x16_bf16 v[28:43], v[196:199], v[132:135], v[28:43]
    v_fma_f32 v100, v100, s20, -v10
    v_fma_f32 v101, v101, s20, -v10
    v_fma_f32 v102, v102, s20, -v10
    v_fma_f32 v103, v103, s20, -v10
    v_fma_f32 v104, v104, s20, -v10
    v_fma_f32 v105, v105, s20, -v10
    v_fma_f32 v106, v106, s20, -v10
    v_fma_f32 v107, v107, s20, -v10
    v_exp_f32 v100, v100
    v_exp_f32 v101, v101
    v_exp_f32 v102, v102
    v_exp_f32 v103, v103
    v_exp_f32 v104, v104
    v_exp_f32 v105, v105
    v_exp_f32 v106, v106
    v_exp_f32 v107, v107
    s_nop 0
    v_cvt_pk_bf16_f32 v136, v100, v101
    v_cvt_pk_bf16_f32 v137, v102, v103
    v_cvt_pk_bf16_f32 v138, v104, v105
    v_cvt_pk_bf16_f32 v139, v106, v107
    s_nop 1
    v_mfma_f32_32x32x16_bf16 v[28:43], v[200:203], v[136:139], v[28:43]
    s_waitcnt vmcnt(0)
    ds_write_b32 v5, v12 offset:18432
    ds_write_b32 v5, v13 offset:18448
    ds_write_b32 v206, v14 offset:18464
    ds_write_b32 v6, v15 offset:18432
    ds_write_b32 v6, v16 offset:18448
    ds_write_b32 v207, v17 offset:18464
    s_waitcnt lgkmcnt(0)
    s_barrier
    s_mov_b32 s21, 0x1b0000
    buffer_load_dword v12, v4, s[8:11], s21 offen offset:1152
    buffer_load_dword v13, v4, s[8:11], s21 offen offset:1168
    buffer_load_dword v14, v205, s[8:11], s21 offen offset:1184
    buffer_load_dword v15, v4, s[8:11], s21 offen offset:2304
    buffer_load_dword v16, v4, s[8:11], s21 offen offset:2320
    buffer_load_dword v17, v205, s[8:11], s21 offen offset:2336
    ds_read_b128 v[140:143], v7 offset:18432
    ds_read_b128 v[144:147], v7 offset:18464
    ds_read_b128 v[148:151], v7 offset:20992
    ds_read_b128 v[152:155], v7 offset:21024
    ds_read_b128 v[156:159], v7 offset:23552
    ds_read_b128 v[160:163], v7 offset:23584
    ds_read_b128 v[164:167], v7 offset:26112
    ds_read_b128 v[168:171], v7 offset:26144
    s_waitcnt lgkmcnt(6)
    v_mfma_f32_32x32x16_bf16 v[44:59], v[140:143], v[20:23], 0
    v_mfma_f32_32x32x16_bf16 v[44:59], v[144:147], v[24:27], v[44:59]
    s_waitcnt lgkmcnt(4)
    v_mfma_f32_32x32x16_bf16 v[60:75], v[148:151], v[20:23], 0
    v_mfma_f32_32x32x16_bf16 v[60:75], v[152:155], v[24:27], v[60:75]
    s_waitcnt lgkmcnt(2)
    v_mfma_f32_32x32x16_bf16 v[76:91], v[156:159], v[20:23], 0
    v_mfma_f32_32x32x16_bf16 v[76:91], v[160:163], v[24:27], v[76:91]
    s_waitcnt lgkmcnt(0)
    v_mfma_f32_32x32x16_bf16 v[92:107], v[164:167], v[20:23], 0
    v_mfma_f32_32x32x16_bf16 v[92:107], v[168:171], v[24:27], v[92:107]
    ds_read_b64_tr_b16 v[172:173], v8 offset:18432
    ds_read_b64_tr_b16 v[174:175], v8 offset:18944
    ds_read_b64_tr_b16 v[176:177], v8 offset:19456
    ds_read_b64_tr_b16 v[178:179], v8 offset:19968
    ds_read_b64_tr_b16 v[180:181], v8 offset:20480
    ds_read_b64_tr_b16 v[182:183], v8 offset:20992
    ds_read_b64_tr_b16 v[184:185], v8 offset:21504
    ds_read_b64_tr_b16 v[186:187], v8 offset:22016
    ds_read_b64_tr_b16 v[188:189], v8 offset:22528
    ds_read_b64_tr_b16 v[190:191], v8 offset:23040
    ds_read_b64_tr_b16 v[192:193], v8 offset:23552
    ds_read_b64_tr_b16 v[194:195], v8 offset:24064
    ds_read_b64_tr_b16 v[196:197], v8 offset:24576
    ds_read_b64_tr_b16 v[198:199], v8 offset:25088
    ds_read_b64_tr_b16 v[200:201], v8 offset:25600
    ds_read_b64_tr_b16 v[202:203], v8 offset:26112
    s_nop 7
    s_nop 3
    v_max3_f32 v1, v44, v45, v46
    v_max3_f32 v1, v1, v47, v48
    v_max3_f32 v1, v1, v49, v50
    v_max3_f32 v1, v1, v51, v52
    v_max3_f32 v1, v1, v53, v54
    v_max3_f32 v1, v1, v55, v56
    v_max3_f32 v1, v1, v57, v58
    v_max3_f32 v1, v1, v59, v60
    v_max3_f32 v1, v1, v61, v62
    v_max3_f32 v1, v1, v63, v64
    v_max3_f32 v1, v1, v65, v66
    v_max3_f32 v1, v1, v67, v68
    v_max3_f32 v1, v1, v69, v70
    v_max3_f32 v1, v1, v71, v72
    v_max3_f32 v1, v1, v73, v74
    v_max3_f32 v1, v1, v75, v76
    v_max3_f32 v1, v1, v77, v78
    v_max3_f32 v1, v1, v79, v80
    v_max3_f32 v1, v1, v81, v82
    v_max3_f32 v1, v1, v83, v84
    v_max3_f32 v1, v1, v85, v86
    v_max3_f32 v1, v1, v87, v88
    v_max3_f32 v1, v1, v89, v90
    v_max3_f32 v1, v1, v91, v92
    v_max3_f32 v1, v1, v93, v94
    v_max3_f32 v1, v1, v95, v96
    v_max3_f32 v1, v1, v97, v98
    v_max3_f32 v1, v1, v99, v100
    v_max3_f32 v1, v1, v101, v102
    v_max3_f32 v1, v1, v103, v104
    v_max3_f32 v1, v1, v105, v106
    v_max_f32 v1, v1, v107
    v_mov_b32 v2, v1
    s_nop 1
    v_permlane32_swap_b32 v1, v2
    v_max3_f32 v1, v1, v2, v9
    v_sub_f32 v2, v9, v1
    v_mul_f32 v2, s20, v2
    v_exp_f32 v2, v2
    v_mov_b32 v9, v1
    v_mul_f32 v10, s20, v1
    v_mul_f32 v28, v28, v2
    v_mul_f32 v29, v29, v2
    v_mul_f32 v30, v30, v2
    v_mul_f32 v31, v31, v2
    v_mul_f32 v32, v32, v2
    v_mul_f32 v33, v33, v2
    v_mul_f32 v34, v34, v2
    v_mul_f32 v35, v35, v2
    v_mul_f32 v36, v36, v2
    v_mul_f32 v37, v37, v2
    v_mul_f32 v38, v38, v2
    v_mul_f32 v39, v39, v2
    v_mul_f32 v40, v40, v2
    v_mul_f32 v41, v41, v2
    v_mul_f32 v42, v42, v2
    v_mul_f32 v43, v43, v2
    s_waitcnt lgkmcnt(0)
    v_fma_f32 v44, v44, s20, -v10
    v_fma_f32 v45, v45, s20, -v10
    v_fma_f32 v46, v46, s20, -v10
    v_fma_f32 v47, v47, s20, -v10
    v_fma_f32 v48, v48, s20, -v10
    v_fma_f32 v49, v49, s20, -v10
    v_fma_f32 v50, v50, s20, -v10
    v_fma_f32 v51, v51, s20, -v10
    v_exp_f32 v44, v44
    v_exp_f32 v45, v45
    v_exp_f32 v46, v46
    v_exp_f32 v47, v47
    v_exp_f32 v48, v48
    v_exp_f32 v49, v49
    v_exp_f32 v50, v50
    v_exp_f32 v51, v51
    s_nop 0
    v_cvt_pk_bf16_f32 v108, v44, v45
    v_cvt_pk_bf16_f32 v109, v46, v47
    v_cvt_pk_bf16_f32 v110, v48, v49
    v_cvt_pk_bf16_f32 v111, v50, v51
    s_nop 1
    v_mfma_f32_32x32x16_bf16 v[28:43], v[172:175], v[108:111], v[28:43]
    v_fma_f32 v52, v52, s20, -v10
    v_fma_f32 v53, v53, s20, -v10
    v_fma_f32 v54, v54, s20, -v10
    v_fma_f32 v55, v55, s20, -v10
    v_fma_f32 v56, v56, s20, -v10
    v_fma_f32 v57, v57, s20, -v10
    v_fma_f32 v58, v58, s20, -v10
    v_fma_f32 v59, v59, s20, -v10
    v_exp_f32 v52, v52
    v_exp_f32 v53, v53
    v_exp_f32 v54, v54
    v_exp_f32 v55, v55
    v_exp_f32 v56, v56
    v_exp_f32 v57, v57
    v_exp_f32 v58, v58
    v_exp_f32 v59, v59
    s_nop 0
    v_cvt_pk_bf16_f32 v112, v52, v53
    v_cvt_pk_bf16_f32 v113, v54, v55
    v_cvt_pk_bf16_f32 v114, v56, v57
    v_cvt_pk_bf16_f32 v115, v58, v59
    s_nop 1
    v_mfma_f32_32x32x16_bf16 v[28:43], v[176:179], v[112:115], v[28:43]
    v_fma_f32 v60, v60, s20, -v10
    v_fma_f32 v61, v61, s20, -v10
    v_fma_f32 v62, v62, s20, -v10
    v_fma_f32 v63, v63, s20, -v10
    v_fma_f32 v64, v64, s20, -v10
    v_fma_f32 v65, v65, s20, -v10
    v_fma_f32 v66, v66, s20, -v10
    v_fma_f32 v67, v67, s20, -v10
    v_exp_f32 v60, v60
    v_exp_f32 v61, v61
    v_exp_f32 v62, v62
    v_exp_f32 v63, v63
    v_exp_f32 v64, v64
    v_exp_f32 v65, v65
    v_exp_f32 v66, v66
    v_exp_f32 v67, v67
    s_nop 0
    v_cvt_pk_bf16_f32 v116, v60, v61
    v_cvt_pk_bf16_f32 v117, v62, v63
    v_cvt_pk_bf16_f32 v118, v64, v65
    v_cvt_pk_bf16_f32 v119, v66, v67
    s_nop 1
    v_mfma_f32_32x32x16_bf16 v[28:43], v[180:183], v[116:119], v[28:43]
    v_fma_f32 v68, v68, s20, -v10
    v_fma_f32 v69, v69, s20, -v10
    v_fma_f32 v70, v70, s20, -v10
    v_fma_f32 v71, v71, s20, -v10
    v_fma_f32 v72, v72, s20, -v10
    v_fma_f32 v73, v73, s20, -v10
    v_fma_f32 v74, v74, s20, -v10
    v_fma_f32 v75, v75, s20, -v10
    v_exp_f32 v68, v68
    v_exp_f32 v69, v69
    v_exp_f32 v70, v70
    v_exp_f32 v71, v71
    v_exp_f32 v72, v72
    v_exp_f32 v73, v73
    v_exp_f32 v74, v74
    v_exp_f32 v75, v75
    s_nop 0
    v_cvt_pk_bf16_f32 v120, v68, v69
    v_cvt_pk_bf16_f32 v121, v70, v71
    v_cvt_pk_bf16_f32 v122, v72, v73
    v_cvt_pk_bf16_f32 v123, v74, v75
    s_nop 1
    v_mfma_f32_32x32x16_bf16 v[28:43], v[184:187], v[120:123], v[28:43]
    v_fma_f32 v76, v76, s20, -v10
    v_fma_f32 v77, v77, s20, -v10
    v_fma_f32 v78, v78, s20, -v10
    v_fma_f32 v79, v79, s20, -v10
    v_fma_f32 v80, v80, s20, -v10
    v_fma_f32 v81, v81, s20, -v10
    v_fma_f32 v82, v82, s20, -v10
    v_fma_f32 v83, v83, s20, -v10
    v_exp_f32 v76, v76
    v_exp_f32 v77, v77
    v_exp_f32 v78, v78
    v_exp_f32 v79, v79
    v_exp_f32 v80, v80
    v_exp_f32 v81, v81
    v_exp_f32 v82, v82
    v_exp_f32 v83, v83
    s_nop 0
    v_cvt_pk_bf16_f32 v124, v76, v77
    v_cvt_pk_bf16_f32 v125, v78, v79
    v_cvt_pk_bf16_f32 v126, v80, v81
    v_cvt_pk_bf16_f32 v127, v82, v83
    s_nop 1
    v_mfma_f32_32x32x16_bf16 v[28:43], v[188:191], v[124:127], v[28:43]
    v_fma_f32 v84, v84, s20, -v10
    v_fma_f32 v85, v85, s20, -v10
    v_fma_f32 v86, v86, s20, -v10
    v_fma_f32 v87, v87, s20, -v10
    v_fma_f32 v88, v88, s20, -v10
    v_fma_f32 v89, v89, s20, -v10
    v_fma_f32 v90, v90, s20, -v10
    v_fma_f32 v91, v91, s20, -v10
    v_exp_f32 v84, v84
    v_exp_f32 v85, v85
    v_exp_f32 v86, v86
    v_exp_f32 v87, v87
    v_exp_f32 v88, v88
    v_exp_f32 v89, v89
    v_exp_f32 v90, v90
    v_exp_f32 v91, v91
    s_nop 0
    v_cvt_pk_bf16_f32 v128, v84, v85
    v_cvt_pk_bf16_f32 v129, v86, v87
    v_cvt_pk_bf16_f32 v130, v88, v89
    v_cvt_pk_bf16_f32 v131, v90, v91
    s_nop 1
    v_mfma_f32_32x32x16_bf16 v[28:43], v[192:195], v[128:131], v[28:43]
    v_fma_f32 v92, v92, s20, -v10
    v_fma_f32 v93, v93, s20, -v10
    v_fma_f32 v94, v94, s20, -v10
    v_fma_f32 v95, v95, s20, -v10
    v_fma_f32 v96, v96, s20, -v10
    v_fma_f32 v97, v97, s20, -v10
    v_fma_f32 v98, v98, s20, -v10
    v_fma_f32 v99, v99, s20, -v10
    v_exp_f32 v92, v92
    v_exp_f32 v93, v93
    v_exp_f32 v94, v94
    v_exp_f32 v95, v95
    v_exp_f32 v96, v96
    v_exp_f32 v97, v97
    v_exp_f32 v98, v98
    v_exp_f32 v99, v99
    s_nop 0
    v_cvt_pk_bf16_f32 v132, v92, v93
    v_cvt_pk_bf16_f32 v133, v94, v95
    v_cvt_pk_bf16_f32 v134, v96, v97
    v_cvt_pk_bf16_f32 v135, v98, v99
    s_nop 1
    v_mfma_f32_32x32x16_bf16 v[28:43], v[196:199], v[132:135], v[28:43]
    v_fma_f32 v100, v100, s20, -v10
    v_fma_f32 v101, v101, s20, -v10
    v_fma_f32 v102, v102, s20, -v10
    v_fma_f32 v103, v103, s20, -v10
    v_fma_f32 v104, v104, s20, -v10
    v_fma_f32 v105, v105, s20, -v10
    v_fma_f32 v106, v106, s20, -v10
    v_fma_f32 v107, v107, s20, -v10
    v_exp_f32 v100, v100
    v_exp_f32 v101, v101
    v_exp_f32 v102, v102
    v_exp_f32 v103, v103
    v_exp_f32 v104, v104
    v_exp_f32 v105, v105
    v_exp_f32 v106, v106
    v_exp_f32 v107, v107
    s_nop 0
    v_cvt_pk_bf16_f32 v136, v100, v101
    v_cvt_pk_bf16_f32 v137, v102, v103
    v_cvt_pk_bf16_f32 v138, v104, v105
    v_cvt_pk_bf16_f32 v139, v106, v107
    s_nop 1
    v_mfma_f32_32x32x16_bf16 v[28:43], v[200:203], v[136:139], v[28:43]
    s_waitcnt vmcnt(0)
    ds_write_b32 v5, v12 offset:0
    ds_write_b32 v5, v13 offset:16
    ds_write_b32 v206, v14 offset:32
    ds_write_b32 v6, v15 offset:0
    ds_write_b32 v6, v16 offset:16
    ds_write_b32 v207, v17 offset:32
    s_waitcnt lgkmcnt(0)
    s_barrier
    s_mov_b32 s21, 0x21c000
    buffer_load_dword v12, v4, s[8:11], s21 offen offset:1152
    buffer_load_dword v13, v4, s[8:11], s21 offen offset:1168
    buffer_load_dword v14, v205, s[8:11], s21 offen offset:1184
    buffer_load_dword v15, v4, s[8:11], s21 offen offset:2304
    buffer_load_dword v16, v4, s[8:11], s21 offen offset:2320
    buffer_load_dword v17, v205, s[8:11], s21 offen offset:2336
    ds_read_b128 v[140:143], v7 offset:0
    ds_read_b128 v[144:147], v7 offset:32
    ds_read_b128 v[148:151], v7 offset:2560
    ds_read_b128 v[152:155], v7 offset:2592
    ds_read_b128 v[156:159], v7 offset:5120
    ds_read_b128 v[160:163], v7 offset:5152
    ds_read_b128 v[164:167], v7 offset:7680
    ds_read_b128 v[168:171], v7 offset:7712
    s_waitcnt lgkmcnt(6)
    v_mfma_f32_32x32x16_bf16 v[44:59], v[140:143], v[20:23], 0
    v_mfma_f32_32x32x16_bf16 v[44:59], v[144:147], v[24:27], v[44:59]
    s_waitcnt lgkmcnt(4)
    v_mfma_f32_32x32x16_bf16 v[60:75], v[148:151], v[20:23], 0
    v_mfma_f32_32x32x16_bf16 v[60:75], v[152:155], v[24:27], v[60:75]
    s_waitcnt lgkmcnt(2)
    v_mfma_f32_32x32x16_bf16 v[76:91], v[156:159], v[20:23], 0
    v_mfma_f32_32x32x16_bf16 v[76:91], v[160:163], v[24:27], v[76:91]
    s_waitcnt lgkmcnt(0)
    v_mfma_f32_32x32x16_bf16 v[92:107], v[164:167], v[20:23], 0
    v_mfma_f32_32x32x16_bf16 v[92:107], v[168:171], v[24:27], v[92:107]
    ds_read_b64_tr_b16 v[172:173], v8 offset:0
    ds_read_b64_tr_b16 v[174:175], v8 offset:512
    ds_read_b64_tr_b16 v[176:177], v8 offset:1024
    ds_read_b64_tr_b16 v[178:179], v8 offset:1536
    ds_read_b64_tr_b16 v[180:181], v8 offset:2048
    ds_read_b64_tr_b16 v[182:183], v8 offset:2560
    ds_read_b64_tr_b16 v[184:185], v8 offset:3072
    ds_read_b64_tr_b16 v[186:187], v8 offset:3584
    ds_read_b64_tr_b16 v[188:189], v8 offset:4096
    ds_read_b64_tr_b16 v[190:191], v8 offset:4608
    ds_read_b64_tr_b16 v[192:193], v8 offset:5120
    ds_read_b64_tr_b16 v[194:195], v8 offset:5632
    ds_read_b64_tr_b16 v[196:197], v8 offset:6144
    ds_read_b64_tr_b16 v[198:199], v8 offset:6656
    ds_read_b64_tr_b16 v[200:201], v8 offset:7168
    ds_read_b64_tr_b16 v[202:203], v8 offset:7680
    s_nop 7
    s_nop 3
    v_max3_f32 v1, v44, v45, v46
    v_max3_f32 v1, v1, v47, v48
    v_max3_f32 v1, v1, v49, v50
    v_max3_f32 v1, v1, v51, v52
    v_max3_f32 v1, v1, v53, v54
    v_max3_f32 v1, v1, v55, v56
    v_max3_f32 v1, v1, v57, v58
    v_max3_f32 v1, v1, v59, v60
    v_max3_f32 v1, v1, v61, v62
    v_max3_f32 v1, v1, v63, v64
    v_max3_f32 v1, v1, v65, v66
    v_max3_f32 v1, v1, v67, v68
    v_max3_f32 v1, v1, v69, v70
    v_max3_f32 v1, v1, v71, v72
    v_max3_f32 v1, v1, v73, v74
    v_max3_f32 v1, v1, v75, v76
    v_max3_f32 v1, v1, v77, v78
    v_max3_f32 v1, v1, v79, v80
    v_max3_f32 v1, v1, v81, v82
    v_max3_f32 v1, v1, v83, v84
    v_max3_f32 v1, v1, v85, v86
    v_max3_f32 v1, v1, v87, v88
    v_max3_f32 v1, v1, v89, v90
    v_max3_f32 v1, v1, v91, v92
    v_max3_f32 v1, v1, v93, v94
    v_max3_f32 v1, v1, v95, v96
    v_max3_f32 v1, v1, v97, v98
    v_max3_f32 v1, v1, v99, v100
    v_max3_f32 v1, v1, v101, v102
    v_max3_f32 v1, v1, v103, v104
    v_max3_f32 v1, v1, v105, v106
    v_max_f32 v1, v1, v107
    v_mov_b32 v2, v1
    s_nop 1
    v_permlane32_swap_b32 v1, v2
    v_max3_f32 v1, v1, v2, v9
    v_sub_f32 v2, v9, v1
    v_mul_f32 v2, s20, v2
    v_exp_f32 v2, v2
    v_mov_b32 v9, v1
    v_mul_f32 v10, s20, v1
    v_mul_f32 v28, v28, v2
    v_mul_f32 v29, v29, v2
    v_mul_f32 v30, v30, v2
    v_mul_f32 v31, v31, v2
    v_mul_f32 v32, v32, v2
    v_mul_f32 v33, v33, v2
    v_mul_f32 v34, v34, v2
    v_mul_f32 v35, v35, v2
    v_mul_f32 v36, v36, v2
    v_mul_f32 v37, v37, v2
    v_mul_f32 v38, v38, v2
    v_mul_f32 v39, v39, v2
    v_mul_f32 v40, v40, v2
    v_mul_f32 v41, v41, v2
    v_mul_f32 v42, v42, v2
    v_mul_f32 v43, v43, v2
    s_waitcnt lgkmcnt(0)
    v_fma_f32 v44, v44, s20, -v10
    v_fma_f32 v45, v45, s20, -v10
    v_fma_f32 v46, v46, s20, -v10
    v_fma_f32 v47, v47, s20, -v10
    v_fma_f32 v48, v48, s20, -v10
    v_fma_f32 v49, v49, s20, -v10
    v_fma_f32 v50, v50, s20, -v10
    v_fma_f32 v51, v51, s20, -v10
    v_exp_f32 v44, v44
    v_exp_f32 v45, v45
    v_exp_f32 v46, v46
    v_exp_f32 v47, v47
    v_exp_f32 v48, v48
    v_exp_f32 v49, v49
    v_exp_f32 v50, v50
    v_exp_f32 v51, v51
    s_nop 0
    v_cvt_pk_bf16_f32 v108, v44, v45
    v_cvt_pk_bf16_f32 v109, v46, v47
    v_cvt_pk_bf16_f32 v110, v48, v49
    v_cvt_pk_bf16_f32 v111, v50, v51
    s_nop 1
    v_mfma_f32_32x32x16_bf16 v[28:43], v[172:175], v[108:111], v[28:43]
    v_fma_f32 v52, v52, s20, -v10
    v_fma_f32 v53, v53, s20, -v10
    v_fma_f32 v54, v54, s20, -v10
    v_fma_f32 v55, v55, s20, -v10
    v_fma_f32 v56, v56, s20, -v10
    v_fma_f32 v57, v57, s20, -v10
    v_fma_f32 v58, v58, s20, -v10
    v_fma_f32 v59, v59, s20, -v10
    v_exp_f32 v52, v52
    v_exp_f32 v53, v53
    v_exp_f32 v54, v54
    v_exp_f32 v55, v55
    v_exp_f32 v56, v56
    v_exp_f32 v57, v57
    v_exp_f32 v58, v58
    v_exp_f32 v59, v59
    s_nop 0
    v_cvt_pk_bf16_f32 v112, v52, v53
    v_cvt_pk_bf16_f32 v113, v54, v55
    v_cvt_pk_bf16_f32 v114, v56, v57
    v_cvt_pk_bf16_f32 v115, v58, v59
    s_nop 1
    v_mfma_f32_32x32x16_bf16 v[28:43], v[176:179], v[112:115], v[28:43]
    v_fma_f32 v60, v60, s20, -v10
    v_fma_f32 v61, v61, s20, -v10
    v_fma_f32 v62, v62, s20, -v10
    v_fma_f32 v63, v63, s20, -v10
    v_fma_f32 v64, v64, s20, -v10
    v_fma_f32 v65, v65, s20, -v10
    v_fma_f32 v66, v66, s20, -v10
    v_fma_f32 v67, v67, s20, -v10
    v_exp_f32 v60, v60
    v_exp_f32 v61, v61
    v_exp_f32 v62, v62
    v_exp_f32 v63, v63
    v_exp_f32 v64, v64
    v_exp_f32 v65, v65
    v_exp_f32 v66, v66
    v_exp_f32 v67, v67
    s_nop 0
    v_cvt_pk_bf16_f32 v116, v60, v61
    v_cvt_pk_bf16_f32 v117, v62, v63
    v_cvt_pk_bf16_f32 v118, v64, v65
    v_cvt_pk_bf16_f32 v119, v66, v67
    s_nop 1
    v_mfma_f32_32x32x16_bf16 v[28:43], v[180:183], v[116:119], v[28:43]
    v_fma_f32 v68, v68, s20, -v10
    v_fma_f32 v69, v69, s20, -v10
    v_fma_f32 v70, v70, s20, -v10
    v_fma_f32 v71, v71, s20, -v10
    v_fma_f32 v72, v72, s20, -v10
    v_fma_f32 v73, v73, s20, -v10
    v_fma_f32 v74, v74, s20, -v10
    v_fma_f32 v75, v75, s20, -v10
    v_exp_f32 v68, v68
    v_exp_f32 v69, v69
    v_exp_f32 v70, v70
    v_exp_f32 v71, v71
    v_exp_f32 v72, v72
    v_exp_f32 v73, v73
    v_exp_f32 v74, v74
    v_exp_f32 v75, v75
    s_nop 0
    v_cvt_pk_bf16_f32 v120, v68, v69
    v_cvt_pk_bf16_f32 v121, v70, v71
    v_cvt_pk_bf16_f32 v122, v72, v73
    v_cvt_pk_bf16_f32 v123, v74, v75
    s_nop 1
    v_mfma_f32_32x32x16_bf16 v[28:43], v[184:187], v[120:123], v[28:43]
    v_fma_f32 v76, v76, s20, -v10
    v_fma_f32 v77, v77, s20, -v10
    v_fma_f32 v78, v78, s20, -v10
    v_fma_f32 v79, v79, s20, -v10
    v_fma_f32 v80, v80, s20, -v10
    v_fma_f32 v81, v81, s20, -v10
    v_fma_f32 v82, v82, s20, -v10
    v_fma_f32 v83, v83, s20, -v10
    v_exp_f32 v76, v76
    v_exp_f32 v77, v77
    v_exp_f32 v78, v78
    v_exp_f32 v79, v79
    v_exp_f32 v80, v80
    v_exp_f32 v81, v81
    v_exp_f32 v82, v82
    v_exp_f32 v83, v83
    s_nop 0
    v_cvt_pk_bf16_f32 v124, v76, v77
    v_cvt_pk_bf16_f32 v125, v78, v79
    v_cvt_pk_bf16_f32 v126, v80, v81
    v_cvt_pk_bf16_f32 v127, v82, v83
    s_nop 1
    v_mfma_f32_32x32x16_bf16 v[28:43], v[188:191], v[124:127], v[28:43]
    v_fma_f32 v84, v84, s20, -v10
    v_fma_f32 v85, v85, s20, -v10
    v_fma_f32 v86, v86, s20, -v10
    v_fma_f32 v87, v87, s20, -v10
    v_fma_f32 v88, v88, s20, -v10
    v_fma_f32 v89, v89, s20, -v10
    v_fma_f32 v90, v90, s20, -v10
    v_fma_f32 v91, v91, s20, -v10
    v_exp_f32 v84, v84
    v_exp_f32 v85, v85
    v_exp_f32 v86, v86
    v_exp_f32 v87, v87
    v_exp_f32 v88, v88
    v_exp_f32 v89, v89
    v_exp_f32 v90, v90
    v_exp_f32 v91, v91
    s_nop 0
    v_cvt_pk_bf16_f32 v128, v84, v85
    v_cvt_pk_bf16_f32 v129, v86, v87
    v_cvt_pk_bf16_f32 v130, v88, v89
    v_cvt_pk_bf16_f32 v131, v90, v91
    s_nop 1
    v_mfma_f32_32x32x16_bf16 v[28:43], v[192:195], v[128:131], v[28:43]
    v_fma_f32 v92, v92, s20, -v10
    v_fma_f32 v93, v93, s20, -v10
    v_fma_f32 v94, v94, s20, -v10
    v_fma_f32 v95, v95, s20, -v10
    v_fma_f32 v96, v96, s20, -v10
    v_fma_f32 v97, v97, s20, -v10
    v_fma_f32 v98, v98, s20, -v10
    v_fma_f32 v99, v99, s20, -v10
    v_exp_f32 v92, v92
    v_exp_f32 v93, v93
    v_exp_f32 v94, v94
    v_exp_f32 v95, v95
    v_exp_f32 v96, v96
    v_exp_f32 v97, v97
    v_exp_f32 v98, v98
    v_exp_f32 v99, v99
    s_nop 0
    v_cvt_pk_bf16_f32 v132, v92, v93
    v_cvt_pk_bf16_f32 v133, v94, v95
    v_cvt_pk_bf16_f32 v134, v96, v97
    v_cvt_pk_bf16_f32 v135, v98, v99
    s_nop 1
    v_mfma_f32_32x32x16_bf16 v[28:43], v[196:199], v[132:135], v[28:43]
    v_fma_f32 v100, v100, s20, -v10
    v_fma_f32 v101, v101, s20, -v10
    v_fma_f32 v102, v102, s20, -v10
    v_fma_f32 v103, v103, s20, -v10
    v_fma_f32 v104, v104, s20, -v10
    v_fma_f32 v105, v105, s20, -v10
    v_fma_f32 v106, v106, s20, -v10
    v_fma_f32 v107, v107, s20, -v10
    v_exp_f32 v100, v100
    v_exp_f32 v101, v101
    v_exp_f32 v102, v102
    v_exp_f32 v103, v103
    v_exp_f32 v104, v104
    v_exp_f32 v105, v105
    v_exp_f32 v106, v106
    v_exp_f32 v107, v107
    s_nop 0
    v_cvt_pk_bf16_f32 v136, v100, v101
    v_cvt_pk_bf16_f32 v137, v102, v103
    v_cvt_pk_bf16_f32 v138, v104, v105
    v_cvt_pk_bf16_f32 v139, v106, v107
    s_nop 1
    v_mfma_f32_32x32x16_bf16 v[28:43], v[200:203], v[136:139], v[28:43]
    s_waitcnt vmcnt(0)
    ds_write_b32 v5, v12 offset:18432
    ds_write_b32 v5, v13 offset:18448
    ds_write_b32 v206, v14 offset:18464
    ds_write_b32 v6, v15 offset:18432
    ds_write_b32 v6, v16 offset:18448
    ds_write_b32 v207, v17 offset:18464
    s_waitcnt lgkmcnt(0)
    s_barrier
    s_mov_b32 s21, 0x288000
    buffer_load_dword v12, v4, s[8:11], s21 offen offset:1152
    buffer_load_dword v13, v4, s[8:11], s21 offen offset:1168
    buffer_load_dword v14, v205, s[8:11], s21 offen offset:1184
    buffer_load_dword v15, v4, s[8:11], s21 offen offset:2304
    buffer_load_dword v16, v4, s[8:11], s21 offen offset:2320
    buffer_load_dword v17, v205, s[8:11], s21 offen offset:2336
    ds_read_b128 v[140:143], v7 offset:18432
    ds_read_b128 v[144:147], v7 offset:18464
    ds_read_b128 v[148:151], v7 offset:20992
    ds_read_b128 v[152:155], v7 offset:21024
    ds_read_b128 v[156:159], v7 offset:23552
    ds_read_b128 v[160:163], v7 offset:23584
    ds_read_b128 v[164:167], v7 offset:26112
    ds_read_b128 v[168:171], v7 offset:26144
    s_waitcnt lgkmcnt(6)
    v_mfma_f32_32x32x16_bf16 v[44:59], v[140:143], v[20:23], 0
    v_mfma_f32_32x32x16_bf16 v[44:59], v[144:147], v[24:27], v[44:59]
    s_waitcnt lgkmcnt(4)
    v_mfma_f32_32x32x16_bf16 v[60:75], v[148:151], v[20:23], 0
    v_mfma_f32_32x32x16_bf16 v[60:75], v[152:155], v[24:27], v[60:75]
    s_waitcnt lgkmcnt(2)
    v_mfma_f32_32x32x16_bf16 v[76:91], v[156:159], v[20:23], 0
    v_mfma_f32_32x32x16_bf16 v[76:91], v[160:163], v[24:27], v[76:91]
    s_waitcnt lgkmcnt(0)
    v_mfma_f32_32x32x16_bf16 v[92:107], v[164:167], v[20:23], 0
    v_mfma_f32_32x32x16_bf16 v[92:107], v[168:171], v[24:27], v[92:107]
    ds_read_b64_tr_b16 v[172:173], v8 offset:18432
    ds_read_b64_tr_b16 v[174:175], v8 offset:18944
    ds_read_b64_tr_b16 v[176:177], v8 offset:19456
    ds_read_b64_tr_b16 v[178:179], v8 offset:19968
    ds_read_b64_tr_b16 v[180:181], v8 offset:20480
    ds_read_b64_tr_b16 v[182:183], v8 offset:20992
    ds_read_b64_tr_b16 v[184:185], v8 offset:21504
    ds_read_b64_tr_b16 v[186:187], v8 offset:22016
    ds_read_b64_tr_b16 v[188:189], v8 offset:22528
    ds_read_b64_tr_b16 v[190:191], v8 offset:23040
    ds_read_b64_tr_b16 v[192:193], v8 offset:23552
    ds_read_b64_tr_b16 v[194:195], v8 offset:24064
    ds_read_b64_tr_b16 v[196:197], v8 offset:24576
    ds_read_b64_tr_b16 v[198:199], v8 offset:25088
    ds_read_b64_tr_b16 v[200:201], v8 offset:25600
    ds_read_b64_tr_b16 v[202:203], v8 offset:26112
    s_nop 7
    s_nop 3
    v_max3_f32 v1, v44, v45, v46
    v_max3_f32 v1, v1, v47, v48
    v_max3_f32 v1, v1, v49, v50
    v_max3_f32 v1, v1, v51, v52
    v_max3_f32 v1, v1, v53, v54
    v_max3_f32 v1, v1, v55, v56
    v_max3_f32 v1, v1, v57, v58
    v_max3_f32 v1, v1, v59, v60
    v_max3_f32 v1, v1, v61, v62
    v_max3_f32 v1, v1, v63, v64
    v_max3_f32 v1, v1, v65, v66
    v_max3_f32 v1, v1, v67, v68
    v_max3_f32 v1, v1, v69, v70
    v_max3_f32 v1, v1, v71, v72
    v_max3_f32 v1, v1, v73, v74
    v_max3_f32 v1, v1, v75, v76
    v_max3_f32 v1, v1, v77, v78
    v_max3_f32 v1, v1, v79, v80
    v_max3_f32 v1, v1, v81, v82
    v_max3_f32 v1, v1, v83, v84
    v_max3_f32 v1, v1, v85, v86
    v_max3_f32 v1, v1, v87, v88
    v_max3_f32 v1, v1, v89, v90
    v_max3_f32 v1, v1, v91, v92
    v_max3_f32 v1, v1, v93, v94
    v_max3_f32 v1, v1, v95, v96
    v_max3_f32 v1, v1, v97, v98
    v_max3_f32 v1, v1, v99, v100
    v_max3_f32 v1, v1, v101, v102
    v_max3_f32 v1, v1, v103, v104
    v_max3_f32 v1, v1, v105, v106
    v_max_f32 v1, v1, v107
    v_mov_b32 v2, v1
    s_nop 1
    v_permlane32_swap_b32 v1, v2
    v_max3_f32 v1, v1, v2, v9
    v_sub_f32 v2, v9, v1
    v_mul_f32 v2, s20, v2
    v_exp_f32 v2, v2
    v_mov_b32 v9, v1
    v_mul_f32 v10, s20, v1
    v_mul_f32 v28, v28, v2
    v_mul_f32 v29, v29, v2
    v_mul_f32 v30, v30, v2
    v_mul_f32 v31, v31, v2
    v_mul_f32 v32, v32, v2
    v_mul_f32 v33, v33, v2
    v_mul_f32 v34, v34, v2
    v_mul_f32 v35, v35, v2
    v_mul_f32 v36, v36, v2
    v_mul_f32 v37, v37, v2
    v_mul_f32 v38, v38, v2
    v_mul_f32 v39, v39, v2
    v_mul_f32 v40, v40, v2
    v_mul_f32 v41, v41, v2
    v_mul_f32 v42, v42, v2
    v_mul_f32 v43, v43, v2
    s_waitcnt lgkmcnt(0)
    v_fma_f32 v44, v44, s20, -v10
    v_fma_f32 v45, v45, s20, -v10
    v_fma_f32 v46, v46, s20, -v10
    v_fma_f32 v47, v47, s20, -v10
    v_fma_f32 v48, v48, s20, -v10
    v_fma_f32 v49, v49, s20, -v10
    v_fma_f32 v50, v50, s20, -v10
    v_fma_f32 v51, v51, s20, -v10
    v_exp_f32 v44, v44
    v_exp_f32 v45, v45
    v_exp_f32 v46, v46
    v_exp_f32 v47, v47
    v_exp_f32 v48, v48
    v_exp_f32 v49, v49
    v_exp_f32 v50, v50
    v_exp_f32 v51, v51
    s_nop 0
    v_cvt_pk_bf16_f32 v108, v44, v45
    v_cvt_pk_bf16_f32 v109, v46, v47
    v_cvt_pk_bf16_f32 v110, v48, v49
    v_cvt_pk_bf16_f32 v111, v50, v51
    s_nop 1
    v_mfma_f32_32x32x16_bf16 v[28:43], v[172:175], v[108:111], v[28:43]
    v_fma_f32 v52, v52, s20, -v10
    v_fma_f32 v53, v53, s20, -v10
    v_fma_f32 v54, v54, s20, -v10
    v_fma_f32 v55, v55, s20, -v10
    v_fma_f32 v56, v56, s20, -v10
    v_fma_f32 v57, v57, s20, -v10
    v_fma_f32 v58, v58, s20, -v10
    v_fma_f32 v59, v59, s20, -v10
    v_exp_f32 v52, v52
    v_exp_f32 v53, v53
    v_exp_f32 v54, v54
    v_exp_f32 v55, v55
    v_exp_f32 v56, v56
    v_exp_f32 v57, v57
    v_exp_f32 v58, v58
    v_exp_f32 v59, v59
    s_nop 0
    v_cvt_pk_bf16_f32 v112, v52, v53
    v_cvt_pk_bf16_f32 v113, v54, v55
    v_cvt_pk_bf16_f32 v114, v56, v57
    v_cvt_pk_bf16_f32 v115, v58, v59
    s_nop 1
    v_mfma_f32_32x32x16_bf16 v[28:43], v[176:179], v[112:115], v[28:43]
    v_fma_f32 v60, v60, s20, -v10
    v_fma_f32 v61, v61, s20, -v10
    v_fma_f32 v62, v62, s20, -v10
    v_fma_f32 v63, v63, s20, -v10
    v_fma_f32 v64, v64, s20, -v10
    v_fma_f32 v65, v65, s20, -v10
    v_fma_f32 v66, v66, s20, -v10
    v_fma_f32 v67, v67, s20, -v10
    v_exp_f32 v60, v60
    v_exp_f32 v61, v61
    v_exp_f32 v62, v62
    v_exp_f32 v63, v63
    v_exp_f32 v64, v64
    v_exp_f32 v65, v65
    v_exp_f32 v66, v66
    v_exp_f32 v67, v67
    s_nop 0
    v_cvt_pk_bf16_f32 v116, v60, v61
    v_cvt_pk_bf16_f32 v117, v62, v63
    v_cvt_pk_bf16_f32 v118, v64, v65
    v_cvt_pk_bf16_f32 v119, v66, v67
    s_nop 1
    v_mfma_f32_32x32x16_bf16 v[28:43], v[180:183], v[116:119], v[28:43]
    v_fma_f32 v68, v68, s20, -v10
    v_fma_f32 v69, v69, s20, -v10
    v_fma_f32 v70, v70, s20, -v10
    v_fma_f32 v71, v71, s20, -v10
    v_fma_f32 v72, v72, s20, -v10
    v_fma_f32 v73, v73, s20, -v10
    v_fma_f32 v74, v74, s20, -v10
    v_fma_f32 v75, v75, s20, -v10
    v_exp_f32 v68, v68
    v_exp_f32 v69, v69
    v_exp_f32 v70, v70
    v_exp_f32 v71, v71
    v_exp_f32 v72, v72
    v_exp_f32 v73, v73
    v_exp_f32 v74, v74
    v_exp_f32 v75, v75
    s_nop 0
    v_cvt_pk_bf16_f32 v120, v68, v69
    v_cvt_pk_bf16_f32 v121, v70, v71
    v_cvt_pk_bf16_f32 v122, v72, v73
    v_cvt_pk_bf16_f32 v123, v74, v75
    s_nop 1
    v_mfma_f32_32x32x16_bf16 v[28:43], v[184:187], v[120:123], v[28:43]
    v_fma_f32 v76, v76, s20, -v10
    v_fma_f32 v77, v77, s20, -v10
    v_fma_f32 v78, v78, s20, -v10
    v_fma_f32 v79, v79, s20, -v10
    v_fma_f32 v80, v80, s20, -v10
    v_fma_f32 v81, v81, s20, -v10
    v_fma_f32 v82, v82, s20, -v10
    v_fma_f32 v83, v83, s20, -v10
    v_exp_f32 v76, v76
    v_exp_f32 v77, v77
    v_exp_f32 v78, v78
    v_exp_f32 v79, v79
    v_exp_f32 v80, v80
    v_exp_f32 v81, v81
    v_exp_f32 v82, v82
    v_exp_f32 v83, v83
    s_nop 0
    v_cvt_pk_bf16_f32 v124, v76, v77
    v_cvt_pk_bf16_f32 v125, v78, v79
    v_cvt_pk_bf16_f32 v126, v80, v81
    v_cvt_pk_bf16_f32 v127, v82, v83
    s_nop 1
    v_mfma_f32_32x32x16_bf16 v[28:43], v[188:191], v[124:127], v[28:43]
    v_fma_f32 v84, v84, s20, -v10
    v_fma_f32 v85, v85, s20, -v10
    v_fma_f32 v86, v86, s20, -v10
    v_fma_f32 v87, v87, s20, -v10
    v_fma_f32 v88, v88, s20, -v10
    v_fma_f32 v89, v89, s20, -v10
    v_fma_f32 v90, v90, s20, -v10
    v_fma_f32 v91, v91, s20, -v10
    v_exp_f32 v84, v84
    v_exp_f32 v85, v85
    v_exp_f32 v86, v86
    v_exp_f32 v87, v87
    v_exp_f32 v88, v88
    v_exp_f32 v89, v89
    v_exp_f32 v90, v90
    v_exp_f32 v91, v91
    s_nop 0
    v_cvt_pk_bf16_f32 v128, v84, v85
    v_cvt_pk_bf16_f32 v129, v86, v87
    v_cvt_pk_bf16_f32 v130, v88, v89
    v_cvt_pk_bf16_f32 v131, v90, v91
    s_nop 1
    v_mfma_f32_32x32x16_bf16 v[28:43], v[192:195], v[128:131], v[28:43]
    v_fma_f32 v92, v92, s20, -v10
    v_fma_f32 v93, v93, s20, -v10
    v_fma_f32 v94, v94, s20, -v10
    v_fma_f32 v95, v95, s20, -v10
    v_fma_f32 v96, v96, s20, -v10
    v_fma_f32 v97, v97, s20, -v10
    v_fma_f32 v98, v98, s20, -v10
    v_fma_f32 v99, v99, s20, -v10
    v_exp_f32 v92, v92
    v_exp_f32 v93, v93
    v_exp_f32 v94, v94
    v_exp_f32 v95, v95
    v_exp_f32 v96, v96
    v_exp_f32 v97, v97
    v_exp_f32 v98, v98
    v_exp_f32 v99, v99
    s_nop 0
    v_cvt_pk_bf16_f32 v132, v92, v93
    v_cvt_pk_bf16_f32 v133, v94, v95
    v_cvt_pk_bf16_f32 v134, v96, v97
    v_cvt_pk_bf16_f32 v135, v98, v99
    s_nop 1
    v_mfma_f32_32x32x16_bf16 v[28:43], v[196:199], v[132:135], v[28:43]
    v_fma_f32 v100, v100, s20, -v10
    v_fma_f32 v101, v101, s20, -v10
    v_fma_f32 v102, v102, s20, -v10
    v_fma_f32 v103, v103, s20, -v10
    v_fma_f32 v104, v104, s20, -v10
    v_fma_f32 v105, v105, s20, -v10
    v_fma_f32 v106, v106, s20, -v10
    v_fma_f32 v107, v107, s20, -v10
    v_exp_f32 v100, v100
    v_exp_f32 v101, v101
    v_exp_f32 v102, v102
    v_exp_f32 v103, v103
    v_exp_f32 v104, v104
    v_exp_f32 v105, v105
    v_exp_f32 v106, v106
    v_exp_f32 v107, v107
    s_nop 0
    v_cvt_pk_bf16_f32 v136, v100, v101
    v_cvt_pk_bf16_f32 v137, v102, v103
    v_cvt_pk_bf16_f32 v138, v104, v105
    v_cvt_pk_bf16_f32 v139, v106, v107
    s_nop 1
    v_mfma_f32_32x32x16_bf16 v[28:43], v[200:203], v[136:139], v[28:43]
    s_waitcnt vmcnt(0)
    ds_write_b32 v5, v12 offset:0
    ds_write_b32 v5, v13 offset:16
    ds_write_b32 v206, v14 offset:32
    ds_write_b32 v6, v15 offset:0
    ds_write_b32 v6, v16 offset:16
    ds_write_b32 v207, v17 offset:32
    s_waitcnt lgkmcnt(0)
    s_barrier
    s_mov_b32 s21, 0x2f4000
    buffer_load_dword v12, v4, s[8:11], s21 offen offset:1152
    buffer_load_dword v13, v4, s[8:11], s21 offen offset:1168
    buffer_load_dword v14, v205, s[8:11], s21 offen offset:1184
    buffer_load_dword v15, v4, s[8:11], s21 offen offset:2304
    buffer_load_dword v16, v4, s[8:11], s21 offen offset:2320
    buffer_load_dword v17, v205, s[8:11], s21 offen offset:2336
    ds_read_b128 v[140:143], v7 offset:0
    ds_read_b128 v[144:147], v7 offset:32
    ds_read_b128 v[148:151], v7 offset:2560
    ds_read_b128 v[152:155], v7 offset:2592
    ds_read_b128 v[156:159], v7 offset:5120
    ds_read_b128 v[160:163], v7 offset:5152
    ds_read_b128 v[164:167], v7 offset:7680
    ds_read_b128 v[168:171], v7 offset:7712
    s_waitcnt lgkmcnt(6)
    v_mfma_f32_32x32x16_bf16 v[44:59], v[140:143], v[20:23], 0
    v_mfma_f32_32x32x16_bf16 v[44:59], v[144:147], v[24:27], v[44:59]
    s_waitcnt lgkmcnt(4)
    v_mfma_f32_32x32x16_bf16 v[60:75], v[148:151], v[20:23], 0
    v_mfma_f32_32x32x16_bf16 v[60:75], v[152:155], v[24:27], v[60:75]
    s_waitcnt lgkmcnt(2)
    v_mfma_f32_32x32x16_bf16 v[76:91], v[156:159], v[20:23], 0
    v_mfma_f32_32x32x16_bf16 v[76:91], v[160:163], v[24:27], v[76:91]
    s_waitcnt lgkmcnt(0)
    v_mfma_f32_32x32x16_bf16 v[92:107], v[164:167], v[20:23], 0
    v_mfma_f32_32x32x16_bf16 v[92:107], v[168:171], v[24:27], v[92:107]
    ds_read_b64_tr_b16 v[172:173], v8 offset:0
    ds_read_b64_tr_b16 v[174:175], v8 offset:512
    ds_read_b64_tr_b16 v[176:177], v8 offset:1024
    ds_read_b64_tr_b16 v[178:179], v8 offset:1536
    ds_read_b64_tr_b16 v[180:181], v8 offset:2048
    ds_read_b64_tr_b16 v[182:183], v8 offset:2560
    ds_read_b64_tr_b16 v[184:185], v8 offset:3072
    ds_read_b64_tr_b16 v[186:187], v8 offset:3584
    ds_read_b64_tr_b16 v[188:189], v8 offset:4096
    ds_read_b64_tr_b16 v[190:191], v8 offset:4608
    ds_read_b64_tr_b16 v[192:193], v8 offset:5120
    ds_read_b64_tr_b16 v[194:195], v8 offset:5632
    ds_read_b64_tr_b16 v[196:197], v8 offset:6144
    ds_read_b64_tr_b16 v[198:199], v8 offset:6656
    ds_read_b64_tr_b16 v[200:201], v8 offset:7168
    ds_read_b64_tr_b16 v[202:203], v8 offset:7680
    s_nop 7
    s_nop 3
    v_max3_f32 v1, v44, v45, v46
    v_max3_f32 v1, v1, v47, v48
    v_max3_f32 v1, v1, v49, v50
    v_max3_f32 v1, v1, v51, v52
    v_max3_f32 v1, v1, v53, v54
    v_max3_f32 v1, v1, v55, v56
    v_max3_f32 v1, v1, v57, v58
    v_max3_f32 v1, v1, v59, v60
    v_max3_f32 v1, v1, v61, v62
    v_max3_f32 v1, v1, v63, v64
    v_max3_f32 v1, v1, v65, v66
    v_max3_f32 v1, v1, v67, v68
    v_max3_f32 v1, v1, v69, v70
    v_max3_f32 v1, v1, v71, v72
    v_max3_f32 v1, v1, v73, v74
    v_max3_f32 v1, v1, v75, v76
    v_max3_f32 v1, v1, v77, v78
    v_max3_f32 v1, v1, v79, v80
    v_max3_f32 v1, v1, v81, v82
    v_max3_f32 v1, v1, v83, v84
    v_max3_f32 v1, v1, v85, v86
    v_max3_f32 v1, v1, v87, v88
    v_max3_f32 v1, v1, v89, v90
    v_max3_f32 v1, v1, v91, v92
    v_max3_f32 v1, v1, v93, v94
    v_max3_f32 v1, v1, v95, v96
    v_max3_f32 v1, v1, v97, v98
    v_max3_f32 v1, v1, v99, v100
    v_max3_f32 v1, v1, v101, v102
    v_max3_f32 v1, v1, v103, v104
    v_max3_f32 v1, v1, v105, v106
    v_max_f32 v1, v1, v107
    v_mov_b32 v2, v1
    s_nop 1
    v_permlane32_swap_b32 v1, v2
    v_max3_f32 v1, v1, v2, v9
    v_sub_f32 v2, v9, v1
    v_mul_f32 v2, s20, v2
    v_exp_f32 v2, v2
    v_mov_b32 v9, v1
    v_mul_f32 v10, s20, v1
    v_mul_f32 v28, v28, v2
    v_mul_f32 v29, v29, v2
    v_mul_f32 v30, v30, v2
    v_mul_f32 v31, v31, v2
    v_mul_f32 v32, v32, v2
    v_mul_f32 v33, v33, v2
    v_mul_f32 v34, v34, v2
    v_mul_f32 v35, v35, v2
    v_mul_f32 v36, v36, v2
    v_mul_f32 v37, v37, v2
    v_mul_f32 v38, v38, v2
    v_mul_f32 v39, v39, v2
    v_mul_f32 v40, v40, v2
    v_mul_f32 v41, v41, v2
    v_mul_f32 v42, v42, v2
    v_mul_f32 v43, v43, v2
    s_waitcnt lgkmcnt(0)
    v_fma_f32 v44, v44, s20, -v10
    v_fma_f32 v45, v45, s20, -v10
    v_fma_f32 v46, v46, s20, -v10
    v_fma_f32 v47, v47, s20, -v10
    v_fma_f32 v48, v48, s20, -v10
    v_fma_f32 v49, v49, s20, -v10
    v_fma_f32 v50, v50, s20, -v10
    v_fma_f32 v51, v51, s20, -v10
    v_exp_f32 v44, v44
    v_exp_f32 v45, v45
    v_exp_f32 v46, v46
    v_exp_f32 v47, v47
    v_exp_f32 v48, v48
    v_exp_f32 v49, v49
    v_exp_f32 v50, v50
    v_exp_f32 v51, v51
    s_nop 0
    v_cvt_pk_bf16_f32 v108, v44, v45
    v_cvt_pk_bf16_f32 v109, v46, v47
    v_cvt_pk_bf16_f32 v110, v48, v49
    v_cvt_pk_bf16_f32 v111, v50, v51
    s_nop 1
    v_mfma_f32_32x32x16_bf16 v[28:43], v[172:175], v[108:111], v[28:43]
    v_fma_f32 v52, v52, s20, -v10
    v_fma_f32 v53, v53, s20, -v10
    v_fma_f32 v54, v54, s20, -v10
    v_fma_f32 v55, v55, s20, -v10
    v_fma_f32 v56, v56, s20, -v10
    v_fma_f32 v57, v57, s20, -v10
    v_fma_f32 v58, v58, s20, -v10
    v_fma_f32 v59, v59, s20, -v10
    v_exp_f32 v52, v52
    v_exp_f32 v53, v53
    v_exp_f32 v54, v54
    v_exp_f32 v55, v55
    v_exp_f32 v56, v56
    v_exp_f32 v57, v57
    v_exp_f32 v58, v58
    v_exp_f32 v59, v59
    s_nop 0
    v_cvt_pk_bf16_f32 v112, v52, v53
    v_cvt_pk_bf16_f32 v113, v54, v55
    v_cvt_pk_bf16_f32 v114, v56, v57
    v_cvt_pk_bf16_f32 v115, v58, v59
    s_nop 1
    v_mfma_f32_32x32x16_bf16 v[28:43], v[176:179], v[112:115], v[28:43]
    v_fma_f32 v60, v60, s20, -v10
    v_fma_f32 v61, v61, s20, -v10
    v_fma_f32 v62, v62, s20, -v10
    v_fma_f32 v63, v63, s20, -v10
    v_fma_f32 v64, v64, s20, -v10
    v_fma_f32 v65, v65, s20, -v10
    v_fma_f32 v66, v66, s20, -v10
    v_fma_f32 v67, v67, s20, -v10
    v_exp_f32 v60, v60
    v_exp_f32 v61, v61
    v_exp_f32 v62, v62
    v_exp_f32 v63, v63
    v_exp_f32 v64, v64
    v_exp_f32 v65, v65
    v_exp_f32 v66, v66
    v_exp_f32 v67, v67
    s_nop 0
    v_cvt_pk_bf16_f32 v116, v60, v61
    v_cvt_pk_bf16_f32 v117, v62, v63
    v_cvt_pk_bf16_f32 v118, v64, v65
    v_cvt_pk_bf16_f32 v119, v66, v67
    s_nop 1
    v_mfma_f32_32x32x16_bf16 v[28:43], v[180:183], v[116:119], v[28:43]
    v_fma_f32 v68, v68, s20, -v10
    v_fma_f32 v69, v69, s20, -v10
    v_fma_f32 v70, v70, s20, -v10
    v_fma_f32 v71, v71, s20, -v10
    v_fma_f32 v72, v72, s20, -v10
    v_fma_f32 v73, v73, s20, -v10
    v_fma_f32 v74, v74, s20, -v10
    v_fma_f32 v75, v75, s20, -v10
    v_exp_f32 v68, v68
    v_exp_f32 v69, v69
    v_exp_f32 v70, v70
    v_exp_f32 v71, v71
    v_exp_f32 v72, v72
    v_exp_f32 v73, v73
    v_exp_f32 v74, v74
    v_exp_f32 v75, v75
    s_nop 0
    v_cvt_pk_bf16_f32 v120, v68, v69
    v_cvt_pk_bf16_f32 v121, v70, v71
    v_cvt_pk_bf16_f32 v122, v72, v73
    v_cvt_pk_bf16_f32 v123, v74, v75
    s_nop 1
    v_mfma_f32_32x32x16_bf16 v[28:43], v[184:187], v[120:123], v[28:43]
    v_fma_f32 v76, v76, s20, -v10
    v_fma_f32 v77, v77, s20, -v10
    v_fma_f32 v78, v78, s20, -v10
    v_fma_f32 v79, v79, s20, -v10
    v_fma_f32 v80, v80, s20, -v10
    v_fma_f32 v81, v81, s20, -v10
    v_fma_f32 v82, v82, s20, -v10
    v_fma_f32 v83, v83, s20, -v10
    v_exp_f32 v76, v76
    v_exp_f32 v77, v77
    v_exp_f32 v78, v78
    v_exp_f32 v79, v79
    v_exp_f32 v80, v80
    v_exp_f32 v81, v81
    v_exp_f32 v82, v82
    v_exp_f32 v83, v83
    s_nop 0
    v_cvt_pk_bf16_f32 v124, v76, v77
    v_cvt_pk_bf16_f32 v125, v78, v79
    v_cvt_pk_bf16_f32 v126, v80, v81
    v_cvt_pk_bf16_f32 v127, v82, v83
    s_nop 1
    v_mfma_f32_32x32x16_bf16 v[28:43], v[188:191], v[124:127], v[28:43]
    v_fma_f32 v84, v84, s20, -v10
    v_fma_f32 v85, v85, s20, -v10
    v_fma_f32 v86, v86, s20, -v10
    v_fma_f32 v87, v87, s20, -v10
    v_fma_f32 v88, v88, s20, -v10
    v_fma_f32 v89, v89, s20, -v10
    v_fma_f32 v90, v90, s20, -v10
    v_fma_f32 v91, v91, s20, -v10
    v_exp_f32 v84, v84
    v_exp_f32 v85, v85
    v_exp_f32 v86, v86
    v_exp_f32 v87, v87
    v_exp_f32 v88, v88
    v_exp_f32 v89, v89
    v_exp_f32 v90, v90
    v_exp_f32 v91, v91
    s_nop 0
    v_cvt_pk_bf16_f32 v128, v84, v85
    v_cvt_pk_bf16_f32 v129, v86, v87
    v_cvt_pk_bf16_f32 v130, v88, v89
    v_cvt_pk_bf16_f32 v131, v90, v91
    s_nop 1
    v_mfma_f32_32x32x16_bf16 v[28:43], v[192:195], v[128:131], v[28:43]
    v_fma_f32 v92, v92, s20, -v10
    v_fma_f32 v93, v93, s20, -v10
    v_fma_f32 v94, v94, s20, -v10
    v_fma_f32 v95, v95, s20, -v10
    v_fma_f32 v96, v96, s20, -v10
    v_fma_f32 v97, v97, s20, -v10
    v_fma_f32 v98, v98, s20, -v10
    v_fma_f32 v99, v99, s20, -v10
    v_exp_f32 v92, v92
    v_exp_f32 v93, v93
    v_exp_f32 v94, v94
    v_exp_f32 v95, v95
    v_exp_f32 v96, v96
    v_exp_f32 v97, v97
    v_exp_f32 v98, v98
    v_exp_f32 v99, v99
    s_nop 0
    v_cvt_pk_bf16_f32 v132, v92, v93
    v_cvt_pk_bf16_f32 v133, v94, v95
    v_cvt_pk_bf16_f32 v134, v96, v97
    v_cvt_pk_bf16_f32 v135, v98, v99
    s_nop 1
    v_mfma_f32_32x32x16_bf16 v[28:43], v[196:199], v[132:135], v[28:43]
    v_fma_f32 v100, v100, s20, -v10
    v_fma_f32 v101, v101, s20, -v10
    v_fma_f32 v102, v102, s20, -v10
    v_fma_f32 v103, v103, s20, -v10
    v_fma_f32 v104, v104, s20, -v10
    v_fma_f32 v105, v105, s20, -v10
    v_fma_f32 v106, v106, s20, -v10
    v_fma_f32 v107, v107, s20, -v10
    v_exp_f32 v100, v100
    v_exp_f32 v101, v101
    v_exp_f32 v102, v102
    v_exp_f32 v103, v103
    v_exp_f32 v104, v104
    v_exp_f32 v105, v105
    v_exp_f32 v106, v106
    v_exp_f32 v107, v107
    s_nop 0
    v_cvt_pk_bf16_f32 v136, v100, v101
    v_cvt_pk_bf16_f32 v137, v102, v103
    v_cvt_pk_bf16_f32 v138, v104, v105
    v_cvt_pk_bf16_f32 v139, v106, v107
    s_nop 1
    v_mfma_f32_32x32x16_bf16 v[28:43], v[200:203], v[136:139], v[28:43]
    s_waitcnt vmcnt(0)
    ds_write_b32 v5, v12 offset:18432
    ds_write_b32 v5, v13 offset:18448
    ds_write_b32 v206, v14 offset:18464
    ds_write_b32 v6, v15 offset:18432
    ds_write_b32 v6, v16 offset:18448
    ds_write_b32 v207, v17 offset:18464
    s_waitcnt lgkmcnt(0)
    s_barrier
    s_mov_b32 s21, 0x360000
    buffer_load_dword v12, v4, s[8:11], s21 offen offset:1152
    buffer_load_dword v13, v4, s[8:11], s21 offen offset:1168
    buffer_load_dword v14, v205, s[8:11], s21 offen offset:1184
    buffer_load_dword v15, v4, s[8:11], s21 offen offset:2304
    buffer_load_dword v16, v4, s[8:11], s21 offen offset:2320
    buffer_load_dword v17, v205, s[8:11], s21 offen offset:2336
    ds_read_b128 v[140:143], v7 offset:18432
    ds_read_b128 v[144:147], v7 offset:18464
    ds_read_b128 v[148:151], v7 offset:20992
    ds_read_b128 v[152:155], v7 offset:21024
    ds_read_b128 v[156:159], v7 offset:23552
    ds_read_b128 v[160:163], v7 offset:23584
    ds_read_b128 v[164:167], v7 offset:26112
    ds_read_b128 v[168:171], v7 offset:26144
    s_waitcnt lgkmcnt(6)
    v_mfma_f32_32x32x16_bf16 v[44:59], v[140:143], v[20:23], 0
    v_mfma_f32_32x32x16_bf16 v[44:59], v[144:147], v[24:27], v[44:59]
    s_waitcnt lgkmcnt(4)
    v_mfma_f32_32x32x16_bf16 v[60:75], v[148:151], v[20:23], 0
    v_mfma_f32_32x32x16_bf16 v[60:75], v[152:155], v[24:27], v[60:75]
    s_waitcnt lgkmcnt(2)
    v_mfma_f32_32x32x16_bf16 v[76:91], v[156:159], v[20:23], 0
    v_mfma_f32_32x32x16_bf16 v[76:91], v[160:163], v[24:27], v[76:91]
    s_waitcnt lgkmcnt(0)
    v_mfma_f32_32x32x16_bf16 v[92:107], v[164:167], v[20:23], 0
    v_mfma_f32_32x32x16_bf16 v[92:107], v[168:171], v[24:27], v[92:107]
    ds_read_b64_tr_b16 v[172:173], v8 offset:18432
    ds_read_b64_tr_b16 v[174:175], v8 offset:18944
    ds_read_b64_tr_b16 v[176:177], v8 offset:19456
    ds_read_b64_tr_b16 v[178:179], v8 offset:19968
    ds_read_b64_tr_b16 v[180:181], v8 offset:20480
    ds_read_b64_tr_b16 v[182:183], v8 offset:20992
    ds_read_b64_tr_b16 v[184:185], v8 offset:21504
    ds_read_b64_tr_b16 v[186:187], v8 offset:22016
    ds_read_b64_tr_b16 v[188:189], v8 offset:22528
    ds_read_b64_tr_b16 v[190:191], v8 offset:23040
    ds_read_b64_tr_b16 v[192:193], v8 offset:23552
    ds_read_b64_tr_b16 v[194:195], v8 offset:24064
    ds_read_b64_tr_b16 v[196:197], v8 offset:24576
    ds_read_b64_tr_b16 v[198:199], v8 offset:25088
    ds_read_b64_tr_b16 v[200:201], v8 offset:25600
    ds_read_b64_tr_b16 v[202:203], v8 offset:26112
    s_nop 7
    s_nop 3
    v_max3_f32 v1, v44, v45, v46
    v_max3_f32 v1, v1, v47, v48
    v_max3_f32 v1, v1, v49, v50
    v_max3_f32 v1, v1, v51, v52
    v_max3_f32 v1, v1, v53, v54
    v_max3_f32 v1, v1, v55, v56
    v_max3_f32 v1, v1, v57, v58
    v_max3_f32 v1, v1, v59, v60
    v_max3_f32 v1, v1, v61, v62
    v_max3_f32 v1, v1, v63, v64
    v_max3_f32 v1, v1, v65, v66
    v_max3_f32 v1, v1, v67, v68
    v_max3_f32 v1, v1, v69, v70
    v_max3_f32 v1, v1, v71, v72
    v_max3_f32 v1, v1, v73, v74
    v_max3_f32 v1, v1, v75, v76
    v_max3_f32 v1, v1, v77, v78
    v_max3_f32 v1, v1, v79, v80
    v_max3_f32 v1, v1, v81, v82
    v_max3_f32 v1, v1, v83, v84
    v_max3_f32 v1, v1, v85, v86
    v_max3_f32 v1, v1, v87, v88
    v_max3_f32 v1, v1, v89, v90
    v_max3_f32 v1, v1, v91, v92
    v_max3_f32 v1, v1, v93, v94
    v_max3_f32 v1, v1, v95, v96
    v_max3_f32 v1, v1, v97, v98
    v_max3_f32 v1, v1, v99, v100
    v_max3_f32 v1, v1, v101, v102
    v_max3_f32 v1, v1, v103, v104
    v_max3_f32 v1, v1, v105, v106
    v_max_f32 v1, v1, v107
    v_mov_b32 v2, v1
    s_nop 1
    v_permlane32_swap_b32 v1, v2
    v_max3_f32 v1, v1, v2, v9
    v_sub_f32 v2, v9, v1
    v_mul_f32 v2, s20, v2
    v_exp_f32 v2, v2
    v_mov_b32 v9, v1
    v_mul_f32 v10, s20, v1
    v_mul_f32 v28, v28, v2
    v_mul_f32 v29, v29, v2
    v_mul_f32 v30, v30, v2
    v_mul_f32 v31, v31, v2
    v_mul_f32 v32, v32, v2
    v_mul_f32 v33, v33, v2
    v_mul_f32 v34, v34, v2
    v_mul_f32 v35, v35, v2
    v_mul_f32 v36, v36, v2
    v_mul_f32 v37, v37, v2
    v_mul_f32 v38, v38, v2
    v_mul_f32 v39, v39, v2
    v_mul_f32 v40, v40, v2
    v_mul_f32 v41, v41, v2
    v_mul_f32 v42, v42, v2
    v_mul_f32 v43, v43, v2
    s_waitcnt lgkmcnt(0)
    v_fma_f32 v44, v44, s20, -v10
    v_fma_f32 v45, v45, s20, -v10
    v_fma_f32 v46, v46, s20, -v10
    v_fma_f32 v47, v47, s20, -v10
    v_fma_f32 v48, v48, s20, -v10
    v_fma_f32 v49, v49, s20, -v10
    v_fma_f32 v50, v50, s20, -v10
    v_fma_f32 v51, v51, s20, -v10
    v_exp_f32 v44, v44
    v_exp_f32 v45, v45
    v_exp_f32 v46, v46
    v_exp_f32 v47, v47
    v_exp_f32 v48, v48
    v_exp_f32 v49, v49
    v_exp_f32 v50, v50
    v_exp_f32 v51, v51
    s_nop 0
    v_cvt_pk_bf16_f32 v108, v44, v45
    v_cvt_pk_bf16_f32 v109, v46, v47
    v_cvt_pk_bf16_f32 v110, v48, v49
    v_cvt_pk_bf16_f32 v111, v50, v51
    s_nop 1
    v_mfma_f32_32x32x16_bf16 v[28:43], v[172:175], v[108:111], v[28:43]
    v_fma_f32 v52, v52, s20, -v10
    v_fma_f32 v53, v53, s20, -v10
    v_fma_f32 v54, v54, s20, -v10
    v_fma_f32 v55, v55, s20, -v10
    v_fma_f32 v56, v56, s20, -v10
    v_fma_f32 v57, v57, s20, -v10
    v_fma_f32 v58, v58, s20, -v10
    v_fma_f32 v59, v59, s20, -v10
    v_exp_f32 v52, v52
    v_exp_f32 v53, v53
    v_exp_f32 v54, v54
    v_exp_f32 v55, v55
    v_exp_f32 v56, v56
    v_exp_f32 v57, v57
    v_exp_f32 v58, v58
    v_exp_f32 v59, v59
    s_nop 0
    v_cvt_pk_bf16_f32 v112, v52, v53
    v_cvt_pk_bf16_f32 v113, v54, v55
    v_cvt_pk_bf16_f32 v114, v56, v57
    v_cvt_pk_bf16_f32 v115, v58, v59
    s_nop 1
    v_mfma_f32_32x32x16_bf16 v[28:43], v[176:179], v[112:115], v[28:43]
    v_fma_f32 v60, v60, s20, -v10
    v_fma_f32 v61, v61, s20, -v10
    v_fma_f32 v62, v62, s20, -v10
    v_fma_f32 v63, v63, s20, -v10
    v_fma_f32 v64, v64, s20, -v10
    v_fma_f32 v65, v65, s20, -v10
    v_fma_f32 v66, v66, s20, -v10
    v_fma_f32 v67, v67, s20, -v10
    v_exp_f32 v60, v60
    v_exp_f32 v61, v61
    v_exp_f32 v62, v62
    v_exp_f32 v63, v63
    v_exp_f32 v64, v64
    v_exp_f32 v65, v65
    v_exp_f32 v66, v66
    v_exp_f32 v67, v67
    s_nop 0
    v_cvt_pk_bf16_f32 v116, v60, v61
    v_cvt_pk_bf16_f32 v117, v62, v63
    v_cvt_pk_bf16_f32 v118, v64, v65
    v_cvt_pk_bf16_f32 v119, v66, v67
    s_nop 1
    v_mfma_f32_32x32x16_bf16 v[28:43], v[180:183], v[116:119], v[28:43]
    v_fma_f32 v68, v68, s20, -v10
    v_fma_f32 v69, v69, s20, -v10
    v_fma_f32 v70, v70, s20, -v10
    v_fma_f32 v71, v71, s20, -v10
    v_fma_f32 v72, v72, s20, -v10
    v_fma_f32 v73, v73, s20, -v10
    v_fma_f32 v74, v74, s20, -v10
    v_fma_f32 v75, v75, s20, -v10
    v_exp_f32 v68, v68
    v_exp_f32 v69, v69
    v_exp_f32 v70, v70
    v_exp_f32 v71, v71
    v_exp_f32 v72, v72
    v_exp_f32 v73, v73
    v_exp_f32 v74, v74
    v_exp_f32 v75, v75
    s_nop 0
    v_cvt_pk_bf16_f32 v120, v68, v69
    v_cvt_pk_bf16_f32 v121, v70, v71
    v_cvt_pk_bf16_f32 v122, v72, v73
    v_cvt_pk_bf16_f32 v123, v74, v75
    s_nop 1
    v_mfma_f32_32x32x16_bf16 v[28:43], v[184:187], v[120:123], v[28:43]
    v_fma_f32 v76, v76, s20, -v10
    v_fma_f32 v77, v77, s20, -v10
    v_fma_f32 v78, v78, s20, -v10
    v_fma_f32 v79, v79, s20, -v10
    v_fma_f32 v80, v80, s20, -v10
    v_fma_f32 v81, v81, s20, -v10
    v_fma_f32 v82, v82, s20, -v10
    v_fma_f32 v83, v83, s20, -v10
    v_exp_f32 v76, v76
    v_exp_f32 v77, v77
    v_exp_f32 v78, v78
    v_exp_f32 v79, v79
    v_exp_f32 v80, v80
    v_exp_f32 v81, v81
    v_exp_f32 v82, v82
    v_exp_f32 v83, v83
    s_nop 0
    v_cvt_pk_bf16_f32 v124, v76, v77
    v_cvt_pk_bf16_f32 v125, v78, v79
    v_cvt_pk_bf16_f32 v126, v80, v81
    v_cvt_pk_bf16_f32 v127, v82, v83
    s_nop 1
    v_mfma_f32_32x32x16_bf16 v[28:43], v[188:191], v[124:127], v[28:43]
    v_fma_f32 v84, v84, s20, -v10
    v_fma_f32 v85, v85, s20, -v10
    v_fma_f32 v86, v86, s20, -v10
    v_fma_f32 v87, v87, s20, -v10
    v_fma_f32 v88, v88, s20, -v10
    v_fma_f32 v89, v89, s20, -v10
    v_fma_f32 v90, v90, s20, -v10
    v_fma_f32 v91, v91, s20, -v10
    v_exp_f32 v84, v84
    v_exp_f32 v85, v85
    v_exp_f32 v86, v86
    v_exp_f32 v87, v87
    v_exp_f32 v88, v88
    v_exp_f32 v89, v89
    v_exp_f32 v90, v90
    v_exp_f32 v91, v91
    s_nop 0
    v_cvt_pk_bf16_f32 v128, v84, v85
    v_cvt_pk_bf16_f32 v129, v86, v87
    v_cvt_pk_bf16_f32 v130, v88, v89
    v_cvt_pk_bf16_f32 v131, v90, v91
    s_nop 1
    v_mfma_f32_32x32x16_bf16 v[28:43], v[192:195], v[128:131], v[28:43]
    v_fma_f32 v92, v92, s20, -v10
    v_fma_f32 v93, v93, s20, -v10
    v_fma_f32 v94, v94, s20, -v10
    v_fma_f32 v95, v95, s20, -v10
    v_fma_f32 v96, v96, s20, -v10
    v_fma_f32 v97, v97, s20, -v10
    v_fma_f32 v98, v98, s20, -v10
    v_fma_f32 v99, v99, s20, -v10
    v_exp_f32 v92, v92
    v_exp_f32 v93, v93
    v_exp_f32 v94, v94
    v_exp_f32 v95, v95
    v_exp_f32 v96, v96
    v_exp_f32 v97, v97
    v_exp_f32 v98, v98
    v_exp_f32 v99, v99
    s_nop 0
    v_cvt_pk_bf16_f32 v132, v92, v93
    v_cvt_pk_bf16_f32 v133, v94, v95
    v_cvt_pk_bf16_f32 v134, v96, v97
    v_cvt_pk_bf16_f32 v135, v98, v99
    s_nop 1
    v_mfma_f32_32x32x16_bf16 v[28:43], v[196:199], v[132:135], v[28:43]
    v_fma_f32 v100, v100, s20, -v10
    v_fma_f32 v101, v101, s20, -v10
    v_fma_f32 v102, v102, s20, -v10
    v_fma_f32 v103, v103, s20, -v10
    v_fma_f32 v104, v104, s20, -v10
    v_fma_f32 v105, v105, s20, -v10
    v_fma_f32 v106, v106, s20, -v10
    v_fma_f32 v107, v107, s20, -v10
    v_exp_f32 v100, v100
    v_exp_f32 v101, v101
    v_exp_f32 v102, v102
    v_exp_f32 v103, v103
    v_exp_f32 v104, v104
    v_exp_f32 v105, v105
    v_exp_f32 v106, v106
    v_exp_f32 v107, v107
    s_nop 0
    v_cvt_pk_bf16_f32 v136, v100, v101
    v_cvt_pk_bf16_f32 v137, v102, v103
    v_cvt_pk_bf16_f32 v138, v104, v105
    v_cvt_pk_bf16_f32 v139, v106, v107
    s_nop 1
    v_mfma_f32_32x32x16_bf16 v[28:43], v[200:203], v[136:139], v[28:43]
    s_waitcnt vmcnt(0)
    ds_write_b32 v5, v12 offset:0
    ds_write_b32 v5, v13 offset:16
    ds_write_b32 v206, v14 offset:32
    ds_write_b32 v6, v15 offset:0
    ds_write_b32 v6, v16 offset:16
    ds_write_b32 v207, v17 offset:32
    s_waitcnt lgkmcnt(0)
    s_barrier
    s_mov_b32 s21, 0x3cc000
    buffer_load_dword v12, v4, s[8:11], s21 offen offset:1152
    buffer_load_dword v13, v4, s[8:11], s21 offen offset:1168
    buffer_load_dword v14, v205, s[8:11], s21 offen offset:1184
    buffer_load_dword v15, v4, s[8:11], s21 offen offset:2304
    buffer_load_dword v16, v4, s[8:11], s21 offen offset:2320
    buffer_load_dword v17, v205, s[8:11], s21 offen offset:2336
    ds_read_b128 v[140:143], v7 offset:0
    ds_read_b128 v[144:147], v7 offset:32
    ds_read_b128 v[148:151], v7 offset:2560
    ds_read_b128 v[152:155], v7 offset:2592
    ds_read_b128 v[156:159], v7 offset:5120
    ds_read_b128 v[160:163], v7 offset:5152
    ds_read_b128 v[164:167], v7 offset:7680
    ds_read_b128 v[168:171], v7 offset:7712
    s_waitcnt lgkmcnt(6)
    v_mfma_f32_32x32x16_bf16 v[44:59], v[140:143], v[20:23], 0
    v_mfma_f32_32x32x16_bf16 v[44:59], v[144:147], v[24:27], v[44:59]
    s_waitcnt lgkmcnt(4)
    v_mfma_f32_32x32x16_bf16 v[60:75], v[148:151], v[20:23], 0
    v_mfma_f32_32x32x16_bf16 v[60:75], v[152:155], v[24:27], v[60:75]
    s_waitcnt lgkmcnt(2)
    v_mfma_f32_32x32x16_bf16 v[76:91], v[156:159], v[20:23], 0
    v_mfma_f32_32x32x16_bf16 v[76:91], v[160:163], v[24:27], v[76:91]
    s_waitcnt lgkmcnt(0)
    v_mfma_f32_32x32x16_bf16 v[92:107], v[164:167], v[20:23], 0
    v_mfma_f32_32x32x16_bf16 v[92:107], v[168:171], v[24:27], v[92:107]
    ds_read_b64_tr_b16 v[172:173], v8 offset:0
    ds_read_b64_tr_b16 v[174:175], v8 offset:512
    ds_read_b64_tr_b16 v[176:177], v8 offset:1024
    ds_read_b64_tr_b16 v[178:179], v8 offset:1536
    ds_read_b64_tr_b16 v[180:181], v8 offset:2048
    ds_read_b64_tr_b16 v[182:183], v8 offset:2560
    ds_read_b64_tr_b16 v[184:185], v8 offset:3072
    ds_read_b64_tr_b16 v[186:187], v8 offset:3584
    ds_read_b64_tr_b16 v[188:189], v8 offset:4096
    ds_read_b64_tr_b16 v[190:191], v8 offset:4608
    ds_read_b64_tr_b16 v[192:193], v8 offset:5120
    ds_read_b64_tr_b16 v[194:195], v8 offset:5632
    ds_read_b64_tr_b16 v[196:197], v8 offset:6144
    ds_read_b64_tr_b16 v[198:199], v8 offset:6656
    ds_read_b64_tr_b16 v[200:201], v8 offset:7168
    ds_read_b64_tr_b16 v[202:203], v8 offset:7680
    s_nop 7
    s_nop 3
    v_max3_f32 v1, v44, v45, v46
    v_max3_f32 v1, v1, v47, v48
    v_max3_f32 v1, v1, v49, v50
    v_max3_f32 v1, v1, v51, v52
    v_max3_f32 v1, v1, v53, v54
    v_max3_f32 v1, v1, v55, v56
    v_max3_f32 v1, v1, v57, v58
    v_max3_f32 v1, v1, v59, v60
    v_max3_f32 v1, v1, v61, v62
    v_max3_f32 v1, v1, v63, v64
    v_max3_f32 v1, v1, v65, v66
    v_max3_f32 v1, v1, v67, v68
    v_max3_f32 v1, v1, v69, v70
    v_max3_f32 v1, v1, v71, v72
    v_max3_f32 v1, v1, v73, v74
    v_max3_f32 v1, v1, v75, v76
    v_max3_f32 v1, v1, v77, v78
    v_max3_f32 v1, v1, v79, v80
    v_max3_f32 v1, v1, v81, v82
    v_max3_f32 v1, v1, v83, v84
    v_max3_f32 v1, v1, v85, v86
    v_max3_f32 v1, v1, v87, v88
    v_max3_f32 v1, v1, v89, v90
    v_max3_f32 v1, v1, v91, v92
    v_max3_f32 v1, v1, v93, v94
    v_max3_f32 v1, v1, v95, v96
    v_max3_f32 v1, v1, v97, v98
    v_max3_f32 v1, v1, v99, v100
    v_max3_f32 v1, v1, v101, v102
    v_max3_f32 v1, v1, v103, v104
    v_max3_f32 v1, v1, v105, v106
    v_max_f32 v1, v1, v107
    v_mov_b32 v2, v1
    s_nop 1
    v_permlane32_swap_b32 v1, v2
    v_max3_f32 v1, v1, v2, v9
    v_sub_f32 v2, v9, v1
    v_mul_f32 v2, s20, v2
    v_exp_f32 v2, v2
    v_mov_b32 v9, v1
    v_mul_f32 v10, s20, v1
    v_mul_f32 v28, v28, v2
    v_mul_f32 v29, v29, v2
    v_mul_f32 v30, v30, v2
    v_mul_f32 v31, v31, v2
    v_mul_f32 v32, v32, v2
    v_mul_f32 v33, v33, v2
    v_mul_f32 v34, v34, v2
    v_mul_f32 v35, v35, v2
    v_mul_f32 v36, v36, v2
    v_mul_f32 v37, v37, v2
    v_mul_f32 v38, v38, v2
    v_mul_f32 v39, v39, v2
    v_mul_f32 v40, v40, v2
    v_mul_f32 v41, v41, v2
    v_mul_f32 v42, v42, v2
    v_mul_f32 v43, v43, v2
    s_waitcnt lgkmcnt(0)
    v_fma_f32 v44, v44, s20, -v10
    v_fma_f32 v45, v45, s20, -v10
    v_fma_f32 v46, v46, s20, -v10
    v_fma_f32 v47, v47, s20, -v10
    v_fma_f32 v48, v48, s20, -v10
    v_fma_f32 v49, v49, s20, -v10
    v_fma_f32 v50, v50, s20, -v10
    v_fma_f32 v51, v51, s20, -v10
    v_exp_f32 v44, v44
    v_exp_f32 v45, v45
    v_exp_f32 v46, v46
    v_exp_f32 v47, v47
    v_exp_f32 v48, v48
    v_exp_f32 v49, v49
    v_exp_f32 v50, v50
    v_exp_f32 v51, v51
    s_nop 0
    v_cvt_pk_bf16_f32 v108, v44, v45
    v_cvt_pk_bf16_f32 v109, v46, v47
    v_cvt_pk_bf16_f32 v110, v48, v49
    v_cvt_pk_bf16_f32 v111, v50, v51
    s_nop 1
    v_mfma_f32_32x32x16_bf16 v[28:43], v[172:175], v[108:111], v[28:43]
    v_fma_f32 v52, v52, s20, -v10
    v_fma_f32 v53, v53, s20, -v10
    v_fma_f32 v54, v54, s20, -v10
    v_fma_f32 v55, v55, s20, -v10
    v_fma_f32 v56, v56, s20, -v10
    v_fma_f32 v57, v57, s20, -v10
    v_fma_f32 v58, v58, s20, -v10
    v_fma_f32 v59, v59, s20, -v10
    v_exp_f32 v52, v52
    v_exp_f32 v53, v53
    v_exp_f32 v54, v54
    v_exp_f32 v55, v55
    v_exp_f32 v56, v56
    v_exp_f32 v57, v57
    v_exp_f32 v58, v58
    v_exp_f32 v59, v59
    s_nop 0
    v_cvt_pk_bf16_f32 v112, v52, v53
    v_cvt_pk_bf16_f32 v113, v54, v55
    v_cvt_pk_bf16_f32 v114, v56, v57
    v_cvt_pk_bf16_f32 v115, v58, v59
    s_nop 1
    v_mfma_f32_32x32x16_bf16 v[28:43], v[176:179], v[112:115], v[28:43]
    v_fma_f32 v60, v60, s20, -v10
    v_fma_f32 v61, v61, s20, -v10
    v_fma_f32 v62, v62, s20, -v10
    v_fma_f32 v63, v63, s20, -v10
    v_fma_f32 v64, v64, s20, -v10
    v_fma_f32 v65, v65, s20, -v10
    v_fma_f32 v66, v66, s20, -v10
    v_fma_f32 v67, v67, s20, -v10
    v_exp_f32 v60, v60
    v_exp_f32 v61, v61
    v_exp_f32 v62, v62
    v_exp_f32 v63, v63
    v_exp_f32 v64, v64
    v_exp_f32 v65, v65
    v_exp_f32 v66, v66
    v_exp_f32 v67, v67
    s_nop 0
    v_cvt_pk_bf16_f32 v116, v60, v61
    v_cvt_pk_bf16_f32 v117, v62, v63
    v_cvt_pk_bf16_f32 v118, v64, v65
    v_cvt_pk_bf16_f32 v119, v66, v67
    s_nop 1
    v_mfma_f32_32x32x16_bf16 v[28:43], v[180:183], v[116:119], v[28:43]
    v_fma_f32 v68, v68, s20, -v10
    v_fma_f32 v69, v69, s20, -v10
    v_fma_f32 v70, v70, s20, -v10
    v_fma_f32 v71, v71, s20, -v10
    v_fma_f32 v72, v72, s20, -v10
    v_fma_f32 v73, v73, s20, -v10
    v_fma_f32 v74, v74, s20, -v10
    v_fma_f32 v75, v75, s20, -v10
    v_exp_f32 v68, v68
    v_exp_f32 v69, v69
    v_exp_f32 v70, v70
    v_exp_f32 v71, v71
    v_exp_f32 v72, v72
    v_exp_f32 v73, v73
    v_exp_f32 v74, v74
    v_exp_f32 v75, v75
    s_nop 0
    v_cvt_pk_bf16_f32 v120, v68, v69
    v_cvt_pk_bf16_f32 v121, v70, v71
    v_cvt_pk_bf16_f32 v122, v72, v73
    v_cvt_pk_bf16_f32 v123, v74, v75
    s_nop 1
    v_mfma_f32_32x32x16_bf16 v[28:43], v[184:187], v[120:123], v[28:43]
    v_fma_f32 v76, v76, s20, -v10
    v_fma_f32 v77, v77, s20, -v10
    v_fma_f32 v78, v78, s20, -v10
    v_fma_f32 v79, v79, s20, -v10
    v_fma_f32 v80, v80, s20, -v10
    v_fma_f32 v81, v81, s20, -v10
    v_fma_f32 v82, v82, s20, -v10
    v_fma_f32 v83, v83, s20, -v10
    v_exp_f32 v76, v76
    v_exp_f32 v77, v77
    v_exp_f32 v78, v78
    v_exp_f32 v79, v79
    v_exp_f32 v80, v80
    v_exp_f32 v81, v81
    v_exp_f32 v82, v82
    v_exp_f32 v83, v83
    s_nop 0
    v_cvt_pk_bf16_f32 v124, v76, v77
    v_cvt_pk_bf16_f32 v125, v78, v79
    v_cvt_pk_bf16_f32 v126, v80, v81
    v_cvt_pk_bf16_f32 v127, v82, v83
    s_nop 1
    v_mfma_f32_32x32x16_bf16 v[28:43], v[188:191], v[124:127], v[28:43]
    v_fma_f32 v84, v84, s20, -v10
    v_fma_f32 v85, v85, s20, -v10
    v_fma_f32 v86, v86, s20, -v10
    v_fma_f32 v87, v87, s20, -v10
    v_fma_f32 v88, v88, s20, -v10
    v_fma_f32 v89, v89, s20, -v10
    v_fma_f32 v90, v90, s20, -v10
    v_fma_f32 v91, v91, s20, -v10
    v_exp_f32 v84, v84
    v_exp_f32 v85, v85
    v_exp_f32 v86, v86
    v_exp_f32 v87, v87
    v_exp_f32 v88, v88
    v_exp_f32 v89, v89
    v_exp_f32 v90, v90
    v_exp_f32 v91, v91
    s_nop 0
    v_cvt_pk_bf16_f32 v128, v84, v85
    v_cvt_pk_bf16_f32 v129, v86, v87
    v_cvt_pk_bf16_f32 v130, v88, v89
    v_cvt_pk_bf16_f32 v131, v90, v91
    s_nop 1
    v_mfma_f32_32x32x16_bf16 v[28:43], v[192:195], v[128:131], v[28:43]
    v_fma_f32 v92, v92, s20, -v10
    v_fma_f32 v93, v93, s20, -v10
    v_fma_f32 v94, v94, s20, -v10
    v_fma_f32 v95, v95, s20, -v10
    v_fma_f32 v96, v96, s20, -v10
    v_fma_f32 v97, v97, s20, -v10
    v_fma_f32 v98, v98, s20, -v10
    v_fma_f32 v99, v99, s20, -v10
    v_exp_f32 v92, v92
    v_exp_f32 v93, v93
    v_exp_f32 v94, v94
    v_exp_f32 v95, v95
    v_exp_f32 v96, v96
    v_exp_f32 v97, v97
    v_exp_f32 v98, v98
    v_exp_f32 v99, v99
    s_nop 0
    v_cvt_pk_bf16_f32 v132, v92, v93
    v_cvt_pk_bf16_f32 v133, v94, v95
    v_cvt_pk_bf16_f32 v134, v96, v97
    v_cvt_pk_bf16_f32 v135, v98, v99
    s_nop 1
    v_mfma_f32_32x32x16_bf16 v[28:43], v[196:199], v[132:135], v[28:43]
    v_fma_f32 v100, v100, s20, -v10
    v_fma_f32 v101, v101, s20, -v10
    v_fma_f32 v102, v102, s20, -v10
    v_fma_f32 v103, v103, s20, -v10
    v_fma_f32 v104, v104, s20, -v10
    v_fma_f32 v105, v105, s20, -v10
    v_fma_f32 v106, v106, s20, -v10
    v_fma_f32 v107, v107, s20, -v10
    v_exp_f32 v100, v100
    v_exp_f32 v101, v101
    v_exp_f32 v102, v102
    v_exp_f32 v103, v103
    v_exp_f32 v104, v104
    v_exp_f32 v105, v105
    v_exp_f32 v106, v106
    v_exp_f32 v107, v107
    s_nop 0
    v_cvt_pk_bf16_f32 v136, v100, v101
    v_cvt_pk_bf16_f32 v137, v102, v103
    v_cvt_pk_bf16_f32 v138, v104, v105
    v_cvt_pk_bf16_f32 v139, v106, v107
    s_nop 1
    v_mfma_f32_32x32x16_bf16 v[28:43], v[200:203], v[136:139], v[28:43]
    s_waitcnt vmcnt(0)
    ds_write_b32 v5, v12 offset:18432
    ds_write_b32 v5, v13 offset:18448
    ds_write_b32 v206, v14 offset:18464
    ds_write_b32 v6, v15 offset:18432
    ds_write_b32 v6, v16 offset:18448
    ds_write_b32 v207, v17 offset:18464
    s_waitcnt lgkmcnt(0)
    s_barrier
    s_mov_b32 s21, 0x438000
    buffer_load_dword v12, v4, s[8:11], s21 offen offset:1152
    buffer_load_dword v13, v4, s[8:11], s21 offen offset:1168
    buffer_load_dword v14, v205, s[8:11], s21 offen offset:1184
    buffer_load_dword v15, v4, s[8:11], s21 offen offset:2304
    buffer_load_dword v16, v4, s[8:11], s21 offen offset:2320
    buffer_load_dword v17, v205, s[8:11], s21 offen offset:2336
    ds_read_b128 v[140:143], v7 offset:18432
    ds_read_b128 v[144:147], v7 offset:18464
    ds_read_b128 v[148:151], v7 offset:20992
    ds_read_b128 v[152:155], v7 offset:21024
    ds_read_b128 v[156:159], v7 offset:23552
    ds_read_b128 v[160:163], v7 offset:23584
    ds_read_b128 v[164:167], v7 offset:26112
    ds_read_b128 v[168:171], v7 offset:26144
    s_waitcnt lgkmcnt(6)
    v_mfma_f32_32x32x16_bf16 v[44:59], v[140:143], v[20:23], 0
    v_mfma_f32_32x32x16_bf16 v[44:59], v[144:147], v[24:27], v[44:59]
    s_waitcnt lgkmcnt(4)
    v_mfma_f32_32x32x16_bf16 v[60:75], v[148:151], v[20:23], 0
    v_mfma_f32_32x32x16_bf16 v[60:75], v[152:155], v[24:27], v[60:75]
    s_waitcnt lgkmcnt(2)
    v_mfma_f32_32x32x16_bf16 v[76:91], v[156:159], v[20:23], 0
    v_mfma_f32_32x32x16_bf16 v[76:91], v[160:163], v[24:27], v[76:91]
    s_waitcnt lgkmcnt(0)
    v_mfma_f32_32x32x16_bf16 v[92:107], v[164:167], v[20:23], 0
    v_mfma_f32_32x32x16_bf16 v[92:107], v[168:171], v[24:27], v[92:107]
    ds_read_b64_tr_b16 v[172:173], v8 offset:18432
    ds_read_b64_tr_b16 v[174:175], v8 offset:18944
    ds_read_b64_tr_b16 v[176:177], v8 offset:19456
    ds_read_b64_tr_b16 v[178:179], v8 offset:19968
    ds_read_b64_tr_b16 v[180:181], v8 offset:20480
    ds_read_b64_tr_b16 v[182:183], v8 offset:20992
    ds_read_b64_tr_b16 v[184:185], v8 offset:21504
    ds_read_b64_tr_b16 v[186:187], v8 offset:22016
    ds_read_b64_tr_b16 v[188:189], v8 offset:22528
    ds_read_b64_tr_b16 v[190:191], v8 offset:23040
    ds_read_b64_tr_b16 v[192:193], v8 offset:23552
    ds_read_b64_tr_b16 v[194:195], v8 offset:24064
    ds_read_b64_tr_b16 v[196:197], v8 offset:24576
    ds_read_b64_tr_b16 v[198:199], v8 offset:25088
    ds_read_b64_tr_b16 v[200:201], v8 offset:25600
    ds_read_b64_tr_b16 v[202:203], v8 offset:26112
    s_nop 7
    s_nop 3
    v_max3_f32 v1, v44, v45, v46
    v_max3_f32 v1, v1, v47, v48
    v_max3_f32 v1, v1, v49, v50
    v_max3_f32 v1, v1, v51, v52
    v_max3_f32 v1, v1, v53, v54
    v_max3_f32 v1, v1, v55, v56
    v_max3_f32 v1, v1, v57, v58
    v_max3_f32 v1, v1, v59, v60
    v_max3_f32 v1, v1, v61, v62
    v_max3_f32 v1, v1, v63, v64
    v_max3_f32 v1, v1, v65, v66
    v_max3_f32 v1, v1, v67, v68
    v_max3_f32 v1, v1, v69, v70
    v_max3_f32 v1, v1, v71, v72
    v_max3_f32 v1, v1, v73, v74
    v_max3_f32 v1, v1, v75, v76
    v_max3_f32 v1, v1, v77, v78
    v_max3_f32 v1, v1, v79, v80
    v_max3_f32 v1, v1, v81, v82
    v_max3_f32 v1, v1, v83, v84
    v_max3_f32 v1, v1, v85, v86
    v_max3_f32 v1, v1, v87, v88
    v_max3_f32 v1, v1, v89, v90
    v_max3_f32 v1, v1, v91, v92
    v_max3_f32 v1, v1, v93, v94
    v_max3_f32 v1, v1, v95, v96
    v_max3_f32 v1, v1, v97, v98
    v_max3_f32 v1, v1, v99, v100
    v_max3_f32 v1, v1, v101, v102
    v_max3_f32 v1, v1, v103, v104
    v_max3_f32 v1, v1, v105, v106
    v_max_f32 v1, v1, v107
    v_mov_b32 v2, v1
    s_nop 1
    v_permlane32_swap_b32 v1, v2
    v_max3_f32 v1, v1, v2, v9
    v_sub_f32 v2, v9, v1
    v_mul_f32 v2, s20, v2
    v_exp_f32 v2, v2
    v_mov_b32 v9, v1
    v_mul_f32 v10, s20, v1
    v_mul_f32 v28, v28, v2
    v_mul_f32 v29, v29, v2
    v_mul_f32 v30, v30, v2
    v_mul_f32 v31, v31, v2
    v_mul_f32 v32, v32, v2
    v_mul_f32 v33, v33, v2
    v_mul_f32 v34, v34, v2
    v_mul_f32 v35, v35, v2
    v_mul_f32 v36, v36, v2
    v_mul_f32 v37, v37, v2
    v_mul_f32 v38, v38, v2
    v_mul_f32 v39, v39, v2
    v_mul_f32 v40, v40, v2
    v_mul_f32 v41, v41, v2
    v_mul_f32 v42, v42, v2
    v_mul_f32 v43, v43, v2
    s_waitcnt lgkmcnt(0)
    v_fma_f32 v44, v44, s20, -v10
    v_fma_f32 v45, v45, s20, -v10
    v_fma_f32 v46, v46, s20, -v10
    v_fma_f32 v47, v47, s20, -v10
    v_fma_f32 v48, v48, s20, -v10
    v_fma_f32 v49, v49, s20, -v10
    v_fma_f32 v50, v50, s20, -v10
    v_fma_f32 v51, v51, s20, -v10
    v_exp_f32 v44, v44
    v_exp_f32 v45, v45
    v_exp_f32 v46, v46
    v_exp_f32 v47, v47
    v_exp_f32 v48, v48
    v_exp_f32 v49, v49
    v_exp_f32 v50, v50
    v_exp_f32 v51, v51
    s_nop 0
    v_cvt_pk_bf16_f32 v108, v44, v45
    v_cvt_pk_bf16_f32 v109, v46, v47
    v_cvt_pk_bf16_f32 v110, v48, v49
    v_cvt_pk_bf16_f32 v111, v50, v51
    s_nop 1
    v_mfma_f32_32x32x16_bf16 v[28:43], v[172:175], v[108:111], v[28:43]
    v_fma_f32 v52, v52, s20, -v10
    v_fma_f32 v53, v53, s20, -v10
    v_fma_f32 v54, v54, s20, -v10
    v_fma_f32 v55, v55, s20, -v10
    v_fma_f32 v56, v56, s20, -v10
    v_fma_f32 v57, v57, s20, -v10
    v_fma_f32 v58, v58, s20, -v10
    v_fma_f32 v59, v59, s20, -v10
    v_exp_f32 v52, v52
    v_exp_f32 v53, v53
    v_exp_f32 v54, v54
    v_exp_f32 v55, v55
    v_exp_f32 v56, v56
    v_exp_f32 v57, v57
    v_exp_f32 v58, v58
    v_exp_f32 v59, v59
    s_nop 0
    v_cvt_pk_bf16_f32 v112, v52, v53
    v_cvt_pk_bf16_f32 v113, v54, v55
    v_cvt_pk_bf16_f32 v114, v56, v57
    v_cvt_pk_bf16_f32 v115, v58, v59
    s_nop 1
    v_mfma_f32_32x32x16_bf16 v[28:43], v[176:179], v[112:115], v[28:43]
    v_fma_f32 v60, v60, s20, -v10
    v_fma_f32 v61, v61, s20, -v10
    v_fma_f32 v62, v62, s20, -v10
    v_fma_f32 v63, v63, s20, -v10
    v_fma_f32 v64, v64, s20, -v10
    v_fma_f32 v65, v65, s20, -v10
    v_fma_f32 v66, v66, s20, -v10
    v_fma_f32 v67, v67, s20, -v10
    v_exp_f32 v60, v60
    v_exp_f32 v61, v61
    v_exp_f32 v62, v62
    v_exp_f32 v63, v63
    v_exp_f32 v64, v64
    v_exp_f32 v65, v65
    v_exp_f32 v66, v66
    v_exp_f32 v67, v67
    s_nop 0
    v_cvt_pk_bf16_f32 v116, v60, v61
    v_cvt_pk_bf16_f32 v117, v62, v63
    v_cvt_pk_bf16_f32 v118, v64, v65
    v_cvt_pk_bf16_f32 v119, v66, v67
    s_nop 1
    v_mfma_f32_32x32x16_bf16 v[28:43], v[180:183], v[116:119], v[28:43]
    v_fma_f32 v68, v68, s20, -v10
    v_fma_f32 v69, v69, s20, -v10
    v_fma_f32 v70, v70, s20, -v10
    v_fma_f32 v71, v71, s20, -v10
    v_fma_f32 v72, v72, s20, -v10
    v_fma_f32 v73, v73, s20, -v10
    v_fma_f32 v74, v74, s20, -v10
    v_fma_f32 v75, v75, s20, -v10
    v_exp_f32 v68, v68
    v_exp_f32 v69, v69
    v_exp_f32 v70, v70
    v_exp_f32 v71, v71
    v_exp_f32 v72, v72
    v_exp_f32 v73, v73
    v_exp_f32 v74, v74
    v_exp_f32 v75, v75
    s_nop 0
    v_cvt_pk_bf16_f32 v120, v68, v69
    v_cvt_pk_bf16_f32 v121, v70, v71
    v_cvt_pk_bf16_f32 v122, v72, v73
    v_cvt_pk_bf16_f32 v123, v74, v75
    s_nop 1
    v_mfma_f32_32x32x16_bf16 v[28:43], v[184:187], v[120:123], v[28:43]
    v_fma_f32 v76, v76, s20, -v10
    v_fma_f32 v77, v77, s20, -v10
    v_fma_f32 v78, v78, s20, -v10
    v_fma_f32 v79, v79, s20, -v10
    v_fma_f32 v80, v80, s20, -v10
    v_fma_f32 v81, v81, s20, -v10
    v_fma_f32 v82, v82, s20, -v10
    v_fma_f32 v83, v83, s20, -v10
    v_exp_f32 v76, v76
    v_exp_f32 v77, v77
    v_exp_f32 v78, v78
    v_exp_f32 v79, v79
    v_exp_f32 v80, v80
    v_exp_f32 v81, v81
    v_exp_f32 v82, v82
    v_exp_f32 v83, v83
    s_nop 0
    v_cvt_pk_bf16_f32 v124, v76, v77
    v_cvt_pk_bf16_f32 v125, v78, v79
    v_cvt_pk_bf16_f32 v126, v80, v81
    v_cvt_pk_bf16_f32 v127, v82, v83
    s_nop 1
    v_mfma_f32_32x32x16_bf16 v[28:43], v[188:191], v[124:127], v[28:43]
    v_fma_f32 v84, v84, s20, -v10
    v_fma_f32 v85, v85, s20, -v10
    v_fma_f32 v86, v86, s20, -v10
    v_fma_f32 v87, v87, s20, -v10
    v_fma_f32 v88, v88, s20, -v10
    v_fma_f32 v89, v89, s20, -v10
    v_fma_f32 v90, v90, s20, -v10
    v_fma_f32 v91, v91, s20, -v10
    v_exp_f32 v84, v84
    v_exp_f32 v85, v85
    v_exp_f32 v86, v86
    v_exp_f32 v87, v87
    v_exp_f32 v88, v88
    v_exp_f32 v89, v89
    v_exp_f32 v90, v90
    v_exp_f32 v91, v91
    s_nop 0
    v_cvt_pk_bf16_f32 v128, v84, v85
    v_cvt_pk_bf16_f32 v129, v86, v87
    v_cvt_pk_bf16_f32 v130, v88, v89
    v_cvt_pk_bf16_f32 v131, v90, v91
    s_nop 1
    v_mfma_f32_32x32x16_bf16 v[28:43], v[192:195], v[128:131], v[28:43]
    v_fma_f32 v92, v92, s20, -v10
    v_fma_f32 v93, v93, s20, -v10
    v_fma_f32 v94, v94, s20, -v10
    v_fma_f32 v95, v95, s20, -v10
    v_fma_f32 v96, v96, s20, -v10
    v_fma_f32 v97, v97, s20, -v10
    v_fma_f32 v98, v98, s20, -v10
    v_fma_f32 v99, v99, s20, -v10
    v_exp_f32 v92, v92
    v_exp_f32 v93, v93
    v_exp_f32 v94, v94
    v_exp_f32 v95, v95
    v_exp_f32 v96, v96
    v_exp_f32 v97, v97
    v_exp_f32 v98, v98
    v_exp_f32 v99, v99
    s_nop 0
    v_cvt_pk_bf16_f32 v132, v92, v93
    v_cvt_pk_bf16_f32 v133, v94, v95
    v_cvt_pk_bf16_f32 v134, v96, v97
    v_cvt_pk_bf16_f32 v135, v98, v99
    s_nop 1
    v_mfma_f32_32x32x16_bf16 v[28:43], v[196:199], v[132:135], v[28:43]
    v_fma_f32 v100, v100, s20, -v10
    v_fma_f32 v101, v101, s20, -v10
    v_fma_f32 v102, v102, s20, -v10
    v_fma_f32 v103, v103, s20, -v10
    v_fma_f32 v104, v104, s20, -v10
    v_fma_f32 v105, v105, s20, -v10
    v_fma_f32 v106, v106, s20, -v10
    v_fma_f32 v107, v107, s20, -v10
    v_exp_f32 v100, v100
    v_exp_f32 v101, v101
    v_exp_f32 v102, v102
    v_exp_f32 v103, v103
    v_exp_f32 v104, v104
    v_exp_f32 v105, v105
    v_exp_f32 v106, v106
    v_exp_f32 v107, v107
    s_nop 0
    v_cvt_pk_bf16_f32 v136, v100, v101
    v_cvt_pk_bf16_f32 v137, v102, v103
    v_cvt_pk_bf16_f32 v138, v104, v105
    v_cvt_pk_bf16_f32 v139, v106, v107
    s_nop 1
    v_mfma_f32_32x32x16_bf16 v[28:43], v[200:203], v[136:139], v[28:43]
    s_waitcnt vmcnt(0)
    ds_write_b32 v5, v12 offset:0
    ds_write_b32 v5, v13 offset:16
    ds_write_b32 v206, v14 offset:32
    ds_write_b32 v6, v15 offset:0
    ds_write_b32 v6, v16 offset:16
    ds_write_b32 v207, v17 offset:32
    s_waitcnt lgkmcnt(0)
    s_barrier
    s_mov_b32 s21, 0x4a4000
    buffer_load_dword v12, v4, s[8:11], s21 offen offset:1152
    buffer_load_dword v13, v4, s[8:11], s21 offen offset:1168
    buffer_load_dword v14, v205, s[8:11], s21 offen offset:1184
    buffer_load_dword v15, v4, s[8:11], s21 offen offset:2304
    buffer_load_dword v16, v4, s[8:11], s21 offen offset:2320
    buffer_load_dword v17, v205, s[8:11], s21 offen offset:2336
    ds_read_b128 v[140:143], v7 offset:0
    ds_read_b128 v[144:147], v7 offset:32
    ds_read_b128 v[148:151], v7 offset:2560
    ds_read_b128 v[152:155], v7 offset:2592
    ds_read_b128 v[156:159], v7 offset:5120
    ds_read_b128 v[160:163], v7 offset:5152
    ds_read_b128 v[164:167], v7 offset:7680
    ds_read_b128 v[168:171], v7 offset:7712
    s_waitcnt lgkmcnt(6)
    v_mfma_f32_32x32x16_bf16 v[44:59], v[140:143], v[20:23], 0
    v_mfma_f32_32x32x16_bf16 v[44:59], v[144:147], v[24:27], v[44:59]
    s_waitcnt lgkmcnt(4)
    v_mfma_f32_32x32x16_bf16 v[60:75], v[148:151], v[20:23], 0
    v_mfma_f32_32x32x16_bf16 v[60:75], v[152:155], v[24:27], v[60:75]
    s_waitcnt lgkmcnt(2)
    v_mfma_f32_32x32x16_bf16 v[76:91], v[156:159], v[20:23], 0
    v_mfma_f32_32x32x16_bf16 v[76:91], v[160:163], v[24:27], v[76:91]
    s_waitcnt lgkmcnt(0)
    v_mfma_f32_32x32x16_bf16 v[92:107], v[164:167], v[20:23], 0
    v_mfma_f32_32x32x16_bf16 v[92:107], v[168:171], v[24:27], v[92:107]
    ds_read_b64_tr_b16 v[172:173], v8 offset:0
    ds_read_b64_tr_b16 v[174:175], v8 offset:512
    ds_read_b64_tr_b16 v[176:177], v8 offset:1024
    ds_read_b64_tr_b16 v[178:179], v8 offset:1536
    ds_read_b64_tr_b16 v[180:181], v8 offset:2048
    ds_read_b64_tr_b16 v[182:183], v8 offset:2560
    ds_read_b64_tr_b16 v[184:185], v8 offset:3072
    ds_read_b64_tr_b16 v[186:187], v8 offset:3584
    ds_read_b64_tr_b16 v[188:189], v8 offset:4096
    ds_read_b64_tr_b16 v[190:191], v8 offset:4608
    ds_read_b64_tr_b16 v[192:193], v8 offset:5120
    ds_read_b64_tr_b16 v[194:195], v8 offset:5632
    ds_read_b64_tr_b16 v[196:197], v8 offset:6144
    ds_read_b64_tr_b16 v[198:199], v8 offset:6656
    ds_read_b64_tr_b16 v[200:201], v8 offset:7168
    ds_read_b64_tr_b16 v[202:203], v8 offset:7680
    s_nop 7
    s_nop 3
    v_max3_f32 v1, v44, v45, v46
    v_max3_f32 v1, v1, v47, v48
    v_max3_f32 v1, v1, v49, v50
    v_max3_f32 v1, v1, v51, v52
    v_max3_f32 v1, v1, v53, v54
    v_max3_f32 v1, v1, v55, v56
    v_max3_f32 v1, v1, v57, v58
    v_max3_f32 v1, v1, v59, v60
    v_max3_f32 v1, v1, v61, v62
    v_max3_f32 v1, v1, v63, v64
    v_max3_f32 v1, v1, v65, v66
    v_max3_f32 v1, v1, v67, v68
    v_max3_f32 v1, v1, v69, v70
    v_max3_f32 v1, v1, v71, v72
    v_max3_f32 v1, v1, v73, v74
    v_max3_f32 v1, v1, v75, v76
    v_max3_f32 v1, v1, v77, v78
    v_max3_f32 v1, v1, v79, v80
    v_max3_f32 v1, v1, v81, v82
    v_max3_f32 v1, v1, v83, v84
    v_max3_f32 v1, v1, v85, v86
    v_max3_f32 v1, v1, v87, v88
    v_max3_f32 v1, v1, v89, v90
    v_max3_f32 v1, v1, v91, v92
    v_max3_f32 v1, v1, v93, v94
    v_max3_f32 v1, v1, v95, v96
    v_max3_f32 v1, v1, v97, v98
    v_max3_f32 v1, v1, v99, v100
    v_max3_f32 v1, v1, v101, v102
    v_max3_f32 v1, v1, v103, v104
    v_max3_f32 v1, v1, v105, v106
    v_max_f32 v1, v1, v107
    v_mov_b32 v2, v1
    s_nop 1
    v_permlane32_swap_b32 v1, v2
    v_max3_f32 v1, v1, v2, v9
    v_sub_f32 v2, v9, v1
    v_mul_f32 v2, s20, v2
    v_exp_f32 v2, v2
    v_mov_b32 v9, v1
    v_mul_f32 v10, s20, v1
    v_mul_f32 v28, v28, v2
    v_mul_f32 v29, v29, v2
    v_mul_f32 v30, v30, v2
    v_mul_f32 v31, v31, v2
    v_mul_f32 v32, v32, v2
    v_mul_f32 v33, v33, v2
    v_mul_f32 v34, v34, v2
    v_mul_f32 v35, v35, v2
    v_mul_f32 v36, v36, v2
    v_mul_f32 v37, v37, v2
    v_mul_f32 v38, v38, v2
    v_mul_f32 v39, v39, v2
    v_mul_f32 v40, v40, v2
    v_mul_f32 v41, v41, v2
    v_mul_f32 v42, v42, v2
    v_mul_f32 v43, v43, v2
    s_waitcnt lgkmcnt(0)
    v_fma_f32 v44, v44, s20, -v10
    v_fma_f32 v45, v45, s20, -v10
    v_fma_f32 v46, v46, s20, -v10
    v_fma_f32 v47, v47, s20, -v10
    v_fma_f32 v48, v48, s20, -v10
    v_fma_f32 v49, v49, s20, -v10
    v_fma_f32 v50, v50, s20, -v10
    v_fma_f32 v51, v51, s20, -v10
    v_exp_f32 v44, v44
    v_exp_f32 v45, v45
    v_exp_f32 v46, v46
    v_exp_f32 v47, v47
    v_exp_f32 v48, v48
    v_exp_f32 v49, v49
    v_exp_f32 v50, v50
    v_exp_f32 v51, v51
    s_nop 0
    v_cvt_pk_bf16_f32 v108, v44, v45
    v_cvt_pk_bf16_f32 v109, v46, v47
    v_cvt_pk_bf16_f32 v110, v48, v49
    v_cvt_pk_bf16_f32 v111, v50, v51
    s_nop 1
    v_mfma_f32_32x32x16_bf16 v[28:43], v[172:175], v[108:111], v[28:43]
    v_fma_f32 v52, v52, s20, -v10
    v_fma_f32 v53, v53, s20, -v10
    v_fma_f32 v54, v54, s20, -v10
    v_fma_f32 v55, v55, s20, -v10
    v_fma_f32 v56, v56, s20, -v10
    v_fma_f32 v57, v57, s20, -v10
    v_fma_f32 v58, v58, s20, -v10
    v_fma_f32 v59, v59, s20, -v10
    v_exp_f32 v52, v52
    v_exp_f32 v53, v53
    v_exp_f32 v54, v54
    v_exp_f32 v55, v55
    v_exp_f32 v56, v56
    v_exp_f32 v57, v57
    v_exp_f32 v58, v58
    v_exp_f32 v59, v59
    s_nop 0
    v_cvt_pk_bf16_f32 v112, v52, v53
    v_cvt_pk_bf16_f32 v113, v54, v55
    v_cvt_pk_bf16_f32 v114, v56, v57
    v_cvt_pk_bf16_f32 v115, v58, v59
    s_nop 1
    v_mfma_f32_32x32x16_bf16 v[28:43], v[176:179], v[112:115], v[28:43]
    v_fma_f32 v60, v60, s20, -v10
    v_fma_f32 v61, v61, s20, -v10
    v_fma_f32 v62, v62, s20, -v10
    v_fma_f32 v63, v63, s20, -v10
    v_fma_f32 v64, v64, s20, -v10
    v_fma_f32 v65, v65, s20, -v10
    v_fma_f32 v66, v66, s20, -v10
    v_fma_f32 v67, v67, s20, -v10
    v_exp_f32 v60, v60
    v_exp_f32 v61, v61
    v_exp_f32 v62, v62
    v_exp_f32 v63, v63
    v_exp_f32 v64, v64
    v_exp_f32 v65, v65
    v_exp_f32 v66, v66
    v_exp_f32 v67, v67
    s_nop 0
    v_cvt_pk_bf16_f32 v116, v60, v61
    v_cvt_pk_bf16_f32 v117, v62, v63
    v_cvt_pk_bf16_f32 v118, v64, v65
    v_cvt_pk_bf16_f32 v119, v66, v67
    s_nop 1
    v_mfma_f32_32x32x16_bf16 v[28:43], v[180:183], v[116:119], v[28:43]
    v_fma_f32 v68, v68, s20, -v10
    v_fma_f32 v69, v69, s20, -v10
    v_fma_f32 v70, v70, s20, -v10
    v_fma_f32 v71, v71, s20, -v10
    v_fma_f32 v72, v72, s20, -v10
    v_fma_f32 v73, v73, s20, -v10
    v_fma_f32 v74, v74, s20, -v10
    v_fma_f32 v75, v75, s20, -v10
    v_exp_f32 v68, v68
    v_exp_f32 v69, v69
    v_exp_f32 v70, v70
    v_exp_f32 v71, v71
    v_exp_f32 v72, v72
    v_exp_f32 v73, v73
    v_exp_f32 v74, v74
    v_exp_f32 v75, v75
    s_nop 0
    v_cvt_pk_bf16_f32 v120, v68, v69
    v_cvt_pk_bf16_f32 v121, v70, v71
    v_cvt_pk_bf16_f32 v122, v72, v73
    v_cvt_pk_bf16_f32 v123, v74, v75
    s_nop 1
    v_mfma_f32_32x32x16_bf16 v[28:43], v[184:187], v[120:123], v[28:43]
    v_fma_f32 v76, v76, s20, -v10
    v_fma_f32 v77, v77, s20, -v10
    v_fma_f32 v78, v78, s20, -v10
    v_fma_f32 v79, v79, s20, -v10
    v_fma_f32 v80, v80, s20, -v10
    v_fma_f32 v81, v81, s20, -v10
    v_fma_f32 v82, v82, s20, -v10
    v_fma_f32 v83, v83, s20, -v10
    v_exp_f32 v76, v76
    v_exp_f32 v77, v77
    v_exp_f32 v78, v78
    v_exp_f32 v79, v79
    v_exp_f32 v80, v80
    v_exp_f32 v81, v81
    v_exp_f32 v82, v82
    v_exp_f32 v83, v83
    s_nop 0
    v_cvt_pk_bf16_f32 v124, v76, v77
    v_cvt_pk_bf16_f32 v125, v78, v79
    v_cvt_pk_bf16_f32 v126, v80, v81
    v_cvt_pk_bf16_f32 v127, v82, v83
    s_nop 1
    v_mfma_f32_32x32x16_bf16 v[28:43], v[188:191], v[124:127], v[28:43]
    v_fma_f32 v84, v84, s20, -v10
    v_fma_f32 v85, v85, s20, -v10
    v_fma_f32 v86, v86, s20, -v10
    v_fma_f32 v87, v87, s20, -v10
    v_fma_f32 v88, v88, s20, -v10
    v_fma_f32 v89, v89, s20, -v10
    v_fma_f32 v90, v90, s20, -v10
    v_fma_f32 v91, v91, s20, -v10
    v_exp_f32 v84, v84
    v_exp_f32 v85, v85
    v_exp_f32 v86, v86
    v_exp_f32 v87, v87
    v_exp_f32 v88, v88
    v_exp_f32 v89, v89
    v_exp_f32 v90, v90
    v_exp_f32 v91, v91
    s_nop 0
    v_cvt_pk_bf16_f32 v128, v84, v85
    v_cvt_pk_bf16_f32 v129, v86, v87
    v_cvt_pk_bf16_f32 v130, v88, v89
    v_cvt_pk_bf16_f32 v131, v90, v91
    s_nop 1
    v_mfma_f32_32x32x16_bf16 v[28:43], v[192:195], v[128:131], v[28:43]
    v_fma_f32 v92, v92, s20, -v10
    v_fma_f32 v93, v93, s20, -v10
    v_fma_f32 v94, v94, s20, -v10
    v_fma_f32 v95, v95, s20, -v10
    v_fma_f32 v96, v96, s20, -v10
    v_fma_f32 v97, v97, s20, -v10
    v_fma_f32 v98, v98, s20, -v10
    v_fma_f32 v99, v99, s20, -v10
    v_exp_f32 v92, v92
    v_exp_f32 v93, v93
    v_exp_f32 v94, v94
    v_exp_f32 v95, v95
    v_exp_f32 v96, v96
    v_exp_f32 v97, v97
    v_exp_f32 v98, v98
    v_exp_f32 v99, v99
    s_nop 0
    v_cvt_pk_bf16_f32 v132, v92, v93
    v_cvt_pk_bf16_f32 v133, v94, v95
    v_cvt_pk_bf16_f32 v134, v96, v97
    v_cvt_pk_bf16_f32 v135, v98, v99
    s_nop 1
    v_mfma_f32_32x32x16_bf16 v[28:43], v[196:199], v[132:135], v[28:43]
    v_fma_f32 v100, v100, s20, -v10
    v_fma_f32 v101, v101, s20, -v10
    v_fma_f32 v102, v102, s20, -v10
    v_fma_f32 v103, v103, s20, -v10
    v_fma_f32 v104, v104, s20, -v10
    v_fma_f32 v105, v105, s20, -v10
    v_fma_f32 v106, v106, s20, -v10
    v_fma_f32 v107, v107, s20, -v10
    v_exp_f32 v100, v100
    v_exp_f32 v101, v101
    v_exp_f32 v102, v102
    v_exp_f32 v103, v103
    v_exp_f32 v104, v104
    v_exp_f32 v105, v105
    v_exp_f32 v106, v106
    v_exp_f32 v107, v107
    s_nop 0
    v_cvt_pk_bf16_f32 v136, v100, v101
    v_cvt_pk_bf16_f32 v137, v102, v103
    v_cvt_pk_bf16_f32 v138, v104, v105
    v_cvt_pk_bf16_f32 v139, v106, v107
    s_nop 1
    v_mfma_f32_32x32x16_bf16 v[28:43], v[200:203], v[136:139], v[28:43]
    s_waitcnt vmcnt(0)
    ds_write_b32 v5, v12 offset:18432
    ds_write_b32 v5, v13 offset:18448
    ds_write_b32 v206, v14 offset:18464
    ds_write_b32 v6, v15 offset:18432
    ds_write_b32 v6, v16 offset:18448
    ds_write_b32 v207, v17 offset:18464
    s_waitcnt lgkmcnt(0)
    s_barrier
    s_mov_b32 s21, 0x510000
    buffer_load_dword v12, v4, s[8:11], s21 offen offset:1152
    buffer_load_dword v13, v4, s[8:11], s21 offen offset:1168
    buffer_load_dword v14, v205, s[8:11], s21 offen offset:1184
    buffer_load_dword v15, v4, s[8:11], s21 offen offset:2304
    buffer_load_dword v16, v4, s[8:11], s21 offen offset:2320
    buffer_load_dword v17, v205, s[8:11], s21 offen offset:2336
    ds_read_b128 v[140:143], v7 offset:18432
    ds_read_b128 v[144:147], v7 offset:18464
    ds_read_b128 v[148:151], v7 offset:20992
    ds_read_b128 v[152:155], v7 offset:21024
    ds_read_b128 v[156:159], v7 offset:23552
    ds_read_b128 v[160:163], v7 offset:23584
    ds_read_b128 v[164:167], v7 offset:26112
    ds_read_b128 v[168:171], v7 offset:26144
    s_waitcnt lgkmcnt(6)
    v_mfma_f32_32x32x16_bf16 v[44:59], v[140:143], v[20:23], 0
    v_mfma_f32_32x32x16_bf16 v[44:59], v[144:147], v[24:27], v[44:59]
    s_waitcnt lgkmcnt(4)
    v_mfma_f32_32x32x16_bf16 v[60:75], v[148:151], v[20:23], 0
    v_mfma_f32_32x32x16_bf16 v[60:75], v[152:155], v[24:27], v[60:75]
    s_waitcnt lgkmcnt(2)
    v_mfma_f32_32x32x16_bf16 v[76:91], v[156:159], v[20:23], 0
    v_mfma_f32_32x32x16_bf16 v[76:91], v[160:163], v[24:27], v[76:91]
    s_waitcnt lgkmcnt(0)
    v_mfma_f32_32x32x16_bf16 v[92:107], v[164:167], v[20:23], 0
    v_mfma_f32_32x32x16_bf16 v[92:107], v[168:171], v[24:27], v[92:107]
    ds_read_b64_tr_b16 v[172:173], v8 offset:18432
    ds_read_b64_tr_b16 v[174:175], v8 offset:18944
    ds_read_b64_tr_b16 v[176:177], v8 offset:19456
    ds_read_b64_tr_b16 v[178:179], v8 offset:19968
    ds_read_b64_tr_b16 v[180:181], v8 offset:20480
    ds_read_b64_tr_b16 v[182:183], v8 offset:20992
    ds_read_b64_tr_b16 v[184:185], v8 offset:21504
    ds_read_b64_tr_b16 v[186:187], v8 offset:22016
    ds_read_b64_tr_b16 v[188:189], v8 offset:22528
    ds_read_b64_tr_b16 v[190:191], v8 offset:23040
    ds_read_b64_tr_b16 v[192:193], v8 offset:23552
    ds_read_b64_tr_b16 v[194:195], v8 offset:24064
    ds_read_b64_tr_b16 v[196:197], v8 offset:24576
    ds_read_b64_tr_b16 v[198:199], v8 offset:25088
    ds_read_b64_tr_b16 v[200:201], v8 offset:25600
    ds_read_b64_tr_b16 v[202:203], v8 offset:26112
    s_nop 7
    s_nop 3
    v_max3_f32 v1, v44, v45, v46
    v_max3_f32 v1, v1, v47, v48
    v_max3_f32 v1, v1, v49, v50
    v_max3_f32 v1, v1, v51, v52
    v_max3_f32 v1, v1, v53, v54
    v_max3_f32 v1, v1, v55, v56
    v_max3_f32 v1, v1, v57, v58
    v_max3_f32 v1, v1, v59, v60
    v_max3_f32 v1, v1, v61, v62
    v_max3_f32 v1, v1, v63, v64
    v_max3_f32 v1, v1, v65, v66
    v_max3_f32 v1, v1, v67, v68
    v_max3_f32 v1, v1, v69, v70
    v_max3_f32 v1, v1, v71, v72
    v_max3_f32 v1, v1, v73, v74
    v_max3_f32 v1, v1, v75, v76
    v_max3_f32 v1, v1, v77, v78
    v_max3_f32 v1, v1, v79, v80
    v_max3_f32 v1, v1, v81, v82
    v_max3_f32 v1, v1, v83, v84
    v_max3_f32 v1, v1, v85, v86
    v_max3_f32 v1, v1, v87, v88
    v_max3_f32 v1, v1, v89, v90
    v_max3_f32 v1, v1, v91, v92
    v_max3_f32 v1, v1, v93, v94
    v_max3_f32 v1, v1, v95, v96
    v_max3_f32 v1, v1, v97, v98
    v_max3_f32 v1, v1, v99, v100
    v_max3_f32 v1, v1, v101, v102
    v_max3_f32 v1, v1, v103, v104
    v_max3_f32 v1, v1, v105, v106
    v_max_f32 v1, v1, v107
    v_mov_b32 v2, v1
    s_nop 1
    v_permlane32_swap_b32 v1, v2
    v_max3_f32 v1, v1, v2, v9
    v_sub_f32 v2, v9, v1
    v_mul_f32 v2, s20, v2
    v_exp_f32 v2, v2
    v_mov_b32 v9, v1
    v_mul_f32 v10, s20, v1
    v_mul_f32 v28, v28, v2
    v_mul_f32 v29, v29, v2
    v_mul_f32 v30, v30, v2
    v_mul_f32 v31, v31, v2
    v_mul_f32 v32, v32, v2
    v_mul_f32 v33, v33, v2
    v_mul_f32 v34, v34, v2
    v_mul_f32 v35, v35, v2
    v_mul_f32 v36, v36, v2
    v_mul_f32 v37, v37, v2
    v_mul_f32 v38, v38, v2
    v_mul_f32 v39, v39, v2
    v_mul_f32 v40, v40, v2
    v_mul_f32 v41, v41, v2
    v_mul_f32 v42, v42, v2
    v_mul_f32 v43, v43, v2
    s_waitcnt lgkmcnt(0)
    v_fma_f32 v44, v44, s20, -v10
    v_fma_f32 v45, v45, s20, -v10
    v_fma_f32 v46, v46, s20, -v10
    v_fma_f32 v47, v47, s20, -v10
    v_fma_f32 v48, v48, s20, -v10
    v_fma_f32 v49, v49, s20, -v10
    v_fma_f32 v50, v50, s20, -v10
    v_fma_f32 v51, v51, s20, -v10
    v_exp_f32 v44, v44
    v_exp_f32 v45, v45
    v_exp_f32 v46, v46
    v_exp_f32 v47, v47
    v_exp_f32 v48, v48
    v_exp_f32 v49, v49
    v_exp_f32 v50, v50
    v_exp_f32 v51, v51
    s_nop 0
    v_cvt_pk_bf16_f32 v108, v44, v45
    v_cvt_pk_bf16_f32 v109, v46, v47
    v_cvt_pk_bf16_f32 v110, v48, v49
    v_cvt_pk_bf16_f32 v111, v50, v51
    s_nop 1
    v_mfma_f32_32x32x16_bf16 v[28:43], v[172:175], v[108:111], v[28:43]
    v_fma_f32 v52, v52, s20, -v10
    v_fma_f32 v53, v53, s20, -v10
    v_fma_f32 v54, v54, s20, -v10
    v_fma_f32 v55, v55, s20, -v10
    v_fma_f32 v56, v56, s20, -v10
    v_fma_f32 v57, v57, s20, -v10
    v_fma_f32 v58, v58, s20, -v10
    v_fma_f32 v59, v59, s20, -v10
    v_exp_f32 v52, v52
    v_exp_f32 v53, v53
    v_exp_f32 v54, v54
    v_exp_f32 v55, v55
    v_exp_f32 v56, v56
    v_exp_f32 v57, v57
    v_exp_f32 v58, v58
    v_exp_f32 v59, v59
    s_nop 0
    v_cvt_pk_bf16_f32 v112, v52, v53
    v_cvt_pk_bf16_f32 v113, v54, v55
    v_cvt_pk_bf16_f32 v114, v56, v57
    v_cvt_pk_bf16_f32 v115, v58, v59
    s_nop 1
    v_mfma_f32_32x32x16_bf16 v[28:43], v[176:179], v[112:115], v[28:43]
    v_fma_f32 v60, v60, s20, -v10
    v_fma_f32 v61, v61, s20, -v10
    v_fma_f32 v62, v62, s20, -v10
    v_fma_f32 v63, v63, s20, -v10
    v_fma_f32 v64, v64, s20, -v10
    v_fma_f32 v65, v65, s20, -v10
    v_fma_f32 v66, v66, s20, -v10
    v_fma_f32 v67, v67, s20, -v10
    v_exp_f32 v60, v60
    v_exp_f32 v61, v61
    v_exp_f32 v62, v62
    v_exp_f32 v63, v63
    v_exp_f32 v64, v64
    v_exp_f32 v65, v65
    v_exp_f32 v66, v66
    v_exp_f32 v67, v67
    s_nop 0
    v_cvt_pk_bf16_f32 v116, v60, v61
    v_cvt_pk_bf16_f32 v117, v62, v63
    v_cvt_pk_bf16_f32 v118, v64, v65
    v_cvt_pk_bf16_f32 v119, v66, v67
    s_nop 1
    v_mfma_f32_32x32x16_bf16 v[28:43], v[180:183], v[116:119], v[28:43]
    v_fma_f32 v68, v68, s20, -v10
    v_fma_f32 v69, v69, s20, -v10
    v_fma_f32 v70, v70, s20, -v10
    v_fma_f32 v71, v71, s20, -v10
    v_fma_f32 v72, v72, s20, -v10
    v_fma_f32 v73, v73, s20, -v10
    v_fma_f32 v74, v74, s20, -v10
    v_fma_f32 v75, v75, s20, -v10
    v_exp_f32 v68, v68
    v_exp_f32 v69, v69
    v_exp_f32 v70, v70
    v_exp_f32 v71, v71
    v_exp_f32 v72, v72
    v_exp_f32 v73, v73
    v_exp_f32 v74, v74
    v_exp_f32 v75, v75
    s_nop 0
    v_cvt_pk_bf16_f32 v120, v68, v69
    v_cvt_pk_bf16_f32 v121, v70, v71
    v_cvt_pk_bf16_f32 v122, v72, v73
    v_cvt_pk_bf16_f32 v123, v74, v75
    s_nop 1
    v_mfma_f32_32x32x16_bf16 v[28:43], v[184:187], v[120:123], v[28:43]
    v_fma_f32 v76, v76, s20, -v10
    v_fma_f32 v77, v77, s20, -v10
    v_fma_f32 v78, v78, s20, -v10
    v_fma_f32 v79, v79, s20, -v10
    v_fma_f32 v80, v80, s20, -v10
    v_fma_f32 v81, v81, s20, -v10
    v_fma_f32 v82, v82, s20, -v10
    v_fma_f32 v83, v83, s20, -v10
    v_exp_f32 v76, v76
    v_exp_f32 v77, v77
    v_exp_f32 v78, v78
    v_exp_f32 v79, v79
    v_exp_f32 v80, v80
    v_exp_f32 v81, v81
    v_exp_f32 v82, v82
    v_exp_f32 v83, v83
    s_nop 0
    v_cvt_pk_bf16_f32 v124, v76, v77
    v_cvt_pk_bf16_f32 v125, v78, v79
    v_cvt_pk_bf16_f32 v126, v80, v81
    v_cvt_pk_bf16_f32 v127, v82, v83
    s_nop 1
    v_mfma_f32_32x32x16_bf16 v[28:43], v[188:191], v[124:127], v[28:43]
    v_fma_f32 v84, v84, s20, -v10
    v_fma_f32 v85, v85, s20, -v10
    v_fma_f32 v86, v86, s20, -v10
    v_fma_f32 v87, v87, s20, -v10
    v_fma_f32 v88, v88, s20, -v10
    v_fma_f32 v89, v89, s20, -v10
    v_fma_f32 v90, v90, s20, -v10
    v_fma_f32 v91, v91, s20, -v10
    v_exp_f32 v84, v84
    v_exp_f32 v85, v85
    v_exp_f32 v86, v86
    v_exp_f32 v87, v87
    v_exp_f32 v88, v88
    v_exp_f32 v89, v89
    v_exp_f32 v90, v90
    v_exp_f32 v91, v91
    s_nop 0
    v_cvt_pk_bf16_f32 v128, v84, v85
    v_cvt_pk_bf16_f32 v129, v86, v87
    v_cvt_pk_bf16_f32 v130, v88, v89
    v_cvt_pk_bf16_f32 v131, v90, v91
    s_nop 1
    v_mfma_f32_32x32x16_bf16 v[28:43], v[192:195], v[128:131], v[28:43]
    v_fma_f32 v92, v92, s20, -v10
    v_fma_f32 v93, v93, s20, -v10
    v_fma_f32 v94, v94, s20, -v10
    v_fma_f32 v95, v95, s20, -v10
    v_fma_f32 v96, v96, s20, -v10
    v_fma_f32 v97, v97, s20, -v10
    v_fma_f32 v98, v98, s20, -v10
    v_fma_f32 v99, v99, s20, -v10
    v_exp_f32 v92, v92
    v_exp_f32 v93, v93
    v_exp_f32 v94, v94
    v_exp_f32 v95, v95
    v_exp_f32 v96, v96
    v_exp_f32 v97, v97
    v_exp_f32 v98, v98
    v_exp_f32 v99, v99
    s_nop 0
    v_cvt_pk_bf16_f32 v132, v92, v93
    v_cvt_pk_bf16_f32 v133, v94, v95
    v_cvt_pk_bf16_f32 v134, v96, v97
    v_cvt_pk_bf16_f32 v135, v98, v99
    s_nop 1
    v_mfma_f32_32x32x16_bf16 v[28:43], v[196:199], v[132:135], v[28:43]
    v_fma_f32 v100, v100, s20, -v10
    v_fma_f32 v101, v101, s20, -v10
    v_fma_f32 v102, v102, s20, -v10
    v_fma_f32 v103, v103, s20, -v10
    v_fma_f32 v104, v104, s20, -v10
    v_fma_f32 v105, v105, s20, -v10
    v_fma_f32 v106, v106, s20, -v10
    v_fma_f32 v107, v107, s20, -v10
    v_exp_f32 v100, v100
    v_exp_f32 v101, v101
    v_exp_f32 v102, v102
    v_exp_f32 v103, v103
    v_exp_f32 v104, v104
    v_exp_f32 v105, v105
    v_exp_f32 v106, v106
    v_exp_f32 v107, v107
    s_nop 0
    v_cvt_pk_bf16_f32 v136, v100, v101
    v_cvt_pk_bf16_f32 v137, v102, v103
    v_cvt_pk_bf16_f32 v138, v104, v105
    v_cvt_pk_bf16_f32 v139, v106, v107
    s_nop 1
    v_mfma_f32_32x32x16_bf16 v[28:43], v[200:203], v[136:139], v[28:43]
    s_waitcnt vmcnt(0)
    ds_write_b32 v5, v12 offset:0
    ds_write_b32 v5, v13 offset:16
    ds_write_b32 v206, v14 offset:32
    ds_write_b32 v6, v15 offset:0
    ds_write_b32 v6, v16 offset:16
    ds_write_b32 v207, v17 offset:32
    s_waitcnt lgkmcnt(0)
    s_barrier
    s_mov_b32 s21, 0x57c000
    buffer_load_dword v12, v4, s[8:11], s21 offen offset:1152
    buffer_load_dword v13, v4, s[8:11], s21 offen offset:1168
    buffer_load_dword v14, v205, s[8:11], s21 offen offset:1184
    buffer_load_dword v15, v4, s[8:11], s21 offen offset:2304
    buffer_load_dword v16, v4, s[8:11], s21 offen offset:2320
    buffer_load_dword v17, v205, s[8:11], s21 offen offset:2336
    ds_read_b128 v[140:143], v7 offset:0
    ds_read_b128 v[144:147], v7 offset:32
    ds_read_b128 v[148:151], v7 offset:2560
    ds_read_b128 v[152:155], v7 offset:2592
    ds_read_b128 v[156:159], v7 offset:5120
    ds_read_b128 v[160:163], v7 offset:5152
    ds_read_b128 v[164:167], v7 offset:7680
    ds_read_b128 v[168:171], v7 offset:7712
    s_waitcnt lgkmcnt(6)
    v_mfma_f32_32x32x16_bf16 v[44:59], v[140:143], v[20:23], 0
    v_mfma_f32_32x32x16_bf16 v[44:59], v[144:147], v[24:27], v[44:59]
    s_waitcnt lgkmcnt(4)
    v_mfma_f32_32x32x16_bf16 v[60:75], v[148:151], v[20:23], 0
    v_mfma_f32_32x32x16_bf16 v[60:75], v[152:155], v[24:27], v[60:75]
    s_waitcnt lgkmcnt(2)
    v_mfma_f32_32x32x16_bf16 v[76:91], v[156:159], v[20:23], 0
    v_mfma_f32_32x32x16_bf16 v[76:91], v[160:163], v[24:27], v[76:91]
    s_waitcnt lgkmcnt(0)
    v_mfma_f32_32x32x16_bf16 v[92:107], v[164:167], v[20:23], 0
    v_mfma_f32_32x32x16_bf16 v[92:107], v[168:171], v[24:27], v[92:107]
    ds_read_b64_tr_b16 v[172:173], v8 offset:0
    ds_read_b64_tr_b16 v[174:175], v8 offset:512
    ds_read_b64_tr_b16 v[176:177], v8 offset:1024
    ds_read_b64_tr_b16 v[178:179], v8 offset:1536
    ds_read_b64_tr_b16 v[180:181], v8 offset:2048
    ds_read_b64_tr_b16 v[182:183], v8 offset:2560
    ds_read_b64_tr_b16 v[184:185], v8 offset:3072
    ds_read_b64_tr_b16 v[186:187], v8 offset:3584
    ds_read_b64_tr_b16 v[188:189], v8 offset:4096
    ds_read_b64_tr_b16 v[190:191], v8 offset:4608
    ds_read_b64_tr_b16 v[192:193], v8 offset:5120
    ds_read_b64_tr_b16 v[194:195], v8 offset:5632
    ds_read_b64_tr_b16 v[196:197], v8 offset:6144
    ds_read_b64_tr_b16 v[198:199], v8 offset:6656
    ds_read_b64_tr_b16 v[200:201], v8 offset:7168
    ds_read_b64_tr_b16 v[202:203], v8 offset:7680
    s_nop 7
    s_nop 3
    v_max3_f32 v1, v44, v45, v46
    v_max3_f32 v1, v1, v47, v48
    v_max3_f32 v1, v1, v49, v50
    v_max3_f32 v1, v1, v51, v52
    v_max3_f32 v1, v1, v53, v54
    v_max3_f32 v1, v1, v55, v56
    v_max3_f32 v1, v1, v57, v58
    v_max3_f32 v1, v1, v59, v60
    v_max3_f32 v1, v1, v61, v62
    v_max3_f32 v1, v1, v63, v64
    v_max3_f32 v1, v1, v65, v66
    v_max3_f32 v1, v1, v67, v68
    v_max3_f32 v1, v1, v69, v70
    v_max3_f32 v1, v1, v71, v72
    v_max3_f32 v1, v1, v73, v74
    v_max3_f32 v1, v1, v75, v76
    v_max3_f32 v1, v1, v77, v78
    v_max3_f32 v1, v1, v79, v80
    v_max3_f32 v1, v1, v81, v82
    v_max3_f32 v1, v1, v83, v84
    v_max3_f32 v1, v1, v85, v86
    v_max3_f32 v1, v1, v87, v88
    v_max3_f32 v1, v1, v89, v90
    v_max3_f32 v1, v1, v91, v92
    v_max3_f32 v1, v1, v93, v94
    v_max3_f32 v1, v1, v95, v96
    v_max3_f32 v1, v1, v97, v98
    v_max3_f32 v1, v1, v99, v100
    v_max3_f32 v1, v1, v101, v102
    v_max3_f32 v1, v1, v103, v104
    v_max3_f32 v1, v1, v105, v106
    v_max_f32 v1, v1, v107
    v_mov_b32 v2, v1
    s_nop 1
    v_permlane32_swap_b32 v1, v2
    v_max3_f32 v1, v1, v2, v9
    v_sub_f32 v2, v9, v1
    v_mul_f32 v2, s20, v2
    v_exp_f32 v2, v2
    v_mov_b32 v9, v1
    v_mul_f32 v10, s20, v1
    v_mul_f32 v28, v28, v2
    v_mul_f32 v29, v29, v2
    v_mul_f32 v30, v30, v2
    v_mul_f32 v31, v31, v2
    v_mul_f32 v32, v32, v2
    v_mul_f32 v33, v33, v2
    v_mul_f32 v34, v34, v2
    v_mul_f32 v35, v35, v2
    v_mul_f32 v36, v36, v2
    v_mul_f32 v37, v37, v2
    v_mul_f32 v38, v38, v2
    v_mul_f32 v39, v39, v2
    v_mul_f32 v40, v40, v2
    v_mul_f32 v41, v41, v2
    v_mul_f32 v42, v42, v2
    v_mul_f32 v43, v43, v2
    s_waitcnt lgkmcnt(0)
    v_fma_f32 v44, v44, s20, -v10
    v_fma_f32 v45, v45, s20, -v10
    v_fma_f32 v46, v46, s20, -v10
    v_fma_f32 v47, v47, s20, -v10
    v_fma_f32 v48, v48, s20, -v10
    v_fma_f32 v49, v49, s20, -v10
    v_fma_f32 v50, v50, s20, -v10
    v_fma_f32 v51, v51, s20, -v10
    v_exp_f32 v44, v44
    v_exp_f32 v45, v45
    v_exp_f32 v46, v46
    v_exp_f32 v47, v47
    v_exp_f32 v48, v48
    v_exp_f32 v49, v49
    v_exp_f32 v50, v50
    v_exp_f32 v51, v51
    s_nop 0
    v_cvt_pk_bf16_f32 v108, v44, v45
    v_cvt_pk_bf16_f32 v109, v46, v47
    v_cvt_pk_bf16_f32 v110, v48, v49
    v_cvt_pk_bf16_f32 v111, v50, v51
    s_nop 1
    v_mfma_f32_32x32x16_bf16 v[28:43], v[172:175], v[108:111], v[28:43]
    v_fma_f32 v52, v52, s20, -v10
    v_fma_f32 v53, v53, s20, -v10
    v_fma_f32 v54, v54, s20, -v10
    v_fma_f32 v55, v55, s20, -v10
    v_fma_f32 v56, v56, s20, -v10
    v_fma_f32 v57, v57, s20, -v10
    v_fma_f32 v58, v58, s20, -v10
    v_fma_f32 v59, v59, s20, -v10
    v_exp_f32 v52, v52
    v_exp_f32 v53, v53
    v_exp_f32 v54, v54
    v_exp_f32 v55, v55
    v_exp_f32 v56, v56
    v_exp_f32 v57, v57
    v_exp_f32 v58, v58
    v_exp_f32 v59, v59
    s_nop 0
    v_cvt_pk_bf16_f32 v112, v52, v53
    v_cvt_pk_bf16_f32 v113, v54, v55
    v_cvt_pk_bf16_f32 v114, v56, v57
    v_cvt_pk_bf16_f32 v115, v58, v59
    s_nop 1
    v_mfma_f32_32x32x16_bf16 v[28:43], v[176:179], v[112:115], v[28:43]
    v_fma_f32 v60, v60, s20, -v10
    v_fma_f32 v61, v61, s20, -v10
    v_fma_f32 v62, v62, s20, -v10
    v_fma_f32 v63, v63, s20, -v10
    v_fma_f32 v64, v64, s20, -v10
    v_fma_f32 v65, v65, s20, -v10
    v_fma_f32 v66, v66, s20, -v10
    v_fma_f32 v67, v67, s20, -v10
    v_exp_f32 v60, v60
    v_exp_f32 v61, v61
    v_exp_f32 v62, v62
    v_exp_f32 v63, v63
    v_exp_f32 v64, v64
    v_exp_f32 v65, v65
    v_exp_f32 v66, v66
    v_exp_f32 v67, v67
    s_nop 0
    v_cvt_pk_bf16_f32 v116, v60, v61
    v_cvt_pk_bf16_f32 v117, v62, v63
    v_cvt_pk_bf16_f32 v118, v64, v65
    v_cvt_pk_bf16_f32 v119, v66, v67
    s_nop 1
    v_mfma_f32_32x32x16_bf16 v[28:43], v[180:183], v[116:119], v[28:43]
    v_fma_f32 v68, v68, s20, -v10
    v_fma_f32 v69, v69, s20, -v10
    v_fma_f32 v70, v70, s20, -v10
    v_fma_f32 v71, v71, s20, -v10
    v_fma_f32 v72, v72, s20, -v10
    v_fma_f32 v73, v73, s20, -v10
    v_fma_f32 v74, v74, s20, -v10
    v_fma_f32 v75, v75, s20, -v10
    v_exp_f32 v68, v68
    v_exp_f32 v69, v69
    v_exp_f32 v70, v70
    v_exp_f32 v71, v71
    v_exp_f32 v72, v72
    v_exp_f32 v73, v73
    v_exp_f32 v74, v74
    v_exp_f32 v75, v75
    s_nop 0
    v_cvt_pk_bf16_f32 v120, v68, v69
    v_cvt_pk_bf16_f32 v121, v70, v71
    v_cvt_pk_bf16_f32 v122, v72, v73
    v_cvt_pk_bf16_f32 v123, v74, v75
    s_nop 1
    v_mfma_f32_32x32x16_bf16 v[28:43], v[184:187], v[120:123], v[28:43]
    v_fma_f32 v76, v76, s20, -v10
    v_fma_f32 v77, v77, s20, -v10
    v_fma_f32 v78, v78, s20, -v10
    v_fma_f32 v79, v79, s20, -v10
    v_fma_f32 v80, v80, s20, -v10
    v_fma_f32 v81, v81, s20, -v10
    v_fma_f32 v82, v82, s20, -v10
    v_fma_f32 v83, v83, s20, -v10
    v_exp_f32 v76, v76
    v_exp_f32 v77, v77
    v_exp_f32 v78, v78
    v_exp_f32 v79, v79
    v_exp_f32 v80, v80
    v_exp_f32 v81, v81
    v_exp_f32 v82, v82
    v_exp_f32 v83, v83
    s_nop 0
    v_cvt_pk_bf16_f32 v124, v76, v77
    v_cvt_pk_bf16_f32 v125, v78, v79
    v_cvt_pk_bf16_f32 v126, v80, v81
    v_cvt_pk_bf16_f32 v127, v82, v83
    s_nop 1
    v_mfma_f32_32x32x16_bf16 v[28:43], v[188:191], v[124:127], v[28:43]
    v_fma_f32 v84, v84, s20, -v10
    v_fma_f32 v85, v85, s20, -v10
    v_fma_f32 v86, v86, s20, -v10
    v_fma_f32 v87, v87, s20, -v10
    v_fma_f32 v88, v88, s20, -v10
    v_fma_f32 v89, v89, s20, -v10
    v_fma_f32 v90, v90, s20, -v10
    v_fma_f32 v91, v91, s20, -v10
    v_exp_f32 v84, v84
    v_exp_f32 v85, v85
    v_exp_f32 v86, v86
    v_exp_f32 v87, v87
    v_exp_f32 v88, v88
    v_exp_f32 v89, v89
    v_exp_f32 v90, v90
    v_exp_f32 v91, v91
    s_nop 0
    v_cvt_pk_bf16_f32 v128, v84, v85
    v_cvt_pk_bf16_f32 v129, v86, v87
    v_cvt_pk_bf16_f32 v130, v88, v89
    v_cvt_pk_bf16_f32 v131, v90, v91
    s_nop 1
    v_mfma_f32_32x32x16_bf16 v[28:43], v[192:195], v[128:131], v[28:43]
    v_fma_f32 v92, v92, s20, -v10
    v_fma_f32 v93, v93, s20, -v10
    v_fma_f32 v94, v94, s20, -v10
    v_fma_f32 v95, v95, s20, -v10
    v_fma_f32 v96, v96, s20, -v10
    v_fma_f32 v97, v97, s20, -v10
    v_fma_f32 v98, v98, s20, -v10
    v_fma_f32 v99, v99, s20, -v10
    v_exp_f32 v92, v92
    v_exp_f32 v93, v93
    v_exp_f32 v94, v94
    v_exp_f32 v95, v95
    v_exp_f32 v96, v96
    v_exp_f32 v97, v97
    v_exp_f32 v98, v98
    v_exp_f32 v99, v99
    s_nop 0
    v_cvt_pk_bf16_f32 v132, v92, v93
    v_cvt_pk_bf16_f32 v133, v94, v95
    v_cvt_pk_bf16_f32 v134, v96, v97
    v_cvt_pk_bf16_f32 v135, v98, v99
    s_nop 1
    v_mfma_f32_32x32x16_bf16 v[28:43], v[196:199], v[132:135], v[28:43]
    v_fma_f32 v100, v100, s20, -v10
    v_fma_f32 v101, v101, s20, -v10
    v_fma_f32 v102, v102, s20, -v10
    v_fma_f32 v103, v103, s20, -v10
    v_fma_f32 v104, v104, s20, -v10
    v_fma_f32 v105, v105, s20, -v10
    v_fma_f32 v106, v106, s20, -v10
    v_fma_f32 v107, v107, s20, -v10
    v_exp_f32 v100, v100
    v_exp_f32 v101, v101
    v_exp_f32 v102, v102
    v_exp_f32 v103, v103
    v_exp_f32 v104, v104
    v_exp_f32 v105, v105
    v_exp_f32 v106, v106
    v_exp_f32 v107, v107
    s_nop 0
    v_cvt_pk_bf16_f32 v136, v100, v101
    v_cvt_pk_bf16_f32 v137, v102, v103
    v_cvt_pk_bf16_f32 v138, v104, v105
    v_cvt_pk_bf16_f32 v139, v106, v107
    s_nop 1
    v_mfma_f32_32x32x16_bf16 v[28:43], v[200:203], v[136:139], v[28:43]
    s_waitcnt vmcnt(0)
    ds_write_b32 v5, v12 offset:18432
    ds_write_b32 v5, v13 offset:18448
    ds_write_b32 v206, v14 offset:18464
    ds_write_b32 v6, v15 offset:18432
    ds_write_b32 v6, v16 offset:18448
    ds_write_b32 v207, v17 offset:18464
    s_waitcnt lgkmcnt(0)
    s_barrier
    s_mov_b32 s21, 0x5e8000
    buffer_load_dword v12, v4, s[8:11], s21 offen offset:1152
    buffer_load_dword v13, v4, s[8:11], s21 offen offset:1168
    buffer_load_dword v14, v205, s[8:11], s21 offen offset:1184
    buffer_load_dword v15, v4, s[8:11], s21 offen offset:2304
    buffer_load_dword v16, v4, s[8:11], s21 offen offset:2320
    buffer_load_dword v17, v205, s[8:11], s21 offen offset:2336
    ds_read_b128 v[140:143], v7 offset:18432
    ds_read_b128 v[144:147], v7 offset:18464
    ds_read_b128 v[148:151], v7 offset:20992
    ds_read_b128 v[152:155], v7 offset:21024
    ds_read_b128 v[156:159], v7 offset:23552
    ds_read_b128 v[160:163], v7 offset:23584
    ds_read_b128 v[164:167], v7 offset:26112
    ds_read_b128 v[168:171], v7 offset:26144
    s_waitcnt lgkmcnt(6)
    v_mfma_f32_32x32x16_bf16 v[44:59], v[140:143], v[20:23], 0
    v_mfma_f32_32x32x16_bf16 v[44:59], v[144:147], v[24:27], v[44:59]
    s_waitcnt lgkmcnt(4)
    v_mfma_f32_32x32x16_bf16 v[60:75], v[148:151], v[20:23], 0
    v_mfma_f32_32x32x16_bf16 v[60:75], v[152:155], v[24:27], v[60:75]
    s_waitcnt lgkmcnt(2)
    v_mfma_f32_32x32x16_bf16 v[76:91], v[156:159], v[20:23], 0
    v_mfma_f32_32x32x16_bf16 v[76:91], v[160:163], v[24:27], v[76:91]
    s_waitcnt lgkmcnt(0)
    v_mfma_f32_32x32x16_bf16 v[92:107], v[164:167], v[20:23], 0
    v_mfma_f32_32x32x16_bf16 v[92:107], v[168:171], v[24:27], v[92:107]
    ds_read_b64_tr_b16 v[172:173], v8 offset:18432
    ds_read_b64_tr_b16 v[174:175], v8 offset:18944
    ds_read_b64_tr_b16 v[176:177], v8 offset:19456
    ds_read_b64_tr_b16 v[178:179], v8 offset:19968
    ds_read_b64_tr_b16 v[180:181], v8 offset:20480
    ds_read_b64_tr_b16 v[182:183], v8 offset:20992
    ds_read_b64_tr_b16 v[184:185], v8 offset:21504
    ds_read_b64_tr_b16 v[186:187], v8 offset:22016
    ds_read_b64_tr_b16 v[188:189], v8 offset:22528
    ds_read_b64_tr_b16 v[190:191], v8 offset:23040
    ds_read_b64_tr_b16 v[192:193], v8 offset:23552
    ds_read_b64_tr_b16 v[194:195], v8 offset:24064
    ds_read_b64_tr_b16 v[196:197], v8 offset:24576
    ds_read_b64_tr_b16 v[198:199], v8 offset:25088
    ds_read_b64_tr_b16 v[200:201], v8 offset:25600
    ds_read_b64_tr_b16 v[202:203], v8 offset:26112
    s_nop 7
    s_nop 3
    v_max3_f32 v1, v44, v45, v46
    v_max3_f32 v1, v1, v47, v48
    v_max3_f32 v1, v1, v49, v50
    v_max3_f32 v1, v1, v51, v52
    v_max3_f32 v1, v1, v53, v54
    v_max3_f32 v1, v1, v55, v56
    v_max3_f32 v1, v1, v57, v58
    v_max3_f32 v1, v1, v59, v60
    v_max3_f32 v1, v1, v61, v62
    v_max3_f32 v1, v1, v63, v64
    v_max3_f32 v1, v1, v65, v66
    v_max3_f32 v1, v1, v67, v68
    v_max3_f32 v1, v1, v69, v70
    v_max3_f32 v1, v1, v71, v72
    v_max3_f32 v1, v1, v73, v74
    v_max3_f32 v1, v1, v75, v76
    v_max3_f32 v1, v1, v77, v78
    v_max3_f32 v1, v1, v79, v80
    v_max3_f32 v1, v1, v81, v82
    v_max3_f32 v1, v1, v83, v84
    v_max3_f32 v1, v1, v85, v86
    v_max3_f32 v1, v1, v87, v88
    v_max3_f32 v1, v1, v89, v90
    v_max3_f32 v1, v1, v91, v92
    v_max3_f32 v1, v1, v93, v94
    v_max3_f32 v1, v1, v95, v96
    v_max3_f32 v1, v1, v97, v98
    v_max3_f32 v1, v1, v99, v100
    v_max3_f32 v1, v1, v101, v102
    v_max3_f32 v1, v1, v103, v104
    v_max3_f32 v1, v1, v105, v106
    v_max_f32 v1, v1, v107
    v_mov_b32 v2, v1
    s_nop 1
    v_permlane32_swap_b32 v1, v2
    v_max3_f32 v1, v1, v2, v9
    v_sub_f32 v2, v9, v1
    v_mul_f32 v2, s20, v2
    v_exp_f32 v2, v2
    v_mov_b32 v9, v1
    v_mul_f32 v10, s20, v1
    v_mul_f32 v28, v28, v2
    v_mul_f32 v29, v29, v2
    v_mul_f32 v30, v30, v2
    v_mul_f32 v31, v31, v2
    v_mul_f32 v32, v32, v2
    v_mul_f32 v33, v33, v2
    v_mul_f32 v34, v34, v2
    v_mul_f32 v35, v35, v2
    v_mul_f32 v36, v36, v2
    v_mul_f32 v37, v37, v2
    v_mul_f32 v38, v38, v2
    v_mul_f32 v39, v39, v2
    v_mul_f32 v40, v40, v2
    v_mul_f32 v41, v41, v2
    v_mul_f32 v42, v42, v2
    v_mul_f32 v43, v43, v2
    s_waitcnt lgkmcnt(0)
    v_fma_f32 v44, v44, s20, -v10
    v_fma_f32 v45, v45, s20, -v10
    v_fma_f32 v46, v46, s20, -v10
    v_fma_f32 v47, v47, s20, -v10
    v_fma_f32 v48, v48, s20, -v10
    v_fma_f32 v49, v49, s20, -v10
    v_fma_f32 v50, v50, s20, -v10
    v_fma_f32 v51, v51, s20, -v10
    v_exp_f32 v44, v44
    v_exp_f32 v45, v45
    v_exp_f32 v46, v46
    v_exp_f32 v47, v47
    v_exp_f32 v48, v48
    v_exp_f32 v49, v49
    v_exp_f32 v50, v50
    v_exp_f32 v51, v51
    s_nop 0
    v_cvt_pk_bf16_f32 v108, v44, v45
    v_cvt_pk_bf16_f32 v109, v46, v47
    v_cvt_pk_bf16_f32 v110, v48, v49
    v_cvt_pk_bf16_f32 v111, v50, v51
    s_nop 1
    v_mfma_f32_32x32x16_bf16 v[28:43], v[172:175], v[108:111], v[28:43]
    v_fma_f32 v52, v52, s20, -v10
    v_fma_f32 v53, v53, s20, -v10
    v_fma_f32 v54, v54, s20, -v10
    v_fma_f32 v55, v55, s20, -v10
    v_fma_f32 v56, v56, s20, -v10
    v_fma_f32 v57, v57, s20, -v10
    v_fma_f32 v58, v58, s20, -v10
    v_fma_f32 v59, v59, s20, -v10
    v_exp_f32 v52, v52
    v_exp_f32 v53, v53
    v_exp_f32 v54, v54
    v_exp_f32 v55, v55
    v_exp_f32 v56, v56
    v_exp_f32 v57, v57
    v_exp_f32 v58, v58
    v_exp_f32 v59, v59
    s_nop 0
    v_cvt_pk_bf16_f32 v112, v52, v53
    v_cvt_pk_bf16_f32 v113, v54, v55
    v_cvt_pk_bf16_f32 v114, v56, v57
    v_cvt_pk_bf16_f32 v115, v58, v59
    s_nop 1
    v_mfma_f32_32x32x16_bf16 v[28:43], v[176:179], v[112:115], v[28:43]
    v_fma_f32 v60, v60, s20, -v10
    v_fma_f32 v61, v61, s20, -v10
    v_fma_f32 v62, v62, s20, -v10
    v_fma_f32 v63, v63, s20, -v10
    v_fma_f32 v64, v64, s20, -v10
    v_fma_f32 v65, v65, s20, -v10
    v_fma_f32 v66, v66, s20, -v10
    v_fma_f32 v67, v67, s20, -v10
    v_exp_f32 v60, v60
    v_exp_f32 v61, v61
    v_exp_f32 v62, v62
    v_exp_f32 v63, v63
    v_exp_f32 v64, v64
    v_exp_f32 v65, v65
    v_exp_f32 v66, v66
    v_exp_f32 v67, v67
    s_nop 0
    v_cvt_pk_bf16_f32 v116, v60, v61
    v_cvt_pk_bf16_f32 v117, v62, v63
    v_cvt_pk_bf16_f32 v118, v64, v65
    v_cvt_pk_bf16_f32 v119, v66, v67
    s_nop 1
    v_mfma_f32_32x32x16_bf16 v[28:43], v[180:183], v[116:119], v[28:43]
    v_fma_f32 v68, v68, s20, -v10
    v_fma_f32 v69, v69, s20, -v10
    v_fma_f32 v70, v70, s20, -v10
    v_fma_f32 v71, v71, s20, -v10
    v_fma_f32 v72, v72, s20, -v10
    v_fma_f32 v73, v73, s20, -v10
    v_fma_f32 v74, v74, s20, -v10
    v_fma_f32 v75, v75, s20, -v10
    v_exp_f32 v68, v68
    v_exp_f32 v69, v69
    v_exp_f32 v70, v70
    v_exp_f32 v71, v71
    v_exp_f32 v72, v72
    v_exp_f32 v73, v73
    v_exp_f32 v74, v74
    v_exp_f32 v75, v75
    s_nop 0
    v_cvt_pk_bf16_f32 v120, v68, v69
    v_cvt_pk_bf16_f32 v121, v70, v71
    v_cvt_pk_bf16_f32 v122, v72, v73
    v_cvt_pk_bf16_f32 v123, v74, v75
    s_nop 1
    v_mfma_f32_32x32x16_bf16 v[28:43], v[184:187], v[120:123], v[28:43]
    v_fma_f32 v76, v76, s20, -v10
    v_fma_f32 v77, v77, s20, -v10
    v_fma_f32 v78, v78, s20, -v10
    v_fma_f32 v79, v79, s20, -v10
    v_fma_f32 v80, v80, s20, -v10
    v_fma_f32 v81, v81, s20, -v10
    v_fma_f32 v82, v82, s20, -v10
    v_fma_f32 v83, v83, s20, -v10
    v_exp_f32 v76, v76
    v_exp_f32 v77, v77
    v_exp_f32 v78, v78
    v_exp_f32 v79, v79
    v_exp_f32 v80, v80
    v_exp_f32 v81, v81
    v_exp_f32 v82, v82
    v_exp_f32 v83, v83
    s_nop 0
    v_cvt_pk_bf16_f32 v124, v76, v77
    v_cvt_pk_bf16_f32 v125, v78, v79
    v_cvt_pk_bf16_f32 v126, v80, v81
    v_cvt_pk_bf16_f32 v127, v82, v83
    s_nop 1
    v_mfma_f32_32x32x16_bf16 v[28:43], v[188:191], v[124:127], v[28:43]
    v_fma_f32 v84, v84, s20, -v10
    v_fma_f32 v85, v85, s20, -v10
    v_fma_f32 v86, v86, s20, -v10
    v_fma_f32 v87, v87, s20, -v10
    v_fma_f32 v88, v88, s20, -v10
    v_fma_f32 v89, v89, s20, -v10
    v_fma_f32 v90, v90, s20, -v10
    v_fma_f32 v91, v91, s20, -v10
    v_exp_f32 v84, v84
    v_exp_f32 v85, v85
    v_exp_f32 v86, v86
    v_exp_f32 v87, v87
    v_exp_f32 v88, v88
    v_exp_f32 v89, v89
    v_exp_f32 v90, v90
    v_exp_f32 v91, v91
    s_nop 0
    v_cvt_pk_bf16_f32 v128, v84, v85
    v_cvt_pk_bf16_f32 v129, v86, v87
    v_cvt_pk_bf16_f32 v130, v88, v89
    v_cvt_pk_bf16_f32 v131, v90, v91
    s_nop 1
    v_mfma_f32_32x32x16_bf16 v[28:43], v[192:195], v[128:131], v[28:43]
    v_fma_f32 v92, v92, s20, -v10
    v_fma_f32 v93, v93, s20, -v10
    v_fma_f32 v94, v94, s20, -v10
    v_fma_f32 v95, v95, s20, -v10
    v_fma_f32 v96, v96, s20, -v10
    v_fma_f32 v97, v97, s20, -v10
    v_fma_f32 v98, v98, s20, -v10
    v_fma_f32 v99, v99, s20, -v10
    v_exp_f32 v92, v92
    v_exp_f32 v93, v93
    v_exp_f32 v94, v94
    v_exp_f32 v95, v95
    v_exp_f32 v96, v96
    v_exp_f32 v97, v97
    v_exp_f32 v98, v98
    v_exp_f32 v99, v99
    s_nop 0
    v_cvt_pk_bf16_f32 v132, v92, v93
    v_cvt_pk_bf16_f32 v133, v94, v95
    v_cvt_pk_bf16_f32 v134, v96, v97
    v_cvt_pk_bf16_f32 v135, v98, v99
    s_nop 1
    v_mfma_f32_32x32x16_bf16 v[28:43], v[196:199], v[132:135], v[28:43]
    v_fma_f32 v100, v100, s20, -v10
    v_fma_f32 v101, v101, s20, -v10
    v_fma_f32 v102, v102, s20, -v10
    v_fma_f32 v103, v103, s20, -v10
    v_fma_f32 v104, v104, s20, -v10
    v_fma_f32 v105, v105, s20, -v10
    v_fma_f32 v106, v106, s20, -v10
    v_fma_f32 v107, v107, s20, -v10
    v_exp_f32 v100, v100
    v_exp_f32 v101, v101
    v_exp_f32 v102, v102
    v_exp_f32 v103, v103
    v_exp_f32 v104, v104
    v_exp_f32 v105, v105
    v_exp_f32 v106, v106
    v_exp_f32 v107, v107
    s_nop 0
    v_cvt_pk_bf16_f32 v136, v100, v101
    v_cvt_pk_bf16_f32 v137, v102, v103
    v_cvt_pk_bf16_f32 v138, v104, v105
    v_cvt_pk_bf16_f32 v139, v106, v107
    s_nop 1
    v_mfma_f32_32x32x16_bf16 v[28:43], v[200:203], v[136:139], v[28:43]
    s_waitcnt vmcnt(0)
    ds_write_b32 v5, v12 offset:0
    ds_write_b32 v5, v13 offset:16
    ds_write_b32 v206, v14 offset:32
    ds_write_b32 v6, v15 offset:0
    ds_write_b32 v6, v16 offset:16
    ds_write_b32 v207, v17 offset:32
    s_waitcnt lgkmcnt(0)
    s_barrier
    s_mov_b32 s21, 0x654000
    buffer_load_dword v12, v4, s[8:11], s21 offen offset:1152
    buffer_load_dword v13, v4, s[8:11], s21 offen offset:1168
    buffer_load_dword v14, v205, s[8:11], s21 offen offset:1184
    buffer_load_dword v15, v4, s[8:11], s21 offen offset:2304
    buffer_load_dword v16, v4, s[8:11], s21 offen offset:2320
    buffer_load_dword v17, v205, s[8:11], s21 offen offset:2336
    ds_read_b128 v[140:143], v7 offset:0
    ds_read_b128 v[144:147], v7 offset:32
    ds_read_b128 v[148:151], v7 offset:2560
    ds_read_b128 v[152:155], v7 offset:2592
    ds_read_b128 v[156:159], v7 offset:5120
    ds_read_b128 v[160:163], v7 offset:5152
    ds_read_b128 v[164:167], v7 offset:7680
    ds_read_b128 v[168:171], v7 offset:7712
    s_waitcnt lgkmcnt(6)
    v_mfma_f32_32x32x16_bf16 v[44:59], v[140:143], v[20:23], 0
    v_mfma_f32_32x32x16_bf16 v[44:59], v[144:147], v[24:27], v[44:59]
    s_waitcnt lgkmcnt(4)
    v_mfma_f32_32x32x16_bf16 v[60:75], v[148:151], v[20:23], 0
    v_mfma_f32_32x32x16_bf16 v[60:75], v[152:155], v[24:27], v[60:75]
    s_waitcnt lgkmcnt(2)
    v_mfma_f32_32x32x16_bf16 v[76:91], v[156:159], v[20:23], 0
    v_mfma_f32_32x32x16_bf16 v[76:91], v[160:163], v[24:27], v[76:91]
    s_waitcnt lgkmcnt(0)
    v_mfma_f32_32x32x16_bf16 v[92:107], v[164:167], v[20:23], 0
    v_mfma_f32_32x32x16_bf16 v[92:107], v[168:171], v[24:27], v[92:107]
    ds_read_b64_tr_b16 v[172:173], v8 offset:0
    ds_read_b64_tr_b16 v[174:175], v8 offset:512
    ds_read_b64_tr_b16 v[176:177], v8 offset:1024
    ds_read_b64_tr_b16 v[178:179], v8 offset:1536
    ds_read_b64_tr_b16 v[180:181], v8 offset:2048
    ds_read_b64_tr_b16 v[182:183], v8 offset:2560
    ds_read_b64_tr_b16 v[184:185], v8 offset:3072
    ds_read_b64_tr_b16 v[186:187], v8 offset:3584
    ds_read_b64_tr_b16 v[188:189], v8 offset:4096
    ds_read_b64_tr_b16 v[190:191], v8 offset:4608
    ds_read_b64_tr_b16 v[192:193], v8 offset:5120
    ds_read_b64_tr_b16 v[194:195], v8 offset:5632
    ds_read_b64_tr_b16 v[196:197], v8 offset:6144
    ds_read_b64_tr_b16 v[198:199], v8 offset:6656
    ds_read_b64_tr_b16 v[200:201], v8 offset:7168
    ds_read_b64_tr_b16 v[202:203], v8 offset:7680
    s_nop 7
    s_nop 3
    v_max3_f32 v1, v44, v45, v46
    v_max3_f32 v1, v1, v47, v48
    v_max3_f32 v1, v1, v49, v50
    v_max3_f32 v1, v1, v51, v52
    v_max3_f32 v1, v1, v53, v54
    v_max3_f32 v1, v1, v55, v56
    v_max3_f32 v1, v1, v57, v58
    v_max3_f32 v1, v1, v59, v60
    v_max3_f32 v1, v1, v61, v62
    v_max3_f32 v1, v1, v63, v64
    v_max3_f32 v1, v1, v65, v66
    v_max3_f32 v1, v1, v67, v68
    v_max3_f32 v1, v1, v69, v70
    v_max3_f32 v1, v1, v71, v72
    v_max3_f32 v1, v1, v73, v74
    v_max3_f32 v1, v1, v75, v76
    v_max3_f32 v1, v1, v77, v78
    v_max3_f32 v1, v1, v79, v80
    v_max3_f32 v1, v1, v81, v82
    v_max3_f32 v1, v1, v83, v84
    v_max3_f32 v1, v1, v85, v86
    v_max3_f32 v1, v1, v87, v88
    v_max3_f32 v1, v1, v89, v90
    v_max3_f32 v1, v1, v91, v92
    v_max3_f32 v1, v1, v93, v94
    v_max3_f32 v1, v1, v95, v96
    v_max3_f32 v1, v1, v97, v98
    v_max3_f32 v1, v1, v99, v100
    v_max3_f32 v1, v1, v101, v102
    v_max3_f32 v1, v1, v103, v104
    v_max3_f32 v1, v1, v105, v106
    v_max_f32 v1, v1, v107
    v_mov_b32 v2, v1
    s_nop 1
    v_permlane32_swap_b32 v1, v2
    v_max3_f32 v1, v1, v2, v9
    v_sub_f32 v2, v9, v1
    v_mul_f32 v2, s20, v2
    v_exp_f32 v2, v2
    v_mov_b32 v9, v1
    v_mul_f32 v10, s20, v1
    v_mul_f32 v28, v28, v2
    v_mul_f32 v29, v29, v2
    v_mul_f32 v30, v30, v2
    v_mul_f32 v31, v31, v2
    v_mul_f32 v32, v32, v2
    v_mul_f32 v33, v33, v2
    v_mul_f32 v34, v34, v2
    v_mul_f32 v35, v35, v2
    v_mul_f32 v36, v36, v2
    v_mul_f32 v37, v37, v2
    v_mul_f32 v38, v38, v2
    v_mul_f32 v39, v39, v2
    v_mul_f32 v40, v40, v2
    v_mul_f32 v41, v41, v2
    v_mul_f32 v42, v42, v2
    v_mul_f32 v43, v43, v2
    s_waitcnt lgkmcnt(0)
    v_fma_f32 v44, v44, s20, -v10
    v_fma_f32 v45, v45, s20, -v10
    v_fma_f32 v46, v46, s20, -v10
    v_fma_f32 v47, v47, s20, -v10
    v_fma_f32 v48, v48, s20, -v10
    v_fma_f32 v49, v49, s20, -v10
    v_fma_f32 v50, v50, s20, -v10
    v_fma_f32 v51, v51, s20, -v10
    v_exp_f32 v44, v44
    v_exp_f32 v45, v45
    v_exp_f32 v46, v46
    v_exp_f32 v47, v47
    v_exp_f32 v48, v48
    v_exp_f32 v49, v49
    v_exp_f32 v50, v50
    v_exp_f32 v51, v51
    s_nop 0
    v_cvt_pk_bf16_f32 v108, v44, v45
    v_cvt_pk_bf16_f32 v109, v46, v47
    v_cvt_pk_bf16_f32 v110, v48, v49
    v_cvt_pk_bf16_f32 v111, v50, v51
    s_nop 1
    v_mfma_f32_32x32x16_bf16 v[28:43], v[172:175], v[108:111], v[28:43]
    v_fma_f32 v52, v52, s20, -v10
    v_fma_f32 v53, v53, s20, -v10
    v_fma_f32 v54, v54, s20, -v10
    v_fma_f32 v55, v55, s20, -v10
    v_fma_f32 v56, v56, s20, -v10
    v_fma_f32 v57, v57, s20, -v10
    v_fma_f32 v58, v58, s20, -v10
    v_fma_f32 v59, v59, s20, -v10
    v_exp_f32 v52, v52
    v_exp_f32 v53, v53
    v_exp_f32 v54, v54
    v_exp_f32 v55, v55
    v_exp_f32 v56, v56
    v_exp_f32 v57, v57
    v_exp_f32 v58, v58
    v_exp_f32 v59, v59
    s_nop 0
    v_cvt_pk_bf16_f32 v112, v52, v53
    v_cvt_pk_bf16_f32 v113, v54, v55
    v_cvt_pk_bf16_f32 v114, v56, v57
    v_cvt_pk_bf16_f32 v115, v58, v59
    s_nop 1
    v_mfma_f32_32x32x16_bf16 v[28:43], v[176:179], v[112:115], v[28:43]
    v_fma_f32 v60, v60, s20, -v10
    v_fma_f32 v61, v61, s20, -v10
    v_fma_f32 v62, v62, s20, -v10
    v_fma_f32 v63, v63, s20, -v10
    v_fma_f32 v64, v64, s20, -v10
    v_fma_f32 v65, v65, s20, -v10
    v_fma_f32 v66, v66, s20, -v10
    v_fma_f32 v67, v67, s20, -v10
    v_exp_f32 v60, v60
    v_exp_f32 v61, v61
    v_exp_f32 v62, v62
    v_exp_f32 v63, v63
    v_exp_f32 v64, v64
    v_exp_f32 v65, v65
    v_exp_f32 v66, v66
    v_exp_f32 v67, v67
    s_nop 0
    v_cvt_pk_bf16_f32 v116, v60, v61
    v_cvt_pk_bf16_f32 v117, v62, v63
    v_cvt_pk_bf16_f32 v118, v64, v65
    v_cvt_pk_bf16_f32 v119, v66, v67
    s_nop 1
    v_mfma_f32_32x32x16_bf16 v[28:43], v[180:183], v[116:119], v[28:43]
    v_fma_f32 v68, v68, s20, -v10
    v_fma_f32 v69, v69, s20, -v10
    v_fma_f32 v70, v70, s20, -v10
    v_fma_f32 v71, v71, s20, -v10
    v_fma_f32 v72, v72, s20, -v10
    v_fma_f32 v73, v73, s20, -v10
    v_fma_f32 v74, v74, s20, -v10
    v_fma_f32 v75, v75, s20, -v10
    v_exp_f32 v68, v68
    v_exp_f32 v69, v69
    v_exp_f32 v70, v70
    v_exp_f32 v71, v71
    v_exp_f32 v72, v72
    v_exp_f32 v73, v73
    v_exp_f32 v74, v74
    v_exp_f32 v75, v75
    s_nop 0
    v_cvt_pk_bf16_f32 v120, v68, v69
    v_cvt_pk_bf16_f32 v121, v70, v71
    v_cvt_pk_bf16_f32 v122, v72, v73
    v_cvt_pk_bf16_f32 v123, v74, v75
    s_nop 1
    v_mfma_f32_32x32x16_bf16 v[28:43], v[184:187], v[120:123], v[28:43]
    v_fma_f32 v76, v76, s20, -v10
    v_fma_f32 v77, v77, s20, -v10
    v_fma_f32 v78, v78, s20, -v10
    v_fma_f32 v79, v79, s20, -v10
    v_fma_f32 v80, v80, s20, -v10
    v_fma_f32 v81, v81, s20, -v10
    v_fma_f32 v82, v82, s20, -v10
    v_fma_f32 v83, v83, s20, -v10
    v_exp_f32 v76, v76
    v_exp_f32 v77, v77
    v_exp_f32 v78, v78
    v_exp_f32 v79, v79
    v_exp_f32 v80, v80
    v_exp_f32 v81, v81
    v_exp_f32 v82, v82
    v_exp_f32 v83, v83
    s_nop 0
    v_cvt_pk_bf16_f32 v124, v76, v77
    v_cvt_pk_bf16_f32 v125, v78, v79
    v_cvt_pk_bf16_f32 v126, v80, v81
    v_cvt_pk_bf16_f32 v127, v82, v83
    s_nop 1
    v_mfma_f32_32x32x16_bf16 v[28:43], v[188:191], v[124:127], v[28:43]
    v_fma_f32 v84, v84, s20, -v10
    v_fma_f32 v85, v85, s20, -v10
    v_fma_f32 v86, v86, s20, -v10
    v_fma_f32 v87, v87, s20, -v10
    v_fma_f32 v88, v88, s20, -v10
    v_fma_f32 v89, v89, s20, -v10
    v_fma_f32 v90, v90, s20, -v10
    v_fma_f32 v91, v91, s20, -v10
    v_exp_f32 v84, v84
    v_exp_f32 v85, v85
    v_exp_f32 v86, v86
    v_exp_f32 v87, v87
    v_exp_f32 v88, v88
    v_exp_f32 v89, v89
    v_exp_f32 v90, v90
    v_exp_f32 v91, v91
    s_nop 0
    v_cvt_pk_bf16_f32 v128, v84, v85
    v_cvt_pk_bf16_f32 v129, v86, v87
    v_cvt_pk_bf16_f32 v130, v88, v89
    v_cvt_pk_bf16_f32 v131, v90, v91
    s_nop 1
    v_mfma_f32_32x32x16_bf16 v[28:43], v[192:195], v[128:131], v[28:43]
    v_fma_f32 v92, v92, s20, -v10
    v_fma_f32 v93, v93, s20, -v10
    v_fma_f32 v94, v94, s20, -v10
    v_fma_f32 v95, v95, s20, -v10
    v_fma_f32 v96, v96, s20, -v10
    v_fma_f32 v97, v97, s20, -v10
    v_fma_f32 v98, v98, s20, -v10
    v_fma_f32 v99, v99, s20, -v10
    v_exp_f32 v92, v92
    v_exp_f32 v93, v93
    v_exp_f32 v94, v94
    v_exp_f32 v95, v95
    v_exp_f32 v96, v96
    v_exp_f32 v97, v97
    v_exp_f32 v98, v98
    v_exp_f32 v99, v99
    s_nop 0
    v_cvt_pk_bf16_f32 v132, v92, v93
    v_cvt_pk_bf16_f32 v133, v94, v95
    v_cvt_pk_bf16_f32 v134, v96, v97
    v_cvt_pk_bf16_f32 v135, v98, v99
    s_nop 1
    v_mfma_f32_32x32x16_bf16 v[28:43], v[196:199], v[132:135], v[28:43]
    v_fma_f32 v100, v100, s20, -v10
    v_fma_f32 v101, v101, s20, -v10
    v_fma_f32 v102, v102, s20, -v10
    v_fma_f32 v103, v103, s20, -v10
    v_fma_f32 v104, v104, s20, -v10
    v_fma_f32 v105, v105, s20, -v10
    v_fma_f32 v106, v106, s20, -v10
    v_fma_f32 v107, v107, s20, -v10
    v_exp_f32 v100, v100
    v_exp_f32 v101, v101
    v_exp_f32 v102, v102
    v_exp_f32 v103, v103
    v_exp_f32 v104, v104
    v_exp_f32 v105, v105
    v_exp_f32 v106, v106
    v_exp_f32 v107, v107
    s_nop 0
    v_cvt_pk_bf16_f32 v136, v100, v101
    v_cvt_pk_bf16_f32 v137, v102, v103
    v_cvt_pk_bf16_f32 v138, v104, v105
    v_cvt_pk_bf16_f32 v139, v106, v107
    s_nop 1
    v_mfma_f32_32x32x16_bf16 v[28:43], v[200:203], v[136:139], v[28:43]
    s_waitcnt vmcnt(0)
    ds_write_b32 v5, v12 offset:18432
    ds_write_b32 v5, v13 offset:18448
    ds_write_b32 v206, v14 offset:18464
    ds_write_b32 v6, v15 offset:18432
    ds_write_b32 v6, v16 offset:18448
    ds_write_b32 v207, v17 offset:18464
    s_waitcnt lgkmcnt(0)
    s_barrier
    ds_read_b128 v[140:143], v7 offset:18432
    ds_read_b128 v[144:147], v7 offset:18464
    ds_read_b128 v[148:151], v7 offset:20992
    ds_read_b128 v[152:155], v7 offset:21024
    ds_read_b128 v[156:159], v7 offset:23552
    ds_read_b128 v[160:163], v7 offset:23584
    ds_read_b128 v[164:167], v7 offset:26112
    ds_read_b128 v[168:171], v7 offset:26144
    s_waitcnt lgkmcnt(6)
    v_mfma_f32_32x32x16_bf16 v[44:59], v[140:143], v[20:23], 0
    v_mfma_f32_32x32x16_bf16 v[44:59], v[144:147], v[24:27], v[44:59]
    s_waitcnt lgkmcnt(4)
    v_mfma_f32_32x32x16_bf16 v[60:75], v[148:151], v[20:23], 0
    v_mfma_f32_32x32x16_bf16 v[60:75], v[152:155], v[24:27], v[60:75]
    s_waitcnt lgkmcnt(2)
    v_mfma_f32_32x32x16_bf16 v[76:91], v[156:159], v[20:23], 0
    v_mfma_f32_32x32x16_bf16 v[76:91], v[160:163], v[24:27], v[76:91]
    s_waitcnt lgkmcnt(0)
    v_mfma_f32_32x32x16_bf16 v[92:107], v[164:167], v[20:23], 0
    v_mfma_f32_32x32x16_bf16 v[92:107], v[168:171], v[24:27], v[92:107]
    ds_read_b64_tr_b16 v[172:173], v8 offset:18432
    ds_read_b64_tr_b16 v[174:175], v8 offset:18944
    ds_read_b64_tr_b16 v[176:177], v8 offset:19456
    ds_read_b64_tr_b16 v[178:179], v8 offset:19968
    ds_read_b64_tr_b16 v[180:181], v8 offset:20480
    ds_read_b64_tr_b16 v[182:183], v8 offset:20992
    ds_read_b64_tr_b16 v[184:185], v8 offset:21504
    ds_read_b64_tr_b16 v[186:187], v8 offset:22016
    ds_read_b64_tr_b16 v[188:189], v8 offset:22528
    ds_read_b64_tr_b16 v[190:191], v8 offset:23040
    ds_read_b64_tr_b16 v[192:193], v8 offset:23552
    ds_read_b64_tr_b16 v[194:195], v8 offset:24064
    ds_read_b64_tr_b16 v[196:197], v8 offset:24576
    ds_read_b64_tr_b16 v[198:199], v8 offset:25088
    ds_read_b64_tr_b16 v[200:201], v8 offset:25600
    ds_read_b64_tr_b16 v[202:203], v8 offset:26112
    s_nop 7
    s_nop 3
    v_max3_f32 v1, v44, v45, v46
    v_max3_f32 v1, v1, v47, v48
    v_max3_f32 v1, v1, v49, v50
    v_max3_f32 v1, v1, v51, v52
    v_max3_f32 v1, v1, v53, v54
    v_max3_f32 v1, v1, v55, v56
    v_max3_f32 v1, v1, v57, v58
    v_max3_f32 v1, v1, v59, v60
    v_max3_f32 v1, v1, v61, v62
    v_max3_f32 v1, v1, v63, v64
    v_max3_f32 v1, v1, v65, v66
    v_max3_f32 v1, v1, v67, v68
    v_max3_f32 v1, v1, v69, v70
    v_max3_f32 v1, v1, v71, v72
    v_max3_f32 v1, v1, v73, v74
    v_max3_f32 v1, v1, v75, v76
    v_max3_f32 v1, v1, v77, v78
    v_max3_f32 v1, v1, v79, v80
    v_max3_f32 v1, v1, v81, v82
    v_max3_f32 v1, v1, v83, v84
    v_max3_f32 v1, v1, v85, v86
    v_max3_f32 v1, v1, v87, v88
    v_max3_f32 v1, v1, v89, v90
    v_max3_f32 v1, v1, v91, v92
    v_max3_f32 v1, v1, v93, v94
    v_max3_f32 v1, v1, v95, v96
    v_max3_f32 v1, v1, v97, v98
    v_max3_f32 v1, v1, v99, v100
    v_max3_f32 v1, v1, v101, v102
    v_max3_f32 v1, v1, v103, v104
    v_max3_f32 v1, v1, v105, v106
    v_max_f32 v1, v1, v107
    v_mov_b32 v2, v1
    s_nop 1
    v_permlane32_swap_b32 v1, v2
    v_max3_f32 v1, v1, v2, v9
    v_sub_f32 v2, v9, v1
    v_mul_f32 v2, s20, v2
    v_exp_f32 v2, v2
    v_mov_b32 v9, v1
    v_mul_f32 v10, s20, v1
    v_mul_f32 v28, v28, v2
    v_mul_f32 v29, v29, v2
    v_mul_f32 v30, v30, v2
    v_mul_f32 v31, v31, v2
    v_mul_f32 v32, v32, v2
    v_mul_f32 v33, v33, v2
    v_mul_f32 v34, v34, v2
    v_mul_f32 v35, v35, v2
    v_mul_f32 v36, v36, v2
    v_mul_f32 v37, v37, v2
    v_mul_f32 v38, v38, v2
    v_mul_f32 v39, v39, v2
    v_mul_f32 v40, v40, v2
    v_mul_f32 v41, v41, v2
    v_mul_f32 v42, v42, v2
    v_mul_f32 v43, v43, v2
    s_waitcnt lgkmcnt(0)
    v_fma_f32 v44, v44, s20, -v10
    v_fma_f32 v45, v45, s20, -v10
    v_fma_f32 v46, v46, s20, -v10
    v_fma_f32 v47, v47, s20, -v10
    v_fma_f32 v48, v48, s20, -v10
    v_fma_f32 v49, v49, s20, -v10
    v_fma_f32 v50, v50, s20, -v10
    v_fma_f32 v51, v51, s20, -v10
    v_exp_f32 v44, v44
    v_exp_f32 v45, v45
    v_exp_f32 v46, v46
    v_exp_f32 v47, v47
    v_exp_f32 v48, v48
    v_exp_f32 v49, v49
    v_exp_f32 v50, v50
    v_exp_f32 v51, v51
    s_nop 0
    v_cvt_pk_bf16_f32 v108, v44, v45
    v_cvt_pk_bf16_f32 v109, v46, v47
    v_cvt_pk_bf16_f32 v110, v48, v49
    v_cvt_pk_bf16_f32 v111, v50, v51
    s_nop 1
    v_mfma_f32_32x32x16_bf16 v[28:43], v[172:175], v[108:111], v[28:43]
    v_fma_f32 v52, v52, s20, -v10
    v_fma_f32 v53, v53, s20, -v10
    v_fma_f32 v54, v54, s20, -v10
    v_fma_f32 v55, v55, s20, -v10
    v_fma_f32 v56, v56, s20, -v10
    v_fma_f32 v57, v57, s20, -v10
    v_fma_f32 v58, v58, s20, -v10
    v_fma_f32 v59, v59, s20, -v10
    v_exp_f32 v52, v52
    v_exp_f32 v53, v53
    v_exp_f32 v54, v54
    v_exp_f32 v55, v55
    v_exp_f32 v56, v56
    v_exp_f32 v57, v57
    v_exp_f32 v58, v58
    v_exp_f32 v59, v59
    s_nop 0
    v_cvt_pk_bf16_f32 v112, v52, v53
    v_cvt_pk_bf16_f32 v113, v54, v55
    v_cvt_pk_bf16_f32 v114, v56, v57
    v_cvt_pk_bf16_f32 v115, v58, v59
    s_nop 1
    v_mfma_f32_32x32x16_bf16 v[28:43], v[176:179], v[112:115], v[28:43]
    v_fma_f32 v60, v60, s20, -v10
    v_fma_f32 v61, v61, s20, -v10
    v_fma_f32 v62, v62, s20, -v10
    v_fma_f32 v63, v63, s20, -v10
    v_fma_f32 v64, v64, s20, -v10
    v_fma_f32 v65, v65, s20, -v10
    v_fma_f32 v66, v66, s20, -v10
    v_fma_f32 v67, v67, s20, -v10
    v_exp_f32 v60, v60
    v_exp_f32 v61, v61
    v_exp_f32 v62, v62
    v_exp_f32 v63, v63
    v_exp_f32 v64, v64
    v_exp_f32 v65, v65
    v_exp_f32 v66, v66
    v_exp_f32 v67, v67
    s_nop 0
    v_cvt_pk_bf16_f32 v116, v60, v61
    v_cvt_pk_bf16_f32 v117, v62, v63
    v_cvt_pk_bf16_f32 v118, v64, v65
    v_cvt_pk_bf16_f32 v119, v66, v67
    s_nop 1
    v_mfma_f32_32x32x16_bf16 v[28:43], v[180:183], v[116:119], v[28:43]
    v_fma_f32 v68, v68, s20, -v10
    v_fma_f32 v69, v69, s20, -v10
    v_fma_f32 v70, v70, s20, -v10
    v_fma_f32 v71, v71, s20, -v10
    v_fma_f32 v72, v72, s20, -v10
    v_fma_f32 v73, v73, s20, -v10
    v_fma_f32 v74, v74, s20, -v10
    v_fma_f32 v75, v75, s20, -v10
    v_exp_f32 v68, v68
    v_exp_f32 v69, v69
    v_exp_f32 v70, v70
    v_exp_f32 v71, v71
    v_exp_f32 v72, v72
    v_exp_f32 v73, v73
    v_exp_f32 v74, v74
    v_exp_f32 v75, v75
    s_nop 0
    v_cvt_pk_bf16_f32 v120, v68, v69
    v_cvt_pk_bf16_f32 v121, v70, v71
    v_cvt_pk_bf16_f32 v122, v72, v73
    v_cvt_pk_bf16_f32 v123, v74, v75
    s_nop 1
    v_mfma_f32_32x32x16_bf16 v[28:43], v[184:187], v[120:123], v[28:43]
    v_fma_f32 v76, v76, s20, -v10
    v_fma_f32 v77, v77, s20, -v10
    v_fma_f32 v78, v78, s20, -v10
    v_fma_f32 v79, v79, s20, -v10
    v_fma_f32 v80, v80, s20, -v10
    v_fma_f32 v81, v81, s20, -v10
    v_fma_f32 v82, v82, s20, -v10
    v_fma_f32 v83, v83, s20, -v10
    v_exp_f32 v76, v76
    v_exp_f32 v77, v77
    v_exp_f32 v78, v78
    v_exp_f32 v79, v79
    v_exp_f32 v80, v80
    v_exp_f32 v81, v81
    v_exp_f32 v82, v82
    v_exp_f32 v83, v83
    s_nop 0
    v_cvt_pk_bf16_f32 v124, v76, v77
    v_cvt_pk_bf16_f32 v125, v78, v79
    v_cvt_pk_bf16_f32 v126, v80, v81
    v_cvt_pk_bf16_f32 v127, v82, v83
    s_nop 1
    v_mfma_f32_32x32x16_bf16 v[28:43], v[188:191], v[124:127], v[28:43]
    v_fma_f32 v84, v84, s20, -v10
    v_fma_f32 v85, v85, s20, -v10
    v_fma_f32 v86, v86, s20, -v10
    v_fma_f32 v87, v87, s20, -v10
    v_fma_f32 v88, v88, s20, -v10
    v_fma_f32 v89, v89, s20, -v10
    v_fma_f32 v90, v90, s20, -v10
    v_fma_f32 v91, v91, s20, -v10
    v_exp_f32 v84, v84
    v_exp_f32 v85, v85
    v_exp_f32 v86, v86
    v_exp_f32 v87, v87
    v_exp_f32 v88, v88
    v_exp_f32 v89, v89
    v_exp_f32 v90, v90
    v_exp_f32 v91, v91
    s_nop 0
    v_cvt_pk_bf16_f32 v128, v84, v85
    v_cvt_pk_bf16_f32 v129, v86, v87
    v_cvt_pk_bf16_f32 v130, v88, v89
    v_cvt_pk_bf16_f32 v131, v90, v91
    s_nop 1
    v_mfma_f32_32x32x16_bf16 v[28:43], v[192:195], v[128:131], v[28:43]
    v_fma_f32 v92, v92, s20, -v10
    v_fma_f32 v93, v93, s20, -v10
    v_fma_f32 v94, v94, s20, -v10
    v_fma_f32 v95, v95, s20, -v10
    v_fma_f32 v96, v96, s20, -v10
    v_fma_f32 v97, v97, s20, -v10
    v_fma_f32 v98, v98, s20, -v10
    v_fma_f32 v99, v99, s20, -v10
    v_exp_f32 v92, v92
    v_exp_f32 v93, v93
    v_exp_f32 v94, v94
    v_exp_f32 v95, v95
    v_exp_f32 v96, v96
    v_exp_f32 v97, v97
    v_exp_f32 v98, v98
    v_exp_f32 v99, v99
    s_nop 0
    v_cvt_pk_bf16_f32 v132, v92, v93
    v_cvt_pk_bf16_f32 v133, v94, v95
    v_cvt_pk_bf16_f32 v134, v96, v97
    v_cvt_pk_bf16_f32 v135, v98, v99
    s_nop 1
    v_mfma_f32_32x32x16_bf16 v[28:43], v[196:199], v[132:135], v[28:43]
    v_fma_f32 v100, v100, s20, -v10
    v_fma_f32 v101, v101, s20, -v10
    v_fma_f32 v102, v102, s20, -v10
    v_fma_f32 v103, v103, s20, -v10
    v_fma_f32 v104, v104, s20, -v10
    v_fma_f32 v105, v105, s20, -v10
    v_fma_f32 v106, v106, s20, -v10
    v_fma_f32 v107, v107, s20, -v10
    v_exp_f32 v100, v100
    v_exp_f32 v101, v101
    v_exp_f32 v102, v102
    v_exp_f32 v103, v103
    v_exp_f32 v104, v104
    v_exp_f32 v105, v105
    v_exp_f32 v106, v106
    v_exp_f32 v107, v107
    s_nop 0
    v_cvt_pk_bf16_f32 v136, v100, v101
    v_cvt_pk_bf16_f32 v137, v102, v103
    v_cvt_pk_bf16_f32 v138, v104, v105
    v_cvt_pk_bf16_f32 v139, v106, v107
    s_nop 1
    v_mfma_f32_32x32x16_bf16 v[28:43], v[200:203], v[136:139], v[28:43]
    s_nop 7
    s_nop 7
    v_mov_b32 v1, v38
    v_mov_b32 v2, v38
    s_nop 1
    v_permlane32_swap_b32 v1, v2
    v_rcp_f32 v1, v1
    s_nop 0
    v_mul_f32 v28, v28, v1
    v_mul_f32 v29, v29, v1
    v_mul_f32 v30, v30, v1
    v_mul_f32 v31, v31, v1
    v_mul_f32 v32, v32, v1
    v_mul_f32 v33, v33, v1
    v_mul_f32 v34, v34, v1
    v_mul_f32 v35, v35, v1
    v_mul_f32 v36, v36, v1
    v_mul_f32 v37, v37, v1
    v_cvt_pk_bf16_f32 v108, v28, v29
    v_cvt_pk_bf16_f32 v109, v30, v31
    v_cvt_pk_bf16_f32 v110, v32, v33
    v_cvt_pk_bf16_f32 v111, v34, v35
    v_cvt_pk_bf16_f32 v112, v36, v37
    v_bfe_u32 v2, v0, 5, 1
    v_lshlrev_b32 v2, 3, v2
    v_add_u32 v204, v204, v2
    buffer_store_dword v108, v204, s[12:15], 0 offen
    buffer_store_dword v109, v204, s[12:15], 0 offen offset:4
    buffer_store_dword v110, v204, s[12:15], 0 offen offset:16
    buffer_store_dword v111, v204, s[12:15], 0 offen offset:20
    v_and_b32 v1, 63, v0
    v_cmp_gt_u32 vcc, 32, v1
    s_and_saveexec_b64 s[22:23], vcc
    buffer_store_dword v112, v204, s[12:15], 0 offen offset:32
    s_mov_b64 exec, s[22:23]
attn_kernel_done:
    s_endpgm
.globl ln0_kernel
.p2align 8
.type ln0_kernel,@function
ln0_kernel:
    s_load_dwordx2 s[4:5], s[0:1], 0
    s_load_dwordx2 s[6:7], s[0:1], 72
    s_cmp_ge_u32 s2, 256
    s_cbranch_scc1 ln0_kernel_done
    s_waitcnt lgkmcnt(0)
    s_mov_b32 s8, s4
    s_and_b32 s9, s5, 0xffff
    s_mov_b32 s10, 0x240000
    s_mov_b32 s11, 0x20000
    s_mov_b32 s12, s6
    s_and_b32 s13, s7, 0xffff
    s_mov_b32 s14, 0x240000
    s_mov_b32 s15, 0x20000
    s_lshl_b32 s3, s2, 8
    v_add_u32 v1, s3, v0
    v_lshrrev_b32 v2, 5, v1
    v_mul_u32_u24 v2, 1152, v2
    v_and_b32 v1, 31, v1
    v_mul_u32_u24 v1, 36, v1
    v_add_u32 v2, v2, v1
    buffer_load_dwordx4 v[4:7], v2, s[8:11], 0 offen
    buffer_load_dwordx4 v[8:11], v2, s[8:11], 0 offen offset:16
    buffer_load_dword v12, v2, s[8:11], 0 offen offset:32
    s_waitcnt vmcnt(0)
    v_lshlrev_b32 v13, 16, v4
    v_and_b32 v14, 0xffff0000, v4
    v_lshlrev_b32 v15, 16, v5
    v_and_b32 v16, 0xffff0000, v5
    v_lshlrev_b32 v17, 16, v6
    v_and_b32 v18, 0xffff0000, v6
    v_lshlrev_b32 v19, 16, v7
    v_and_b32 v20, 0xffff0000, v7
    v_lshlrev_b32 v21, 16, v8
    v_and_b32 v22, 0xffff0000, v8
    v_lshlrev_b32 v23, 16, v9
    v_and_b32 v24, 0xffff0000, v9
    v_lshlrev_b32 v25, 16, v10
    v_and_b32 v26, 0xffff0000, v10
    v_lshlrev_b32 v27, 16, v11
    v_and_b32 v28, 0xffff0000, v11
    v_lshlrev_b32 v29, 16, v12
    v_and_b32 v30, 0xffff0000, v12
    v_add_f32 v31, v13, v14
    v_add_f32 v31, v31, v15
    v_add_f32 v31, v31, v16
    v_add_f32 v31, v31, v17
    v_add_f32 v31, v31, v18
    v_add_f32 v31, v31, v19
    v_add_f32 v31, v31, v20
    v_add_f32 v31, v31, v21
    v_add_f32 v31, v31, v22
    v_add_f32 v31, v31, v23
    v_add_f32 v31, v31, v24
    v_add_f32 v31, v31, v25
    v_add_f32 v31, v31, v26
    v_add_f32 v31, v31, v27
    v_add_f32 v31, v31, v28
    v_add_f32 v31, v31, v29
    v_add_f32 v31, v31, v30
    ds_swizzle_b32 v32, v31 offset:0x41f
    s_waitcnt lgkmcnt(0)
    v_add_f32 v31, v31, v32
    ds_swizzle_b32 v32, v31 offset:0x81f
    s_waitcnt lgkmcnt(0)
    v_add_f32 v31, v31, v32
    ds_swizzle_b32 v32, v31 offset:0x101f
    s_waitcnt lgkmcnt(0)
    v_add_f32 v31, v31, v32
    ds_swizzle_b32 v32, v31 offset:0x201f
    s_waitcnt lgkmcnt(0)
    v_add_f32 v31, v31, v32
    ds_swizzle_b32 v32, v31 offset:0x401f
    s_waitcnt lgkmcnt(0)
    v_add_f32 v31, v31, v32
    v_mul_f32 v33, 0x3ae38e39, v31
    v_sub_f32 v13, v13, v33
    v_sub_f32 v14, v14, v33
    v_sub_f32 v15, v15, v33
    v_sub_f32 v16, v16, v33
    v_sub_f32 v17, v17, v33
    v_sub_f32 v18, v18, v33
    v_sub_f32 v19, v19, v33
    v_sub_f32 v20, v20, v33
    v_sub_f32 v21, v21, v33
    v_sub_f32 v22, v22, v33
    v_sub_f32 v23, v23, v33
    v_sub_f32 v24, v24, v33
    v_sub_f32 v25, v25, v33
    v_sub_f32 v26, v26, v33
    v_sub_f32 v27, v27, v33
    v_sub_f32 v28, v28, v33
    v_sub_f32 v29, v29, v33
    v_sub_f32 v30, v30, v33
    v_mul_f32 v31, v13, v13
    v_fmac_f32 v31, v14, v14
    v_fmac_f32 v31, v15, v15
    v_fmac_f32 v31, v16, v16
    v_fmac_f32 v31, v17, v17
    v_fmac_f32 v31, v18, v18
    v_fmac_f32 v31, v19, v19
    v_fmac_f32 v31, v20, v20
    v_fmac_f32 v31, v21, v21
    v_fmac_f32 v31, v22, v22
    v_fmac_f32 v31, v23, v23
    v_fmac_f32 v31, v24, v24
    v_fmac_f32 v31, v25, v25
    v_fmac_f32 v31, v26, v26
    v_fmac_f32 v31, v27, v27
    v_fmac_f32 v31, v28, v28
    v_fmac_f32 v31, v29, v29
    v_fmac_f32 v31, v30, v30
    ds_swizzle_b32 v32, v31 offset:0x41f
    s_waitcnt lgkmcnt(0)
    v_add_f32 v31, v31, v32
    ds_swizzle_b32 v32, v31 offset:0x81f
    s_waitcnt lgkmcnt(0)
    v_add_f32 v31, v31, v32
    ds_swizzle_b32 v32, v31 offset:0x101f
    s_waitcnt lgkmcnt(0)
    v_add_f32 v31, v31, v32
    ds_swizzle_b32 v32, v31 offset:0x201f
    s_waitcnt lgkmcnt(0)
    v_add_f32 v31, v31, v32
    ds_swizzle_b32 v32, v31 offset:0x401f
    s_waitcnt lgkmcnt(0)
    v_add_f32 v31, v31, v32
    v_mov_b32 v34, 0x3727c5ac
    v_fmac_f32 v34, 0x3ae38e39, v31
    v_rsq_f32 v34, v34
    s_nop 0
    v_mul_f32 v13, v13, v34
    v_mul_f32 v14, v14, v34
    v_mul_f32 v15, v15, v34
    v_mul_f32 v16, v16, v34
    v_mul_f32 v17, v17, v34
    v_mul_f32 v18, v18, v34
    v_mul_f32 v19, v19, v34
    v_mul_f32 v20, v20, v34
    v_mul_f32 v21, v21, v34
    v_mul_f32 v22, v22, v34
    v_mul_f32 v23, v23, v34
    v_mul_f32 v24, v24, v34
    v_mul_f32 v25, v25, v34
    v_mul_f32 v26, v26, v34
    v_mul_f32 v27, v27, v34
    v_mul_f32 v28, v28, v34
    v_mul_f32 v29, v29, v34
    v_mul_f32 v30, v30, v34
    v_cvt_pk_bf16_f32 v4, v13, v14
    v_cvt_pk_bf16_f32 v5, v15, v16
    v_cvt_pk_bf16_f32 v6, v17, v18
    v_cvt_pk_bf16_f32 v7, v19, v20
    v_cvt_pk_bf16_f32 v8, v21, v22
    v_cvt_pk_bf16_f32 v9, v23, v24
    v_cvt_pk_bf16_f32 v10, v25, v26
    v_cvt_pk_bf16_f32 v11, v27, v28
    v_cvt_pk_bf16_f32 v12, v29, v30
    buffer_store_dwordx4 v[4:7], v2, s[12:15], 0 offen
    buffer_store_dwordx4 v[8:11], v2, s[12:15], 0 offen offset:16
    buffer_store_dword v12, v2, s[12:15], 0 offen offset:32
ln0_kernel_done:
    s_endpgm
.globl op0_kernel
.p2align 8
.type op0_kernel,@function
op0_kernel:
    s_load_dwordx2 s[4:5], s[0:1], 72
    s_load_dwordx2 s[6:7], s[0:1], 24
    s_load_dwordx2 s[8:9], s[0:1], 72
    s_load_dwordx2 s[10:11], s[0:1], 0
    s_cmp_ge_u32 s2, 144
    s_cbranch_scc1 op0_kernel_done
    s_waitcnt lgkmcnt(0)
    s_add_u32 s4, s4, 0x900000
    s_addc_u32 s5, s5, 0
    s_add_u32 s8, s8, 0xb40000
    s_addc_u32 s9, s9, 0
    s_mov_b32 s12, s4
    s_and_b32 s13, s5, 0xffff
    s_mov_b32 s14, 0x240000
    s_mov_b32 s15, 0x20000
    s_mov_b32 s16, s6
    s_and_b32 s17, s7, 0xffff
    s_mov_b32 s18, 0xa2000
    s_mov_b32 s19, 0x20000
    s_mov_b32 s20, s8
    s_and_b32 s21, s9, 0xffff
    s_mov_b32 s22, 0x240000
    s_mov_b32 s23, 0x20000
    s_mov_b32 s24, s10
    s_and_b32 s25, s11, 0xffff
    s_mov_b32 s26, 0x240000
    s_mov_b32 s27, 0x20000
    s_mov_b32 s30, 0x1c71c71d
    s_mul_hi_u32 s28, s2, s30
    s_mul_i32 s30, s28, 9
    s_sub_u32 s29, s2, s30
    s_lshl_b32 s30, s28, 7
    v_lshrrev_b32 v7, 1, v0
    v_add_u32 v8, s30, v7
    v_mul_u32_u24 v1, 1152, v8
    v_and_b32 v8, 1, v0
    v_lshlrev_b32 v8, 6, v8
    v_add_u32 v1, v1, v8
    v_mul_u32_u24 v3, 144, v7
    v_add_u32 v3, v3, v8
    v_lshrrev_b32 v7, 2, v0
    v_mul_u32_u24 v2, 1152, v7
    v_and_b32 v8, 3, v0
    v_lshlrev_b32 v8, 5, v8
    v_add_u32 v2, v2, v8
    s_lshl_b32 s31, s29, 7
    v_add_u32 v2, s31, v2
    v_mul_u32_u24 v4, 192, v7
    v_add_u32 v4, v4, v8
    v_add_u32 v4, 18432, v4
    v_lshrrev_b32 v7, 6, v0
    v_lshlrev_b32 v7, 5, v7
    v_and_b32 v8, 31, v0
    v_add_u32 v7, v7, v8
    v_mul_u32_u24 v5, 144, v7
    v_bfe_u32 v8, v0, 5, 1
    v_lshlrev_b32 v8, 4, v8
    v_add_u32 v5, v5, v8
    v_bfe_u32 v7, v0, 5, 1
    v_lshlrev_b32 v7, 3, v7
    v_bfe_u32 v8, v0, 2, 2
    v_add_u32 v7, v7, v8
    v_mul_u32_u24 v6, 192, v7
    v_bfe_u32 v7, v0, 4, 1
    v_lshlrev_b32 v7, 5, v7
    v_and_b32 v8, 3, v0
    v_lshlrev_b32 v8, 3, v8
    v_add3_u32 v6, v6, v7, v8
    v_add_u32 v6, 18432, v6
    v_mov_b32 v108, 0
    v_mov_b32 v109, 0
    v_mov_b32 v110, 0
    v_mov_b32 v111, 0
    v_mov_b32 v112, 0
    v_mov_b32 v113, 0
    v_mov_b32 v114, 0
    v_mov_b32 v115, 0
    v_mov_b32 v116, 0
    v_mov_b32 v117, 0
    v_mov_b32 v118, 0
    v_mov_b32 v119, 0
    v_mov_b32 v120, 0
    v_mov_b32 v121, 0
    v_mov_b32 v122, 0
    v_mov_b32 v123, 0
    v_mov_b32 v124, 0
    v_mov_b32 v125, 0
    v_mov_b32 v126, 0
    v_mov_b32 v127, 0
    v_mov_b32 v128, 0
    v_mov_b32 v129, 0
    v_mov_b32 v130, 0
    v_mov_b32 v131, 0
    v_mov_b32 v132, 0
    v_mov_b32 v133, 0
    v_mov_b32 v134, 0
    v_mov_b32 v135, 0
    v_mov_b32 v136, 0
    v_mov_b32 v137, 0
    v_mov_b32 v138, 0
    v_mov_b32 v139, 0
    buffer_load_dwordx4 v[12:15], v1, s[12:15], 0 offen offset:0
    buffer_load_dwordx4 v[16:19], v1, s[12:15], 0 offen offset:16
    buffer_load_dwordx4 v[20:23], v1, s[12:15], 0 offen offset:32
    buffer_load_dwordx4 v[24:27], v1, s[12:15], 0 offen offset:48
    s_mov_b32 s32, 0x0
    buffer_load_dwordx4 v[44:47], v2, s[16:19], s32 offen offset:0
    buffer_load_dwordx4 v[48:51], v2, s[16:19], s32 offen offset:16
    buffer_load_dwordx4 v[28:31], v1, s[12:15], 0 offen offset:128
    buffer_load_dwordx4 v[32:35], v1, s[12:15], 0 offen offset:144
    buffer_load_dwordx4 v[36:39], v1, s[12:15], 0 offen offset:160
    buffer_load_dwordx4 v[40:43], v1, s[12:15], 0 offen offset:176
    s_mov_b32 s32, 0x12000
    buffer_load_dwordx4 v[52:55], v2, s[16:19], s32 offen offset:0
    buffer_load_dwordx4 v[56:59], v2, s[16:19], s32 offen offset:16
    s_waitcnt vmcnt(6)
    ds_write_b128 v3, v[12:15] offset:0
    ds_write_b128 v3, v[16:19] offset:16
    ds_write_b128 v3, v[20:23] offset:32
    ds_write_b128 v3, v[24:27] offset:48
    ds_write_b128 v4, v[44:47] offset:0
    ds_write_b128 v4, v[48:51] offset:16
    s_waitcnt lgkmcnt(0)
    s_barrier
    buffer_load_dwordx4 v[12:15], v1, s[12:15], 0 offen offset:256
    buffer_load_dwordx4 v[16:19], v1, s[12:15], 0 offen offset:272
    buffer_load_dwordx4 v[20:23], v1, s[12:15], 0 offen offset:288
    buffer_load_dwordx4 v[24:27], v1, s[12:15], 0 offen offset:304
    s_mov_b32 s32, 0x24000
    buffer_load_dwordx4 v[44:47], v2, s[16:19], s32 offen offset:0
    buffer_load_dwordx4 v[48:51], v2, s[16:19], s32 offen offset:16
    ds_read_b128 v[60:63], v5 offset:0
    ds_read_b64_tr_b16 v[76:77], v6 offset:0
    ds_read_b64_tr_b16 v[78:79], v6 offset:768
    ds_read_b64_tr_b16 v[80:81], v6 offset:64
    ds_read_b64_tr_b16 v[82:83], v6 offset:832
    ds_read_b128 v[64:67], v5 offset:32
    ds_read_b64_tr_b16 v[84:85], v6 offset:3072
    ds_read_b64_tr_b16 v[86:87], v6 offset:3840
    ds_read_b64_tr_b16 v[88:89], v6 offset:3136
    ds_read_b64_tr_b16 v[90:91], v6 offset:3904
    ds_read_b128 v[68:71], v5 offset:64
    ds_read_b64_tr_b16 v[92:93], v6 offset:6144
    ds_read_b64_tr_b16 v[94:95], v6 offset:6912
    ds_read_b64_tr_b16 v[96:97], v6 offset:6208
    ds_read_b64_tr_b16 v[98:99], v6 offset:6976
    ds_read_b128 v[72:75], v5 offset:96
    ds_read_b64_tr_b16 v[100:101], v6 offset:9216
    ds_read_b64_tr_b16 v[102:103], v6 offset:9984
    ds_read_b64_tr_b16 v[104:105], v6 offset:9280
    ds_read_b64_tr_b16 v[106:107], v6 offset:10048
    s_waitcnt lgkmcnt(15)
    v_mfma_f32_32x32x16_bf16 v[108:123], v[76:79], v[60:63], v[108:123]
    v_mfma_f32_32x32x16_bf16 v[124:139], v[80:83], v[60:63], v[124:139]
    s_waitcnt lgkmcnt(10)
    v_mfma_f32_32x32x16_bf16 v[108:123], v[84:87], v[64:67], v[108:123]
    v_mfma_f32_32x32x16_bf16 v[124:139], v[88:91], v[64:67], v[124:139]
    s_waitcnt lgkmcnt(5)
    v_mfma_f32_32x32x16_bf16 v[108:123], v[92:95], v[68:71], v[108:123]
    v_mfma_f32_32x32x16_bf16 v[124:139], v[96:99], v[68:71], v[124:139]
    s_waitcnt lgkmcnt(0)
    v_mfma_f32_32x32x16_bf16 v[108:123], v[100:103], v[72:75], v[108:123]
    v_mfma_f32_32x32x16_bf16 v[124:139], v[104:107], v[72:75], v[124:139]
    s_waitcnt vmcnt(6)
    ds_write_b128 v3, v[28:31] offset:30720
    ds_write_b128 v3, v[32:35] offset:30736
    ds_write_b128 v3, v[36:39] offset:30752
    ds_write_b128 v3, v[40:43] offset:30768
    ds_write_b128 v4, v[52:55] offset:30720
    ds_write_b128 v4, v[56:59] offset:30736
    s_waitcnt lgkmcnt(0)
    s_barrier
    buffer_load_dwordx4 v[28:31], v1, s[12:15], 0 offen offset:384
    buffer_load_dwordx4 v[32:35], v1, s[12:15], 0 offen offset:400
    buffer_load_dwordx4 v[36:39], v1, s[12:15], 0 offen offset:416
    buffer_load_dwordx4 v[40:43], v1, s[12:15], 0 offen offset:432
    s_mov_b32 s32, 0x36000
    buffer_load_dwordx4 v[52:55], v2, s[16:19], s32 offen offset:0
    buffer_load_dwordx4 v[56:59], v2, s[16:19], s32 offen offset:16
    ds_read_b128 v[60:63], v5 offset:30720
    ds_read_b64_tr_b16 v[76:77], v6 offset:30720
    ds_read_b64_tr_b16 v[78:79], v6 offset:31488
    ds_read_b64_tr_b16 v[80:81], v6 offset:30784
    ds_read_b64_tr_b16 v[82:83], v6 offset:31552
    ds_read_b128 v[64:67], v5 offset:30752
    ds_read_b64_tr_b16 v[84:85], v6 offset:33792
    ds_read_b64_tr_b16 v[86:87], v6 offset:34560
    ds_read_b64_tr_b16 v[88:89], v6 offset:33856
    ds_read_b64_tr_b16 v[90:91], v6 offset:34624
    ds_read_b128 v[68:71], v5 offset:30784
    ds_read_b64_tr_b16 v[92:93], v6 offset:36864
    ds_read_b64_tr_b16 v[94:95], v6 offset:37632
    ds_read_b64_tr_b16 v[96:97], v6 offset:36928
    ds_read_b64_tr_b16 v[98:99], v6 offset:37696
    ds_read_b128 v[72:75], v5 offset:30816
    ds_read_b64_tr_b16 v[100:101], v6 offset:39936
    ds_read_b64_tr_b16 v[102:103], v6 offset:40704
    ds_read_b64_tr_b16 v[104:105], v6 offset:40000
    ds_read_b64_tr_b16 v[106:107], v6 offset:40768
    s_waitcnt lgkmcnt(15)
    v_mfma_f32_32x32x16_bf16 v[108:123], v[76:79], v[60:63], v[108:123]
    v_mfma_f32_32x32x16_bf16 v[124:139], v[80:83], v[60:63], v[124:139]
    s_waitcnt lgkmcnt(10)
    v_mfma_f32_32x32x16_bf16 v[108:123], v[84:87], v[64:67], v[108:123]
    v_mfma_f32_32x32x16_bf16 v[124:139], v[88:91], v[64:67], v[124:139]
    s_waitcnt lgkmcnt(5)
    v_mfma_f32_32x32x16_bf16 v[108:123], v[92:95], v[68:71], v[108:123]
    v_mfma_f32_32x32x16_bf16 v[124:139], v[96:99], v[68:71], v[124:139]
    s_waitcnt lgkmcnt(0)
    v_mfma_f32_32x32x16_bf16 v[108:123], v[100:103], v[72:75], v[108:123]
    v_mfma_f32_32x32x16_bf16 v[124:139], v[104:107], v[72:75], v[124:139]
    s_waitcnt vmcnt(6)
    ds_write_b128 v3, v[12:15] offset:0
    ds_write_b128 v3, v[16:19] offset:16
    ds_write_b128 v3, v[20:23] offset:32
    ds_write_b128 v3, v[24:27] offset:48
    ds_write_b128 v4, v[44:47] offset:0
    ds_write_b128 v4, v[48:51] offset:16
    s_waitcnt lgkmcnt(0)
    s_barrier
    buffer_load_dwordx4 v[12:15], v1, s[12:15], 0 offen offset:512
    buffer_load_dwordx4 v[16:19], v1, s[12:15], 0 offen offset:528
    buffer_load_dwordx4 v[20:23], v1, s[12:15], 0 offen offset:544
    buffer_load_dwordx4 v[24:27], v1, s[12:15], 0 offen offset:560
    s_mov_b32 s32, 0x48000
    buffer_load_dwordx4 v[44:47], v2, s[16:19], s32 offen offset:0
    buffer_load_dwordx4 v[48:51], v2, s[16:19], s32 offen offset:16
    ds_read_b128 v[60:63], v5 offset:0
    ds_read_b64_tr_b16 v[76:77], v6 offset:0
    ds_read_b64_tr_b16 v[78:79], v6 offset:768
    ds_read_b64_tr_b16 v[80:81], v6 offset:64
    ds_read_b64_tr_b16 v[82:83], v6 offset:832
    ds_read_b128 v[64:67], v5 offset:32
    ds_read_b64_tr_b16 v[84:85], v6 offset:3072
    ds_read_b64_tr_b16 v[86:87], v6 offset:3840
    ds_read_b64_tr_b16 v[88:89], v6 offset:3136
    ds_read_b64_tr_b16 v[90:91], v6 offset:3904
    ds_read_b128 v[68:71], v5 offset:64
    ds_read_b64_tr_b16 v[92:93], v6 offset:6144
    ds_read_b64_tr_b16 v[94:95], v6 offset:6912
    ds_read_b64_tr_b16 v[96:97], v6 offset:6208
    ds_read_b64_tr_b16 v[98:99], v6 offset:6976
    ds_read_b128 v[72:75], v5 offset:96
    ds_read_b64_tr_b16 v[100:101], v6 offset:9216
    ds_read_b64_tr_b16 v[102:103], v6 offset:9984
    ds_read_b64_tr_b16 v[104:105], v6 offset:9280
    ds_read_b64_tr_b16 v[106:107], v6 offset:10048
    s_waitcnt lgkmcnt(15)
    v_mfma_f32_32x32x16_bf16 v[108:123], v[76:79], v[60:63], v[108:123]
    v_mfma_f32_32x32x16_bf16 v[124:139], v[80:83], v[60:63], v[124:139]
    s_waitcnt lgkmcnt(10)
    v_mfma_f32_32x32x16_bf16 v[108:123], v[84:87], v[64:67], v[108:123]
    v_mfma_f32_32x32x16_bf16 v[124:139], v[88:91], v[64:67], v[124:139]
    s_waitcnt lgkmcnt(5)
    v_mfma_f32_32x32x16_bf16 v[108:123], v[92:95], v[68:71], v[108:123]
    v_mfma_f32_32x32x16_bf16 v[124:139], v[96:99], v[68:71], v[124:139]
    s_waitcnt lgkmcnt(0)
    v_mfma_f32_32x32x16_bf16 v[108:123], v[100:103], v[72:75], v[108:123]
    v_mfma_f32_32x32x16_bf16 v[124:139], v[104:107], v[72:75], v[124:139]
    s_waitcnt vmcnt(6)
    ds_write_b128 v3, v[28:31] offset:30720
    ds_write_b128 v3, v[32:35] offset:30736
    ds_write_b128 v3, v[36:39] offset:30752
    ds_write_b128 v3, v[40:43] offset:30768
    ds_write_b128 v4, v[52:55] offset:30720
    ds_write_b128 v4, v[56:59] offset:30736
    s_waitcnt lgkmcnt(0)
    s_barrier
    buffer_load_dwordx4 v[28:31], v1, s[12:15], 0 offen offset:640
    buffer_load_dwordx4 v[32:35], v1, s[12:15], 0 offen offset:656
    buffer_load_dwordx4 v[36:39], v1, s[12:15], 0 offen offset:672
    buffer_load_dwordx4 v[40:43], v1, s[12:15], 0 offen offset:688
    s_mov_b32 s32, 0x5a000
    buffer_load_dwordx4 v[52:55], v2, s[16:19], s32 offen offset:0
    buffer_load_dwordx4 v[56:59], v2, s[16:19], s32 offen offset:16
    ds_read_b128 v[60:63], v5 offset:30720
    ds_read_b64_tr_b16 v[76:77], v6 offset:30720
    ds_read_b64_tr_b16 v[78:79], v6 offset:31488
    ds_read_b64_tr_b16 v[80:81], v6 offset:30784
    ds_read_b64_tr_b16 v[82:83], v6 offset:31552
    ds_read_b128 v[64:67], v5 offset:30752
    ds_read_b64_tr_b16 v[84:85], v6 offset:33792
    ds_read_b64_tr_b16 v[86:87], v6 offset:34560
    ds_read_b64_tr_b16 v[88:89], v6 offset:33856
    ds_read_b64_tr_b16 v[90:91], v6 offset:34624
    ds_read_b128 v[68:71], v5 offset:30784
    ds_read_b64_tr_b16 v[92:93], v6 offset:36864
    ds_read_b64_tr_b16 v[94:95], v6 offset:37632
    ds_read_b64_tr_b16 v[96:97], v6 offset:36928
    ds_read_b64_tr_b16 v[98:99], v6 offset:37696
    ds_read_b128 v[72:75], v5 offset:30816
    ds_read_b64_tr_b16 v[100:101], v6 offset:39936
    ds_read_b64_tr_b16 v[102:103], v6 offset:40704
    ds_read_b64_tr_b16 v[104:105], v6 offset:40000
    ds_read_b64_tr_b16 v[106:107], v6 offset:40768
    s_waitcnt lgkmcnt(15)
    v_mfma_f32_32x32x16_bf16 v[108:123], v[76:79], v[60:63], v[108:123]
    v_mfma_f32_32x32x16_bf16 v[124:139], v[80:83], v[60:63], v[124:139]
    s_waitcnt lgkmcnt(10)
    v_mfma_f32_32x32x16_bf16 v[108:123], v[84:87], v[64:67], v[108:123]
    v_mfma_f32_32x32x16_bf16 v[124:139], v[88:91], v[64:67], v[124:139]
    s_waitcnt lgkmcnt(5)
    v_mfma_f32_32x32x16_bf16 v[108:123], v[92:95], v[68:71], v[108:123]
    v_mfma_f32_32x32x16_bf16 v[124:139], v[96:99], v[68:71], v[124:139]
    s_waitcnt lgkmcnt(0)
    v_mfma_f32_32x32x16_bf16 v[108:123], v[100:103], v[72:75], v[108:123]
    v_mfma_f32_32x32x16_bf16 v[124:139], v[104:107], v[72:75], v[124:139]
    s_waitcnt vmcnt(6)
    ds_write_b128 v3, v[12:15] offset:0
    ds_write_b128 v3, v[16:19] offset:16
    ds_write_b128 v3, v[20:23] offset:32
    ds_write_b128 v3, v[24:27] offset:48
    ds_write_b128 v4, v[44:47] offset:0
    ds_write_b128 v4, v[48:51] offset:16
    s_waitcnt lgkmcnt(0)
    s_barrier
    buffer_load_dwordx4 v[12:15], v1, s[12:15], 0 offen offset:768
    buffer_load_dwordx4 v[16:19], v1, s[12:15], 0 offen offset:784
    buffer_load_dwordx4 v[20:23], v1, s[12:15], 0 offen offset:800
    buffer_load_dwordx4 v[24:27], v1, s[12:15], 0 offen offset:816
    s_mov_b32 s32, 0x6c000
    buffer_load_dwordx4 v[44:47], v2, s[16:19], s32 offen offset:0
    buffer_load_dwordx4 v[48:51], v2, s[16:19], s32 offen offset:16
    ds_read_b128 v[60:63], v5 offset:0
    ds_read_b64_tr_b16 v[76:77], v6 offset:0
    ds_read_b64_tr_b16 v[78:79], v6 offset:768
    ds_read_b64_tr_b16 v[80:81], v6 offset:64
    ds_read_b64_tr_b16 v[82:83], v6 offset:832
    ds_read_b128 v[64:67], v5 offset:32
    ds_read_b64_tr_b16 v[84:85], v6 offset:3072
    ds_read_b64_tr_b16 v[86:87], v6 offset:3840
    ds_read_b64_tr_b16 v[88:89], v6 offset:3136
    ds_read_b64_tr_b16 v[90:91], v6 offset:3904
    ds_read_b128 v[68:71], v5 offset:64
    ds_read_b64_tr_b16 v[92:93], v6 offset:6144
    ds_read_b64_tr_b16 v[94:95], v6 offset:6912
    ds_read_b64_tr_b16 v[96:97], v6 offset:6208
    ds_read_b64_tr_b16 v[98:99], v6 offset:6976
    ds_read_b128 v[72:75], v5 offset:96
    ds_read_b64_tr_b16 v[100:101], v6 offset:9216
    ds_read_b64_tr_b16 v[102:103], v6 offset:9984
    ds_read_b64_tr_b16 v[104:105], v6 offset:9280
    ds_read_b64_tr_b16 v[106:107], v6 offset:10048
    s_waitcnt lgkmcnt(15)
    v_mfma_f32_32x32x16_bf16 v[108:123], v[76:79], v[60:63], v[108:123]
    v_mfma_f32_32x32x16_bf16 v[124:139], v[80:83], v[60:63], v[124:139]
    s_waitcnt lgkmcnt(10)
    v_mfma_f32_32x32x16_bf16 v[108:123], v[84:87], v[64:67], v[108:123]
    v_mfma_f32_32x32x16_bf16 v[124:139], v[88:91], v[64:67], v[124:139]
    s_waitcnt lgkmcnt(5)
    v_mfma_f32_32x32x16_bf16 v[108:123], v[92:95], v[68:71], v[108:123]
    v_mfma_f32_32x32x16_bf16 v[124:139], v[96:99], v[68:71], v[124:139]
    s_waitcnt lgkmcnt(0)
    v_mfma_f32_32x32x16_bf16 v[108:123], v[100:103], v[72:75], v[108:123]
    v_mfma_f32_32x32x16_bf16 v[124:139], v[104:107], v[72:75], v[124:139]
    s_waitcnt vmcnt(6)
    ds_write_b128 v3, v[28:31] offset:30720
    ds_write_b128 v3, v[32:35] offset:30736
    ds_write_b128 v3, v[36:39] offset:30752
    ds_write_b128 v3, v[40:43] offset:30768
    ds_write_b128 v4, v[52:55] offset:30720
    ds_write_b128 v4, v[56:59] offset:30736
    s_waitcnt lgkmcnt(0)
    s_barrier
    buffer_load_dwordx4 v[28:31], v1, s[12:15], 0 offen offset:896
    buffer_load_dwordx4 v[32:35], v1, s[12:15], 0 offen offset:912
    buffer_load_dwordx4 v[36:39], v1, s[12:15], 0 offen offset:928
    buffer_load_dwordx4 v[40:43], v1, s[12:15], 0 offen offset:944
    s_mov_b32 s32, 0x7e000
    buffer_load_dwordx4 v[52:55], v2, s[16:19], s32 offen offset:0
    buffer_load_dwordx4 v[56:59], v2, s[16:19], s32 offen offset:16
    ds_read_b128 v[60:63], v5 offset:30720
    ds_read_b64_tr_b16 v[76:77], v6 offset:30720
    ds_read_b64_tr_b16 v[78:79], v6 offset:31488
    ds_read_b64_tr_b16 v[80:81], v6 offset:30784
    ds_read_b64_tr_b16 v[82:83], v6 offset:31552
    ds_read_b128 v[64:67], v5 offset:30752
    ds_read_b64_tr_b16 v[84:85], v6 offset:33792
    ds_read_b64_tr_b16 v[86:87], v6 offset:34560
    ds_read_b64_tr_b16 v[88:89], v6 offset:33856
    ds_read_b64_tr_b16 v[90:91], v6 offset:34624
    ds_read_b128 v[68:71], v5 offset:30784
    ds_read_b64_tr_b16 v[92:93], v6 offset:36864
    ds_read_b64_tr_b16 v[94:95], v6 offset:37632
    ds_read_b64_tr_b16 v[96:97], v6 offset:36928
    ds_read_b64_tr_b16 v[98:99], v6 offset:37696
    ds_read_b128 v[72:75], v5 offset:30816
    ds_read_b64_tr_b16 v[100:101], v6 offset:39936
    ds_read_b64_tr_b16 v[102:103], v6 offset:40704
    ds_read_b64_tr_b16 v[104:105], v6 offset:40000
    ds_read_b64_tr_b16 v[106:107], v6 offset:40768
    s_waitcnt lgkmcnt(15)
    v_mfma_f32_32x32x16_bf16 v[108:123], v[76:79], v[60:63], v[108:123]
    v_mfma_f32_32x32x16_bf16 v[124:139], v[80:83], v[60:63], v[124:139]
    s_waitcnt lgkmcnt(10)
    v_mfma_f32_32x32x16_bf16 v[108:123], v[84:87], v[64:67], v[108:123]
    v_mfma_f32_32x32x16_bf16 v[124:139], v[88:91], v[64:67], v[124:139]
    s_waitcnt lgkmcnt(5)
    v_mfma_f32_32x32x16_bf16 v[108:123], v[92:95], v[68:71], v[108:123]
    v_mfma_f32_32x32x16_bf16 v[124:139], v[96:99], v[68:71], v[124:139]
    s_waitcnt lgkmcnt(0)
    v_mfma_f32_32x32x16_bf16 v[108:123], v[100:103], v[72:75], v[108:123]
    v_mfma_f32_32x32x16_bf16 v[124:139], v[104:107], v[72:75], v[124:139]
    s_waitcnt vmcnt(6)
    ds_write_b128 v3, v[12:15] offset:0
    ds_write_b128 v3, v[16:19] offset:16
    ds_write_b128 v3, v[20:23] offset:32
    ds_write_b128 v3, v[24:27] offset:48
    ds_write_b128 v4, v[44:47] offset:0
    ds_write_b128 v4, v[48:51] offset:16
    s_waitcnt lgkmcnt(0)
    s_barrier
    buffer_load_dwordx4 v[12:15], v1, s[12:15], 0 offen offset:1024
    buffer_load_dwordx4 v[16:19], v1, s[12:15], 0 offen offset:1040
    buffer_load_dwordx4 v[20:23], v1, s[12:15], 0 offen offset:1056
    buffer_load_dwordx4 v[24:27], v1, s[12:15], 0 offen offset:1072
    s_mov_b32 s32, 0x90000
    buffer_load_dwordx4 v[44:47], v2, s[16:19], s32 offen offset:0
    buffer_load_dwordx4 v[48:51], v2, s[16:19], s32 offen offset:16
    ds_read_b128 v[60:63], v5 offset:0
    ds_read_b64_tr_b16 v[76:77], v6 offset:0
    ds_read_b64_tr_b16 v[78:79], v6 offset:768
    ds_read_b64_tr_b16 v[80:81], v6 offset:64
    ds_read_b64_tr_b16 v[82:83], v6 offset:832
    ds_read_b128 v[64:67], v5 offset:32
    ds_read_b64_tr_b16 v[84:85], v6 offset:3072
    ds_read_b64_tr_b16 v[86:87], v6 offset:3840
    ds_read_b64_tr_b16 v[88:89], v6 offset:3136
    ds_read_b64_tr_b16 v[90:91], v6 offset:3904
    ds_read_b128 v[68:71], v5 offset:64
    ds_read_b64_tr_b16 v[92:93], v6 offset:6144
    ds_read_b64_tr_b16 v[94:95], v6 offset:6912
    ds_read_b64_tr_b16 v[96:97], v6 offset:6208
    ds_read_b64_tr_b16 v[98:99], v6 offset:6976
    ds_read_b128 v[72:75], v5 offset:96
    ds_read_b64_tr_b16 v[100:101], v6 offset:9216
    ds_read_b64_tr_b16 v[102:103], v6 offset:9984
    ds_read_b64_tr_b16 v[104:105], v6 offset:9280
    ds_read_b64_tr_b16 v[106:107], v6 offset:10048
    s_waitcnt lgkmcnt(15)
    v_mfma_f32_32x32x16_bf16 v[108:123], v[76:79], v[60:63], v[108:123]
    v_mfma_f32_32x32x16_bf16 v[124:139], v[80:83], v[60:63], v[124:139]
    s_waitcnt lgkmcnt(10)
    v_mfma_f32_32x32x16_bf16 v[108:123], v[84:87], v[64:67], v[108:123]
    v_mfma_f32_32x32x16_bf16 v[124:139], v[88:91], v[64:67], v[124:139]
    s_waitcnt lgkmcnt(5)
    v_mfma_f32_32x32x16_bf16 v[108:123], v[92:95], v[68:71], v[108:123]
    v_mfma_f32_32x32x16_bf16 v[124:139], v[96:99], v[68:71], v[124:139]
    s_waitcnt lgkmcnt(0)
    v_mfma_f32_32x32x16_bf16 v[108:123], v[100:103], v[72:75], v[108:123]
    v_mfma_f32_32x32x16_bf16 v[124:139], v[104:107], v[72:75], v[124:139]
    s_waitcnt vmcnt(6)
    ds_write_b128 v3, v[28:31] offset:30720
    ds_write_b128 v3, v[32:35] offset:30736
    ds_write_b128 v3, v[36:39] offset:30752
    ds_write_b128 v3, v[40:43] offset:30768
    ds_write_b128 v4, v[52:55] offset:30720
    ds_write_b128 v4, v[56:59] offset:30736
    s_waitcnt lgkmcnt(0)
    s_barrier
    ds_read_b128 v[60:63], v5 offset:30720
    ds_read_b64_tr_b16 v[76:77], v6 offset:30720
    ds_read_b64_tr_b16 v[78:79], v6 offset:31488
    ds_read_b64_tr_b16 v[80:81], v6 offset:30784
    ds_read_b64_tr_b16 v[82:83], v6 offset:31552
    ds_read_b128 v[64:67], v5 offset:30752
    ds_read_b64_tr_b16 v[84:85], v6 offset:33792
    ds_read_b64_tr_b16 v[86:87], v6 offset:34560
    ds_read_b64_tr_b16 v[88:89], v6 offset:33856
    ds_read_b64_tr_b16 v[90:91], v6 offset:34624
    ds_read_b128 v[68:71], v5 offset:30784
    ds_read_b64_tr_b16 v[92:93], v6 offset:36864
    ds_read_b64_tr_b16 v[94:95], v6 offset:37632
    ds_read_b64_tr_b16 v[96:97], v6 offset:36928
    ds_read_b64_tr_b16 v[98:99], v6 offset:37696
    ds_read_b128 v[72:75], v5 offset:30816
    ds_read_b64_tr_b16 v[100:101], v6 offset:39936
    ds_read_b64_tr_b16 v[102:103], v6 offset:40704
    ds_read_b64_tr_b16 v[104:105], v6 offset:40000
    ds_read_b64_tr_b16 v[106:107], v6 offset:40768
    s_waitcnt lgkmcnt(15)
    v_mfma_f32_32x32x16_bf16 v[108:123], v[76:79], v[60:63], v[108:123]
    v_mfma_f32_32x32x16_bf16 v[124:139], v[80:83], v[60:63], v[124:139]
    s_waitcnt lgkmcnt(10)
    v_mfma_f32_32x32x16_bf16 v[108:123], v[84:87], v[64:67], v[108:123]
    v_mfma_f32_32x32x16_bf16 v[124:139], v[88:91], v[64:67], v[124:139]
    s_waitcnt lgkmcnt(5)
    v_mfma_f32_32x32x16_bf16 v[108:123], v[92:95], v[68:71], v[108:123]
    v_mfma_f32_32x32x16_bf16 v[124:139], v[96:99], v[68:71], v[124:139]
    s_waitcnt lgkmcnt(0)
    v_mfma_f32_32x32x16_bf16 v[108:123], v[100:103], v[72:75], v[108:123]
    v_mfma_f32_32x32x16_bf16 v[124:139], v[104:107], v[72:75], v[124:139]
    s_waitcnt vmcnt(0)
    ds_write_b128 v3, v[12:15] offset:0
    ds_write_b128 v3, v[16:19] offset:16
    ds_write_b128 v3, v[20:23] offset:32
    ds_write_b128 v3, v[24:27] offset:48
    ds_write_b128 v4, v[44:47] offset:0
    ds_write_b128 v4, v[48:51] offset:16
    s_waitcnt lgkmcnt(0)
    s_barrier
    ds_read_b128 v[60:63], v5 offset:0
    ds_read_b64_tr_b16 v[76:77], v6 offset:0
    ds_read_b64_tr_b16 v[78:79], v6 offset:768
    ds_read_b64_tr_b16 v[80:81], v6 offset:64
    ds_read_b64_tr_b16 v[82:83], v6 offset:832
    ds_read_b128 v[64:67], v5 offset:32
    ds_read_b64_tr_b16 v[84:85], v6 offset:3072
    ds_read_b64_tr_b16 v[86:87], v6 offset:3840
    ds_read_b64_tr_b16 v[88:89], v6 offset:3136
    ds_read_b64_tr_b16 v[90:91], v6 offset:3904
    ds_read_b128 v[68:71], v5 offset:64
    ds_read_b64_tr_b16 v[92:93], v6 offset:6144
    ds_read_b64_tr_b16 v[94:95], v6 offset:6912
    ds_read_b64_tr_b16 v[96:97], v6 offset:6208
    ds_read_b64_tr_b16 v[98:99], v6 offset:6976
    ds_read_b128 v[72:75], v5 offset:96
    ds_read_b64_tr_b16 v[100:101], v6 offset:9216
    ds_read_b64_tr_b16 v[102:103], v6 offset:9984
    ds_read_b64_tr_b16 v[104:105], v6 offset:9280
    ds_read_b64_tr_b16 v[106:107], v6 offset:10048
    s_waitcnt lgkmcnt(15)
    v_mfma_f32_32x32x16_bf16 v[108:123], v[76:79], v[60:63], v[108:123]
    v_mfma_f32_32x32x16_bf16 v[124:139], v[80:83], v[60:63], v[124:139]
    s_waitcnt lgkmcnt(10)
    v_mfma_f32_32x32x16_bf16 v[108:123], v[84:87], v[64:67], v[108:123]
    v_mfma_f32_32x32x16_bf16 v[124:139], v[88:91], v[64:67], v[124:139]
    s_waitcnt lgkmcnt(5)
    v_mfma_f32_32x32x16_bf16 v[108:123], v[92:95], v[68:71], v[108:123]
    v_mfma_f32_32x32x16_bf16 v[124:139], v[96:99], v[68:71], v[124:139]
    s_waitcnt lgkmcnt(0)
    v_mfma_f32_32x32x16_bf16 v[108:123], v[100:103], v[72:75], v[108:123]
    v_mfma_f32_32x32x16_bf16 v[124:139], v[104:107], v[72:75], v[124:139]
    s_nop 7
    s_nop 7
    v_lshrrev_b32 v7, 6, v0
    v_lshlrev_b32 v7, 5, v7
    v_and_b32 v8, 31, v0
    v_add3_u32 v7, v7, v8, s30
    v_mul_u32_u24 v1, 1152, v7
    v_bfe_u32 v8, v0, 5, 1
    v_lshlrev_b32 v8, 3, v8
    v_add3_u32 v1, v1, v8, s31
    buffer_load_dwordx2 v[60:61], v1, s[24:27], 0 offen offset:0
    buffer_load_dwordx2 v[62:63], v1, s[24:27], 0 offen offset:16
    buffer_load_dwordx2 v[64:65], v1, s[24:27], 0 offen offset:32
    buffer_load_dwordx2 v[66:67], v1, s[24:27], 0 offen offset:48
    buffer_load_dwordx2 v[68:69], v1, s[24:27], 0 offen offset:64
    buffer_load_dwordx2 v[70:71], v1, s[24:27], 0 offen offset:80
    buffer_load_dwordx2 v[72:73], v1, s[24:27], 0 offen offset:96
    buffer_load_dwordx2 v[74:75], v1, s[24:27], 0 offen offset:112
    s_waitcnt vmcnt(0)
    v_cvt_pk_bf16_f32 v76, v108, v109
    v_lshlrev_b32 v108, 16, v76
    v_and_b32 v109, 0xffff0000, v76
    v_lshlrev_b32 v7, 16, v60
    v_and_b32 v8, 0xffff0000, v60
    v_add_f32 v108, v108, v7
    v_add_f32 v109, v109, v8
    v_cvt_pk_bf16_f32 v76, v108, v109
    v_cvt_pk_bf16_f32 v77, v110, v111
    v_lshlrev_b32 v110, 16, v77
    v_and_b32 v111, 0xffff0000, v77
    v_lshlrev_b32 v7, 16, v61
    v_and_b32 v8, 0xffff0000, v61
    v_add_f32 v110, v110, v7
    v_add_f32 v111, v111, v8
    v_cvt_pk_bf16_f32 v77, v110, v111
    buffer_store_dwordx2 v[76:77], v1, s[20:23], 0 offen offset:0
    v_cvt_pk_bf16_f32 v78, v112, v113
    v_lshlrev_b32 v112, 16, v78
    v_and_b32 v113, 0xffff0000, v78
    v_lshlrev_b32 v7, 16, v62
    v_and_b32 v8, 0xffff0000, v62
    v_add_f32 v112, v112, v7
    v_add_f32 v113, v113, v8
    v_cvt_pk_bf16_f32 v78, v112, v113
    v_cvt_pk_bf16_f32 v79, v114, v115
    v_lshlrev_b32 v114, 16, v79
    v_and_b32 v115, 0xffff0000, v79
    v_lshlrev_b32 v7, 16, v63
    v_and_b32 v8, 0xffff0000, v63
    v_add_f32 v114, v114, v7
    v_add_f32 v115, v115, v8
    v_cvt_pk_bf16_f32 v79, v114, v115
    buffer_store_dwordx2 v[78:79], v1, s[20:23], 0 offen offset:16
    v_cvt_pk_bf16_f32 v80, v116, v117
    v_lshlrev_b32 v116, 16, v80
    v_and_b32 v117, 0xffff0000, v80
    v_lshlrev_b32 v7, 16, v64
    v_and_b32 v8, 0xffff0000, v64
    v_add_f32 v116, v116, v7
    v_add_f32 v117, v117, v8
    v_cvt_pk_bf16_f32 v80, v116, v117
    v_cvt_pk_bf16_f32 v81, v118, v119
    v_lshlrev_b32 v118, 16, v81
    v_and_b32 v119, 0xffff0000, v81
    v_lshlrev_b32 v7, 16, v65
    v_and_b32 v8, 0xffff0000, v65
    v_add_f32 v118, v118, v7
    v_add_f32 v119, v119, v8
    v_cvt_pk_bf16_f32 v81, v118, v119
    buffer_store_dwordx2 v[80:81], v1, s[20:23], 0 offen offset:32
    v_cvt_pk_bf16_f32 v82, v120, v121
    v_lshlrev_b32 v120, 16, v82
    v_and_b32 v121, 0xffff0000, v82
    v_lshlrev_b32 v7, 16, v66
    v_and_b32 v8, 0xffff0000, v66
    v_add_f32 v120, v120, v7
    v_add_f32 v121, v121, v8
    v_cvt_pk_bf16_f32 v82, v120, v121
    v_cvt_pk_bf16_f32 v83, v122, v123
    v_lshlrev_b32 v122, 16, v83
    v_and_b32 v123, 0xffff0000, v83
    v_lshlrev_b32 v7, 16, v67
    v_and_b32 v8, 0xffff0000, v67
    v_add_f32 v122, v122, v7
    v_add_f32 v123, v123, v8
    v_cvt_pk_bf16_f32 v83, v122, v123
    buffer_store_dwordx2 v[82:83], v1, s[20:23], 0 offen offset:48
    v_cvt_pk_bf16_f32 v84, v124, v125
    v_lshlrev_b32 v124, 16, v84
    v_and_b32 v125, 0xffff0000, v84
    v_lshlrev_b32 v7, 16, v68
    v_and_b32 v8, 0xffff0000, v68
    v_add_f32 v124, v124, v7
    v_add_f32 v125, v125, v8
    v_cvt_pk_bf16_f32 v84, v124, v125
    v_cvt_pk_bf16_f32 v85, v126, v127
    v_lshlrev_b32 v126, 16, v85
    v_and_b32 v127, 0xffff0000, v85
    v_lshlrev_b32 v7, 16, v69
    v_and_b32 v8, 0xffff0000, v69
    v_add_f32 v126, v126, v7
    v_add_f32 v127, v127, v8
    v_cvt_pk_bf16_f32 v85, v126, v127
    buffer_store_dwordx2 v[84:85], v1, s[20:23], 0 offen offset:64
    v_cvt_pk_bf16_f32 v86, v128, v129
    v_lshlrev_b32 v128, 16, v86
    v_and_b32 v129, 0xffff0000, v86
    v_lshlrev_b32 v7, 16, v70
    v_and_b32 v8, 0xffff0000, v70
    v_add_f32 v128, v128, v7
    v_add_f32 v129, v129, v8
    v_cvt_pk_bf16_f32 v86, v128, v129
    v_cvt_pk_bf16_f32 v87, v130, v131
    v_lshlrev_b32 v130, 16, v87
    v_and_b32 v131, 0xffff0000, v87
    v_lshlrev_b32 v7, 16, v71
    v_and_b32 v8, 0xffff0000, v71
    v_add_f32 v130, v130, v7
    v_add_f32 v131, v131, v8
    v_cvt_pk_bf16_f32 v87, v130, v131
    buffer_store_dwordx2 v[86:87], v1, s[20:23], 0 offen offset:80
    v_cvt_pk_bf16_f32 v88, v132, v133
    v_lshlrev_b32 v132, 16, v88
    v_and_b32 v133, 0xffff0000, v88
    v_lshlrev_b32 v7, 16, v72
    v_and_b32 v8, 0xffff0000, v72
    v_add_f32 v132, v132, v7
    v_add_f32 v133, v133, v8
    v_cvt_pk_bf16_f32 v88, v132, v133
    v_cvt_pk_bf16_f32 v89, v134, v135
    v_lshlrev_b32 v134, 16, v89
    v_and_b32 v135, 0xffff0000, v89
    v_lshlrev_b32 v7, 16, v73
    v_and_b32 v8, 0xffff0000, v73
    v_add_f32 v134, v134, v7
    v_add_f32 v135, v135, v8
    v_cvt_pk_bf16_f32 v89, v134, v135
    buffer_store_dwordx2 v[88:89], v1, s[20:23], 0 offen offset:96
    v_cvt_pk_bf16_f32 v90, v136, v137
    v_lshlrev_b32 v136, 16, v90
    v_and_b32 v137, 0xffff0000, v90
    v_lshlrev_b32 v7, 16, v74
    v_and_b32 v8, 0xffff0000, v74
    v_add_f32 v136, v136, v7
    v_add_f32 v137, v137, v8
    v_cvt_pk_bf16_f32 v90, v136, v137
    v_cvt_pk_bf16_f32 v91, v138, v139
    v_lshlrev_b32 v138, 16, v91
    v_and_b32 v139, 0xffff0000, v91
    v_lshlrev_b32 v7, 16, v75
    v_and_b32 v8, 0xffff0000, v75
    v_add_f32 v138, v138, v7
    v_add_f32 v139, v139, v8
    v_cvt_pk_bf16_f32 v91, v138, v139
    buffer_store_dwordx2 v[90:91], v1, s[20:23], 0 offen offset:112
op0_kernel_done:
    s_endpgm
.globl ln1_kernel
.p2align 8
.type ln1_kernel,@function
ln1_kernel:
    s_load_dwordx2 s[4:5], s[0:1], 72
    s_load_dwordx2 s[6:7], s[0:1], 72
    s_cmp_ge_u32 s2, 256
    s_cbranch_scc1 ln1_kernel_done
    s_waitcnt lgkmcnt(0)
    s_add_u32 s4, s4, 0xb40000
    s_addc_u32 s5, s5, 0
    s_mov_b32 s8, s4
    s_and_b32 s9, s5, 0xffff
    s_mov_b32 s10, 0x240000
    s_mov_b32 s11, 0x20000
    s_mov_b32 s12, s6
    s_and_b32 s13, s7, 0xffff
    s_mov_b32 s14, 0x240000
    s_mov_b32 s15, 0x20000
    s_lshl_b32 s3, s2, 8
    v_add_u32 v1, s3, v0
    v_lshrrev_b32 v2, 5, v1
    v_mul_u32_u24 v2, 1152, v2
    v_and_b32 v1, 31, v1
    v_mul_u32_u24 v1, 36, v1
    v_add_u32 v2, v2, v1
    buffer_load_dwordx4 v[4:7], v2, s[8:11], 0 offen
    buffer_load_dwordx4 v[8:11], v2, s[8:11], 0 offen offset:16
    buffer_load_dword v12, v2, s[8:11], 0 offen offset:32
    s_waitcnt vmcnt(0)
    v_lshlrev_b32 v13, 16, v4
    v_and_b32 v14, 0xffff0000, v4
    v_lshlrev_b32 v15, 16, v5
    v_and_b32 v16, 0xffff0000, v5
    v_lshlrev_b32 v17, 16, v6
    v_and_b32 v18, 0xffff0000, v6
    v_lshlrev_b32 v19, 16, v7
    v_and_b32 v20, 0xffff0000, v7
    v_lshlrev_b32 v21, 16, v8
    v_and_b32 v22, 0xffff0000, v8
    v_lshlrev_b32 v23, 16, v9
    v_and_b32 v24, 0xffff0000, v9
    v_lshlrev_b32 v25, 16, v10
    v_and_b32 v26, 0xffff0000, v10
    v_lshlrev_b32 v27, 16, v11
    v_and_b32 v28, 0xffff0000, v11
    v_lshlrev_b32 v29, 16, v12
    v_and_b32 v30, 0xffff0000, v12
    v_add_f32 v31, v13, v14
    v_add_f32 v31, v31, v15
    v_add_f32 v31, v31, v16
    v_add_f32 v31, v31, v17
    v_add_f32 v31, v31, v18
    v_add_f32 v31, v31, v19
    v_add_f32 v31, v31, v20
    v_add_f32 v31, v31, v21
    v_add_f32 v31, v31, v22
    v_add_f32 v31, v31, v23
    v_add_f32 v31, v31, v24
    v_add_f32 v31, v31, v25
    v_add_f32 v31, v31, v26
    v_add_f32 v31, v31, v27
    v_add_f32 v31, v31, v28
    v_add_f32 v31, v31, v29
    v_add_f32 v31, v31, v30
    ds_swizzle_b32 v32, v31 offset:0x41f
    s_waitcnt lgkmcnt(0)
    v_add_f32 v31, v31, v32
    ds_swizzle_b32 v32, v31 offset:0x81f
    s_waitcnt lgkmcnt(0)
    v_add_f32 v31, v31, v32
    ds_swizzle_b32 v32, v31 offset:0x101f
    s_waitcnt lgkmcnt(0)
    v_add_f32 v31, v31, v32
    ds_swizzle_b32 v32, v31 offset:0x201f
    s_waitcnt lgkmcnt(0)
    v_add_f32 v31, v31, v32
    ds_swizzle_b32 v32, v31 offset:0x401f
    s_waitcnt lgkmcnt(0)
    v_add_f32 v31, v31, v32
    v_mul_f32 v33, 0x3ae38e39, v31
    v_sub_f32 v13, v13, v33
    v_sub_f32 v14, v14, v33
    v_sub_f32 v15, v15, v33
    v_sub_f32 v16, v16, v33
    v_sub_f32 v17, v17, v33
    v_sub_f32 v18, v18, v33
    v_sub_f32 v19, v19, v33
    v_sub_f32 v20, v20, v33
    v_sub_f32 v21, v21, v33
    v_sub_f32 v22, v22, v33
    v_sub_f32 v23, v23, v33
    v_sub_f32 v24, v24, v33
    v_sub_f32 v25, v25, v33
    v_sub_f32 v26, v26, v33
    v_sub_f32 v27, v27, v33
    v_sub_f32 v28, v28, v33
    v_sub_f32 v29, v29, v33
    v_sub_f32 v30, v30, v33
    v_mul_f32 v31, v13, v13
    v_fmac_f32 v31, v14, v14
    v_fmac_f32 v31, v15, v15
    v_fmac_f32 v31, v16, v16
    v_fmac_f32 v31, v17, v17
    v_fmac_f32 v31, v18, v18
    v_fmac_f32 v31, v19, v19
    v_fmac_f32 v31, v20, v20
    v_fmac_f32 v31, v21, v21
    v_fmac_f32 v31, v22, v22
    v_fmac_f32 v31, v23, v23
    v_fmac_f32 v31, v24, v24
    v_fmac_f32 v31, v25, v25
    v_fmac_f32 v31, v26, v26
    v_fmac_f32 v31, v27, v27
    v_fmac_f32 v31, v28, v28
    v_fmac_f32 v31, v29, v29
    v_fmac_f32 v31, v30, v30
    ds_swizzle_b32 v32, v31 offset:0x41f
    s_waitcnt lgkmcnt(0)
    v_add_f32 v31, v31, v32
    ds_swizzle_b32 v32, v31 offset:0x81f
    s_waitcnt lgkmcnt(0)
    v_add_f32 v31, v31, v32
    ds_swizzle_b32 v32, v31 offset:0x101f
    s_waitcnt lgkmcnt(0)
    v_add_f32 v31, v31, v32
    ds_swizzle_b32 v32, v31 offset:0x201f
    s_waitcnt lgkmcnt(0)
    v_add_f32 v31, v31, v32
    ds_swizzle_b32 v32, v31 offset:0x401f
    s_waitcnt lgkmcnt(0)
    v_add_f32 v31, v31, v32
    v_mov_b32 v34, 0x3727c5ac
    v_fmac_f32 v34, 0x3ae38e39, v31
    v_rsq_f32 v34, v34
    s_nop 0
    v_mul_f32 v13, v13, v34
    v_mul_f32 v14, v14, v34
    v_mul_f32 v15, v15, v34
    v_mul_f32 v16, v16, v34
    v_mul_f32 v17, v17, v34
    v_mul_f32 v18, v18, v34
    v_mul_f32 v19, v19, v34
    v_mul_f32 v20, v20, v34
    v_mul_f32 v21, v21, v34
    v_mul_f32 v22, v22, v34
    v_mul_f32 v23, v23, v34
    v_mul_f32 v24, v24, v34
    v_mul_f32 v25, v25, v34
    v_mul_f32 v26, v26, v34
    v_mul_f32 v27, v27, v34
    v_mul_f32 v28, v28, v34
    v_mul_f32 v29, v29, v34
    v_mul_f32 v30, v30, v34
    v_cvt_pk_bf16_f32 v4, v13, v14
    v_cvt_pk_bf16_f32 v5, v15, v16
    v_cvt_pk_bf16_f32 v6, v17, v18
    v_cvt_pk_bf16_f32 v7, v19, v20
    v_cvt_pk_bf16_f32 v8, v21, v22
    v_cvt_pk_bf16_f32 v9, v23, v24
    v_cvt_pk_bf16_f32 v10, v25, v26
    v_cvt_pk_bf16_f32 v11, v27, v28
    v_cvt_pk_bf16_f32 v12, v29, v30
    buffer_store_dwordx4 v[4:7], v2, s[12:15], 0 offen
    buffer_store_dwordx4 v[8:11], v2, s[12:15], 0 offen offset:16
    buffer_store_dword v12, v2, s[12:15], 0 offen offset:32
ln1_kernel_done:
    s_endpgm
.globl op1_kernel
.p2align 8
.type op1_kernel,@function
op1_kernel:
    s_load_dwordx2 s[4:5], s[0:1], 72
    s_load_dwordx2 s[6:7], s[0:1], 48
    s_load_dwordx2 s[8:9], s[0:1], 72
    s_load_dwordx2 s[10:11], s[0:1], 72
    s_cmp_ge_u32 s2, 144
    s_cbranch_scc1 op1_kernel_done
    s_waitcnt lgkmcnt(0)
    s_add_u32 s4, s4, 0x900000
    s_addc_u32 s5, s5, 0
    s_add_u32 s8, s8, 0xd80000
    s_addc_u32 s9, s9, 0
    s_add_u32 s10, s10, 0xb40000
    s_addc_u32 s11, s11, 0
    s_mov_b32 s12, s4
    s_and_b32 s13, s5, 0xffff
    s_mov_b32 s14, 0x240000
    s_mov_b32 s15, 0x20000
    s_mov_b32 s16, s6
    s_and_b32 s17, s7, 0xffff
    s_mov_b32 s18, 0xa2000
    s_mov_b32 s19, 0x20000
    s_mov_b32 s20, s8
    s_and_b32 s21, s9, 0xffff
    s_mov_b32 s22, 0x240000
    s_mov_b32 s23, 0x20000
    s_mov_b32 s24, s10
    s_and_b32 s25, s11, 0xffff
    s_mov_b32 s26, 0x240000
    s_mov_b32 s27, 0x20000
    s_mov_b32 s30, 0x1c71c71d
    s_mul_hi_u32 s28, s2, s30
    s_mul_i32 s30, s28, 9
    s_sub_u32 s29, s2, s30
    s_lshl_b32 s30, s28, 7
    v_lshrrev_b32 v7, 1, v0
    v_add_u32 v8, s30, v7
    v_mul_u32_u24 v1, 1152, v8
    v_and_b32 v8, 1, v0
    v_lshlrev_b32 v8, 6, v8
    v_add_u32 v1, v1, v8
    v_mul_u32_u24 v3, 144, v7
    v_add_u32 v3, v3, v8
    v_lshrrev_b32 v7, 2, v0
    v_mul_u32_u24 v2, 1152, v7
    v_and_b32 v8, 3, v0
    v_lshlrev_b32 v8, 5, v8
    v_add_u32 v2, v2, v8
    s_lshl_b32 s31, s29, 7
    v_add_u32 v2, s31, v2
    v_mul_u32_u24 v4, 192, v7
    v_add_u32 v4, v4, v8
    v_add_u32 v4, 18432, v4
    v_lshrrev_b32 v7, 6, v0
    v_lshlrev_b32 v7, 5, v7
    v_and_b32 v8, 31, v0
    v_add_u32 v7, v7, v8
    v_mul_u32_u24 v5, 144, v7
    v_bfe_u32 v8, v0, 5, 1
    v_lshlrev_b32 v8, 4, v8
    v_add_u32 v5, v5, v8
    v_bfe_u32 v7, v0, 5, 1
    v_lshlrev_b32 v7, 3, v7
    v_bfe_u32 v8, v0, 2, 2
    v_add_u32 v7, v7, v8
    v_mul_u32_u24 v6, 192, v7
    v_bfe_u32 v7, v0, 4, 1
    v_lshlrev_b32 v7, 5, v7
    v_and_b32 v8, 3, v0
    v_lshlrev_b32 v8, 3, v8
    v_add3_u32 v6, v6, v7, v8
    v_add_u32 v6, 18432, v6
    v_mov_b32 v108, 0
    v_mov_b32 v109, 0
    v_mov_b32 v110, 0
    v_mov_b32 v111, 0
    v_mov_b32 v112, 0
    v_mov_b32 v113, 0
    v_mov_b32 v114, 0
    v_mov_b32 v115, 0
    v_mov_b32 v116, 0
    v_mov_b32 v117, 0
    v_mov_b32 v118, 0
    v_mov_b32 v119, 0
    v_mov_b32 v120, 0
    v_mov_b32 v121, 0
    v_mov_b32 v122, 0
    v_mov_b32 v123, 0
    v_mov_b32 v124, 0
    v_mov_b32 v125, 0
    v_mov_b32 v126, 0
    v_mov_b32 v127, 0
    v_mov_b32 v128, 0
    v_mov_b32 v129, 0
    v_mov_b32 v130, 0
    v_mov_b32 v131, 0
    v_mov_b32 v132, 0
    v_mov_b32 v133, 0
    v_mov_b32 v134, 0
    v_mov_b32 v135, 0
    v_mov_b32 v136, 0
    v_mov_b32 v137, 0
    v_mov_b32 v138, 0
    v_mov_b32 v139, 0
    buffer_load_dwordx4 v[12:15], v1, s[12:15], 0 offen offset:0
    buffer_load_dwordx4 v[16:19], v1, s[12:15], 0 offen offset:16
    buffer_load_dwordx4 v[20:23], v1, s[12:15], 0 offen offset:32
    buffer_load_dwordx4 v[24:27], v1, s[12:15], 0 offen offset:48
    s_mov_b32 s32, 0x0
    buffer_load_dwordx4 v[44:47], v2, s[16:19], s32 offen offset:0
    buffer_load_dwordx4 v[48:51], v2, s[16:19], s32 offen offset:16
    buffer_load_dwordx4 v[28:31], v1, s[12:15], 0 offen offset:128
    buffer_load_dwordx4 v[32:35], v1, s[12:15], 0 offen offset:144
    buffer_load_dwordx4 v[36:39], v1, s[12:15], 0 offen offset:160
    buffer_load_dwordx4 v[40:43], v1, s[12:15], 0 offen offset:176
    s_mov_b32 s32, 0x12000
    buffer_load_dwordx4 v[52:55], v2, s[16:19], s32 offen offset:0
    buffer_load_dwordx4 v[56:59], v2, s[16:19], s32 offen offset:16
    s_waitcnt vmcnt(6)
    ds_write_b128 v3, v[12:15] offset:0
    ds_write_b128 v3, v[16:19] offset:16
    ds_write_b128 v3, v[20:23] offset:32
    ds_write_b128 v3, v[24:27] offset:48
    ds_write_b128 v4, v[44:47] offset:0
    ds_write_b128 v4, v[48:51] offset:16
    s_waitcnt lgkmcnt(0)
    s_barrier
    buffer_load_dwordx4 v[12:15], v1, s[12:15], 0 offen offset:256
    buffer_load_dwordx4 v[16:19], v1, s[12:15], 0 offen offset:272
    buffer_load_dwordx4 v[20:23], v1, s[12:15], 0 offen offset:288
    buffer_load_dwordx4 v[24:27], v1, s[12:15], 0 offen offset:304
    s_mov_b32 s32, 0x24000
    buffer_load_dwordx4 v[44:47], v2, s[16:19], s32 offen offset:0
    buffer_load_dwordx4 v[48:51], v2, s[16:19], s32 offen offset:16
    ds_read_b128 v[60:63], v5 offset:0
    ds_read_b64_tr_b16 v[76:77], v6 offset:0
    ds_read_b64_tr_b16 v[78:79], v6 offset:768
    ds_read_b64_tr_b16 v[80:81], v6 offset:64
    ds_read_b64_tr_b16 v[82:83], v6 offset:832
    ds_read_b128 v[64:67], v5 offset:32
    ds_read_b64_tr_b16 v[84:85], v6 offset:3072
    ds_read_b64_tr_b16 v[86:87], v6 offset:3840
    ds_read_b64_tr_b16 v[88:89], v6 offset:3136
    ds_read_b64_tr_b16 v[90:91], v6 offset:3904
    ds_read_b128 v[68:71], v5 offset:64
    ds_read_b64_tr_b16 v[92:93], v6 offset:6144
    ds_read_b64_tr_b16 v[94:95], v6 offset:6912
    ds_read_b64_tr_b16 v[96:97], v6 offset:6208
    ds_read_b64_tr_b16 v[98:99], v6 offset:6976
    ds_read_b128 v[72:75], v5 offset:96
    ds_read_b64_tr_b16 v[100:101], v6 offset:9216
    ds_read_b64_tr_b16 v[102:103], v6 offset:9984
    ds_read_b64_tr_b16 v[104:105], v6 offset:9280
    ds_read_b64_tr_b16 v[106:107], v6 offset:10048
    s_waitcnt lgkmcnt(15)
    v_mfma_f32_32x32x16_bf16 v[108:123], v[76:79], v[60:63], v[108:123]
    v_mfma_f32_32x32x16_bf16 v[124:139], v[80:83], v[60:63], v[124:139]
    s_waitcnt lgkmcnt(10)
    v_mfma_f32_32x32x16_bf16 v[108:123], v[84:87], v[64:67], v[108:123]
    v_mfma_f32_32x32x16_bf16 v[124:139], v[88:91], v[64:67], v[124:139]
    s_waitcnt lgkmcnt(5)
    v_mfma_f32_32x32x16_bf16 v[108:123], v[92:95], v[68:71], v[108:123]
    v_mfma_f32_32x32x16_bf16 v[124:139], v[96:99], v[68:71], v[124:139]
    s_waitcnt lgkmcnt(0)
    v_mfma_f32_32x32x16_bf16 v[108:123], v[100:103], v[72:75], v[108:123]
    v_mfma_f32_32x32x16_bf16 v[124:139], v[104:107], v[72:75], v[124:139]
    s_waitcnt vmcnt(6)
    ds_write_b128 v3, v[28:31] offset:30720
    ds_write_b128 v3, v[32:35] offset:30736
    ds_write_b128 v3, v[36:39] offset:30752
    ds_write_b128 v3, v[40:43] offset:30768
    ds_write_b128 v4, v[52:55] offset:30720
    ds_write_b128 v4, v[56:59] offset:30736
    s_waitcnt lgkmcnt(0)
    s_barrier
    buffer_load_dwordx4 v[28:31], v1, s[12:15], 0 offen offset:384
    buffer_load_dwordx4 v[32:35], v1, s[12:15], 0 offen offset:400
    buffer_load_dwordx4 v[36:39], v1, s[12:15], 0 offen offset:416
    buffer_load_dwordx4 v[40:43], v1, s[12:15], 0 offen offset:432
    s_mov_b32 s32, 0x36000
    buffer_load_dwordx4 v[52:55], v2, s[16:19], s32 offen offset:0
    buffer_load_dwordx4 v[56:59], v2, s[16:19], s32 offen offset:16
    ds_read_b128 v[60:63], v5 offset:30720
    ds_read_b64_tr_b16 v[76:77], v6 offset:30720
    ds_read_b64_tr_b16 v[78:79], v6 offset:31488
    ds_read_b64_tr_b16 v[80:81], v6 offset:30784
    ds_read_b64_tr_b16 v[82:83], v6 offset:31552
    ds_read_b128 v[64:67], v5 offset:30752
    ds_read_b64_tr_b16 v[84:85], v6 offset:33792
    ds_read_b64_tr_b16 v[86:87], v6 offset:34560
    ds_read_b64_tr_b16 v[88:89], v6 offset:33856
    ds_read_b64_tr_b16 v[90:91], v6 offset:34624
    ds_read_b128 v[68:71], v5 offset:30784
    ds_read_b64_tr_b16 v[92:93], v6 offset:36864
    ds_read_b64_tr_b16 v[94:95], v6 offset:37632
    ds_read_b64_tr_b16 v[96:97], v6 offset:36928
    ds_read_b64_tr_b16 v[98:99], v6 offset:37696
    ds_read_b128 v[72:75], v5 offset:30816
    ds_read_b64_tr_b16 v[100:101], v6 offset:39936
    ds_read_b64_tr_b16 v[102:103], v6 offset:40704
    ds_read_b64_tr_b16 v[104:105], v6 offset:40000
    ds_read_b64_tr_b16 v[106:107], v6 offset:40768
    s_waitcnt lgkmcnt(15)
    v_mfma_f32_32x32x16_bf16 v[108:123], v[76:79], v[60:63], v[108:123]
    v_mfma_f32_32x32x16_bf16 v[124:139], v[80:83], v[60:63], v[124:139]
    s_waitcnt lgkmcnt(10)
    v_mfma_f32_32x32x16_bf16 v[108:123], v[84:87], v[64:67], v[108:123]
    v_mfma_f32_32x32x16_bf16 v[124:139], v[88:91], v[64:67], v[124:139]
    s_waitcnt lgkmcnt(5)
    v_mfma_f32_32x32x16_bf16 v[108:123], v[92:95], v[68:71], v[108:123]
    v_mfma_f32_32x32x16_bf16 v[124:139], v[96:99], v[68:71], v[124:139]
    s_waitcnt lgkmcnt(0)
    v_mfma_f32_32x32x16_bf16 v[108:123], v[100:103], v[72:75], v[108:123]
    v_mfma_f32_32x32x16_bf16 v[124:139], v[104:107], v[72:75], v[124:139]
    s_waitcnt vmcnt(6)
    ds_write_b128 v3, v[12:15] offset:0
    ds_write_b128 v3, v[16:19] offset:16
    ds_write_b128 v3, v[20:23] offset:32
    ds_write_b128 v3, v[24:27] offset:48
    ds_write_b128 v4, v[44:47] offset:0
    ds_write_b128 v4, v[48:51] offset:16
    s_waitcnt lgkmcnt(0)
    s_barrier
    buffer_load_dwordx4 v[12:15], v1, s[12:15], 0 offen offset:512
    buffer_load_dwordx4 v[16:19], v1, s[12:15], 0 offen offset:528
    buffer_load_dwordx4 v[20:23], v1, s[12:15], 0 offen offset:544
    buffer_load_dwordx4 v[24:27], v1, s[12:15], 0 offen offset:560
    s_mov_b32 s32, 0x48000
    buffer_load_dwordx4 v[44:47], v2, s[16:19], s32 offen offset:0
    buffer_load_dwordx4 v[48:51], v2, s[16:19], s32 offen offset:16
    ds_read_b128 v[60:63], v5 offset:0
    ds_read_b64_tr_b16 v[76:77], v6 offset:0
    ds_read_b64_tr_b16 v[78:79], v6 offset:768
    ds_read_b64_tr_b16 v[80:81], v6 offset:64
    ds_read_b64_tr_b16 v[82:83], v6 offset:832
    ds_read_b128 v[64:67], v5 offset:32
    ds_read_b64_tr_b16 v[84:85], v6 offset:3072
    ds_read_b64_tr_b16 v[86:87], v6 offset:3840
    ds_read_b64_tr_b16 v[88:89], v6 offset:3136
    ds_read_b64_tr_b16 v[90:91], v6 offset:3904
    ds_read_b128 v[68:71], v5 offset:64
    ds_read_b64_tr_b16 v[92:93], v6 offset:6144
    ds_read_b64_tr_b16 v[94:95], v6 offset:6912
    ds_read_b64_tr_b16 v[96:97], v6 offset:6208
    ds_read_b64_tr_b16 v[98:99], v6 offset:6976
    ds_read_b128 v[72:75], v5 offset:96
    ds_read_b64_tr_b16 v[100:101], v6 offset:9216
    ds_read_b64_tr_b16 v[102:103], v6 offset:9984
    ds_read_b64_tr_b16 v[104:105], v6 offset:9280
    ds_read_b64_tr_b16 v[106:107], v6 offset:10048
    s_waitcnt lgkmcnt(15)
    v_mfma_f32_32x32x16_bf16 v[108:123], v[76:79], v[60:63], v[108:123]
    v_mfma_f32_32x32x16_bf16 v[124:139], v[80:83], v[60:63], v[124:139]
    s_waitcnt lgkmcnt(10)
    v_mfma_f32_32x32x16_bf16 v[108:123], v[84:87], v[64:67], v[108:123]
    v_mfma_f32_32x32x16_bf16 v[124:139], v[88:91], v[64:67], v[124:139]
    s_waitcnt lgkmcnt(5)
    v_mfma_f32_32x32x16_bf16 v[108:123], v[92:95], v[68:71], v[108:123]
    v_mfma_f32_32x32x16_bf16 v[124:139], v[96:99], v[68:71], v[124:139]
    s_waitcnt lgkmcnt(0)
    v_mfma_f32_32x32x16_bf16 v[108:123], v[100:103], v[72:75], v[108:123]
    v_mfma_f32_32x32x16_bf16 v[124:139], v[104:107], v[72:75], v[124:139]
    s_waitcnt vmcnt(6)
    ds_write_b128 v3, v[28:31] offset:30720
    ds_write_b128 v3, v[32:35] offset:30736
    ds_write_b128 v3, v[36:39] offset:30752
    ds_write_b128 v3, v[40:43] offset:30768
    ds_write_b128 v4, v[52:55] offset:30720
    ds_write_b128 v4, v[56:59] offset:30736
    s_waitcnt lgkmcnt(0)
    s_barrier
    buffer_load_dwordx4 v[28:31], v1, s[12:15], 0 offen offset:640
    buffer_load_dwordx4 v[32:35], v1, s[12:15], 0 offen offset:656
    buffer_load_dwordx4 v[36:39], v1, s[12:15], 0 offen offset:672
    buffer_load_dwordx4 v[40:43], v1, s[12:15], 0 offen offset:688
    s_mov_b32 s32, 0x5a000
    buffer_load_dwordx4 v[52:55], v2, s[16:19], s32 offen offset:0
    buffer_load_dwordx4 v[56:59], v2, s[16:19], s32 offen offset:16
    ds_read_b128 v[60:63], v5 offset:30720
    ds_read_b64_tr_b16 v[76:77], v6 offset:30720
    ds_read_b64_tr_b16 v[78:79], v6 offset:31488
    ds_read_b64_tr_b16 v[80:81], v6 offset:30784
    ds_read_b64_tr_b16 v[82:83], v6 offset:31552
    ds_read_b128 v[64:67], v5 offset:30752
    ds_read_b64_tr_b16 v[84:85], v6 offset:33792
    ds_read_b64_tr_b16 v[86:87], v6 offset:34560
    ds_read_b64_tr_b16 v[88:89], v6 offset:33856
    ds_read_b64_tr_b16 v[90:91], v6 offset:34624
    ds_read_b128 v[68:71], v5 offset:30784
    ds_read_b64_tr_b16 v[92:93], v6 offset:36864
    ds_read_b64_tr_b16 v[94:95], v6 offset:37632
    ds_read_b64_tr_b16 v[96:97], v6 offset:36928
    ds_read_b64_tr_b16 v[98:99], v6 offset:37696
    ds_read_b128 v[72:75], v5 offset:30816
    ds_read_b64_tr_b16 v[100:101], v6 offset:39936
    ds_read_b64_tr_b16 v[102:103], v6 offset:40704
    ds_read_b64_tr_b16 v[104:105], v6 offset:40000
    ds_read_b64_tr_b16 v[106:107], v6 offset:40768
    s_waitcnt lgkmcnt(15)
    v_mfma_f32_32x32x16_bf16 v[108:123], v[76:79], v[60:63], v[108:123]
    v_mfma_f32_32x32x16_bf16 v[124:139], v[80:83], v[60:63], v[124:139]
    s_waitcnt lgkmcnt(10)
    v_mfma_f32_32x32x16_bf16 v[108:123], v[84:87], v[64:67], v[108:123]
    v_mfma_f32_32x32x16_bf16 v[124:139], v[88:91], v[64:67], v[124:139]
    s_waitcnt lgkmcnt(5)
    v_mfma_f32_32x32x16_bf16 v[108:123], v[92:95], v[68:71], v[108:123]
    v_mfma_f32_32x32x16_bf16 v[124:139], v[96:99], v[68:71], v[124:139]
    s_waitcnt lgkmcnt(0)
    v_mfma_f32_32x32x16_bf16 v[108:123], v[100:103], v[72:75], v[108:123]
    v_mfma_f32_32x32x16_bf16 v[124:139], v[104:107], v[72:75], v[124:139]
    s_waitcnt vmcnt(6)
    ds_write_b128 v3, v[12:15] offset:0
    ds_write_b128 v3, v[16:19] offset:16
    ds_write_b128 v3, v[20:23] offset:32
    ds_write_b128 v3, v[24:27] offset:48
    ds_write_b128 v4, v[44:47] offset:0
    ds_write_b128 v4, v[48:51] offset:16
    s_waitcnt lgkmcnt(0)
    s_barrier
    buffer_load_dwordx4 v[12:15], v1, s[12:15], 0 offen offset:768
    buffer_load_dwordx4 v[16:19], v1, s[12:15], 0 offen offset:784
    buffer_load_dwordx4 v[20:23], v1, s[12:15], 0 offen offset:800
    buffer_load_dwordx4 v[24:27], v1, s[12:15], 0 offen offset:816
    s_mov_b32 s32, 0x6c000
    buffer_load_dwordx4 v[44:47], v2, s[16:19], s32 offen offset:0
    buffer_load_dwordx4 v[48:51], v2, s[16:19], s32 offen offset:16
    ds_read_b128 v[60:63], v5 offset:0
    ds_read_b64_tr_b16 v[76:77], v6 offset:0
    ds_read_b64_tr_b16 v[78:79], v6 offset:768
    ds_read_b64_tr_b16 v[80:81], v6 offset:64
    ds_read_b64_tr_b16 v[82:83], v6 offset:832
    ds_read_b128 v[64:67], v5 offset:32
    ds_read_b64_tr_b16 v[84:85], v6 offset:3072
    ds_read_b64_tr_b16 v[86:87], v6 offset:3840
    ds_read_b64_tr_b16 v[88:89], v6 offset:3136
    ds_read_b64_tr_b16 v[90:91], v6 offset:3904
    ds_read_b128 v[68:71], v5 offset:64
    ds_read_b64_tr_b16 v[92:93], v6 offset:6144
    ds_read_b64_tr_b16 v[94:95], v6 offset:6912
    ds_read_b64_tr_b16 v[96:97], v6 offset:6208
    ds_read_b64_tr_b16 v[98:99], v6 offset:6976
    ds_read_b128 v[72:75], v5 offset:96
    ds_read_b64_tr_b16 v[100:101], v6 offset:9216
    ds_read_b64_tr_b16 v[102:103], v6 offset:9984
    ds_read_b64_tr_b16 v[104:105], v6 offset:9280
    ds_read_b64_tr_b16 v[106:107], v6 offset:10048
    s_waitcnt lgkmcnt(15)
    v_mfma_f32_32x32x16_bf16 v[108:123], v[76:79], v[60:63], v[108:123]
    v_mfma_f32_32x32x16_bf16 v[124:139], v[80:83], v[60:63], v[124:139]
    s_waitcnt lgkmcnt(10)
    v_mfma_f32_32x32x16_bf16 v[108:123], v[84:87], v[64:67], v[108:123]
    v_mfma_f32_32x32x16_bf16 v[124:139], v[88:91], v[64:67], v[124:139]
    s_waitcnt lgkmcnt(5)
    v_mfma_f32_32x32x16_bf16 v[108:123], v[92:95], v[68:71], v[108:123]
    v_mfma_f32_32x32x16_bf16 v[124:139], v[96:99], v[68:71], v[124:139]
    s_waitcnt lgkmcnt(0)
    v_mfma_f32_32x32x16_bf16 v[108:123], v[100:103], v[72:75], v[108:123]
    v_mfma_f32_32x32x16_bf16 v[124:139], v[104:107], v[72:75], v[124:139]
    s_waitcnt vmcnt(6)
    ds_write_b128 v3, v[28:31] offset:30720
    ds_write_b128 v3, v[32:35] offset:30736
    ds_write_b128 v3, v[36:39] offset:30752
    ds_write_b128 v3, v[40:43] offset:30768
    ds_write_b128 v4, v[52:55] offset:30720
    ds_write_b128 v4, v[56:59] offset:30736
    s_waitcnt lgkmcnt(0)
    s_barrier
    buffer_load_dwordx4 v[28:31], v1, s[12:15], 0 offen offset:896
    buffer_load_dwordx4 v[32:35], v1, s[12:15], 0 offen offset:912
    buffer_load_dwordx4 v[36:39], v1, s[12:15], 0 offen offset:928
    buffer_load_dwordx4 v[40:43], v1, s[12:15], 0 offen offset:944
    s_mov_b32 s32, 0x7e000
    buffer_load_dwordx4 v[52:55], v2, s[16:19], s32 offen offset:0
    buffer_load_dwordx4 v[56:59], v2, s[16:19], s32 offen offset:16
    ds_read_b128 v[60:63], v5 offset:30720
    ds_read_b64_tr_b16 v[76:77], v6 offset:30720
    ds_read_b64_tr_b16 v[78:79], v6 offset:31488
    ds_read_b64_tr_b16 v[80:81], v6 offset:30784
    ds_read_b64_tr_b16 v[82:83], v6 offset:31552
    ds_read_b128 v[64:67], v5 offset:30752
    ds_read_b64_tr_b16 v[84:85], v6 offset:33792
    ds_read_b64_tr_b16 v[86:87], v6 offset:34560
    ds_read_b64_tr_b16 v[88:89], v6 offset:33856
    ds_read_b64_tr_b16 v[90:91], v6 offset:34624
    ds_read_b128 v[68:71], v5 offset:30784
    ds_read_b64_tr_b16 v[92:93], v6 offset:36864
    ds_read_b64_tr_b16 v[94:95], v6 offset:37632
    ds_read_b64_tr_b16 v[96:97], v6 offset:36928
    ds_read_b64_tr_b16 v[98:99], v6 offset:37696
    ds_read_b128 v[72:75], v5 offset:30816
    ds_read_b64_tr_b16 v[100:101], v6 offset:39936
    ds_read_b64_tr_b16 v[102:103], v6 offset:40704
    ds_read_b64_tr_b16 v[104:105], v6 offset:40000
    ds_read_b64_tr_b16 v[106:107], v6 offset:40768
    s_waitcnt lgkmcnt(15)
    v_mfma_f32_32x32x16_bf16 v[108:123], v[76:79], v[60:63], v[108:123]
    v_mfma_f32_32x32x16_bf16 v[124:139], v[80:83], v[60:63], v[124:139]
    s_waitcnt lgkmcnt(10)
    v_mfma_f32_32x32x16_bf16 v[108:123], v[84:87], v[64:67], v[108:123]
    v_mfma_f32_32x32x16_bf16 v[124:139], v[88:91], v[64:67], v[124:139]
    s_waitcnt lgkmcnt(5)
    v_mfma_f32_32x32x16_bf16 v[108:123], v[92:95], v[68:71], v[108:123]
    v_mfma_f32_32x32x16_bf16 v[124:139], v[96:99], v[68:71], v[124:139]
    s_waitcnt lgkmcnt(0)
    v_mfma_f32_32x32x16_bf16 v[108:123], v[100:103], v[72:75], v[108:123]
    v_mfma_f32_32x32x16_bf16 v[124:139], v[104:107], v[72:75], v[124:139]
    s_waitcnt vmcnt(6)
    ds_write_b128 v3, v[12:15] offset:0
    ds_write_b128 v3, v[16:19] offset:16
    ds_write_b128 v3, v[20:23] offset:32
    ds_write_b128 v3, v[24:27] offset:48
    ds_write_b128 v4, v[44:47] offset:0
    ds_write_b128 v4, v[48:51] offset:16
    s_waitcnt lgkmcnt(0)
    s_barrier
    buffer_load_dwordx4 v[12:15], v1, s[12:15], 0 offen offset:1024
    buffer_load_dwordx4 v[16:19], v1, s[12:15], 0 offen offset:1040
    buffer_load_dwordx4 v[20:23], v1, s[12:15], 0 offen offset:1056
    buffer_load_dwordx4 v[24:27], v1, s[12:15], 0 offen offset:1072
    s_mov_b32 s32, 0x90000
    buffer_load_dwordx4 v[44:47], v2, s[16:19], s32 offen offset:0
    buffer_load_dwordx4 v[48:51], v2, s[16:19], s32 offen offset:16
    ds_read_b128 v[60:63], v5 offset:0
    ds_read_b64_tr_b16 v[76:77], v6 offset:0
    ds_read_b64_tr_b16 v[78:79], v6 offset:768
    ds_read_b64_tr_b16 v[80:81], v6 offset:64
    ds_read_b64_tr_b16 v[82:83], v6 offset:832
    ds_read_b128 v[64:67], v5 offset:32
    ds_read_b64_tr_b16 v[84:85], v6 offset:3072
    ds_read_b64_tr_b16 v[86:87], v6 offset:3840
    ds_read_b64_tr_b16 v[88:89], v6 offset:3136
    ds_read_b64_tr_b16 v[90:91], v6 offset:3904
    ds_read_b128 v[68:71], v5 offset:64
    ds_read_b64_tr_b16 v[92:93], v6 offset:6144
    ds_read_b64_tr_b16 v[94:95], v6 offset:6912
    ds_read_b64_tr_b16 v[96:97], v6 offset:6208
    ds_read_b64_tr_b16 v[98:99], v6 offset:6976
    ds_read_b128 v[72:75], v5 offset:96
    ds_read_b64_tr_b16 v[100:101], v6 offset:9216
    ds_read_b64_tr_b16 v[102:103], v6 offset:9984
    ds_read_b64_tr_b16 v[104:105], v6 offset:9280
    ds_read_b64_tr_b16 v[106:107], v6 offset:10048
    s_waitcnt lgkmcnt(15)
    v_mfma_f32_32x32x16_bf16 v[108:123], v[76:79], v[60:63], v[108:123]
    v_mfma_f32_32x32x16_bf16 v[124:139], v[80:83], v[60:63], v[124:139]
    s_waitcnt lgkmcnt(10)
    v_mfma_f32_32x32x16_bf16 v[108:123], v[84:87], v[64:67], v[108:123]
    v_mfma_f32_32x32x16_bf16 v[124:139], v[88:91], v[64:67], v[124:139]
    s_waitcnt lgkmcnt(5)
    v_mfma_f32_32x32x16_bf16 v[108:123], v[92:95], v[68:71], v[108:123]
    v_mfma_f32_32x32x16_bf16 v[124:139], v[96:99], v[68:71], v[124:139]
    s_waitcnt lgkmcnt(0)
    v_mfma_f32_32x32x16_bf16 v[108:123], v[100:103], v[72:75], v[108:123]
    v_mfma_f32_32x32x16_bf16 v[124:139], v[104:107], v[72:75], v[124:139]
    s_waitcnt vmcnt(6)
    ds_write_b128 v3, v[28:31] offset:30720
    ds_write_b128 v3, v[32:35] offset:30736
    ds_write_b128 v3, v[36:39] offset:30752
    ds_write_b128 v3, v[40:43] offset:30768
    ds_write_b128 v4, v[52:55] offset:30720
    ds_write_b128 v4, v[56:59] offset:30736
    s_waitcnt lgkmcnt(0)
    s_barrier
    ds_read_b128 v[60:63], v5 offset:30720
    ds_read_b64_tr_b16 v[76:77], v6 offset:30720
    ds_read_b64_tr_b16 v[78:79], v6 offset:31488
    ds_read_b64_tr_b16 v[80:81], v6 offset:30784
    ds_read_b64_tr_b16 v[82:83], v6 offset:31552
    ds_read_b128 v[64:67], v5 offset:30752
    ds_read_b64_tr_b16 v[84:85], v6 offset:33792
    ds_read_b64_tr_b16 v[86:87], v6 offset:34560
    ds_read_b64_tr_b16 v[88:89], v6 offset:33856
    ds_read_b64_tr_b16 v[90:91], v6 offset:34624
    ds_read_b128 v[68:71], v5 offset:30784
    ds_read_b64_tr_b16 v[92:93], v6 offset:36864
    ds_read_b64_tr_b16 v[94:95], v6 offset:37632
    ds_read_b64_tr_b16 v[96:97], v6 offset:36928
    ds_read_b64_tr_b16 v[98:99], v6 offset:37696
    ds_read_b128 v[72:75], v5 offset:30816
    ds_read_b64_tr_b16 v[100:101], v6 offset:39936
    ds_read_b64_tr_b16 v[102:103], v6 offset:40704
    ds_read_b64_tr_b16 v[104:105], v6 offset:40000
    ds_read_b64_tr_b16 v[106:107], v6 offset:40768
    s_waitcnt lgkmcnt(15)
    v_mfma_f32_32x32x16_bf16 v[108:123], v[76:79], v[60:63], v[108:123]
    v_mfma_f32_32x32x16_bf16 v[124:139], v[80:83], v[60:63], v[124:139]
    s_waitcnt lgkmcnt(10)
    v_mfma_f32_32x32x16_bf16 v[108:123], v[84:87], v[64:67], v[108:123]
    v_mfma_f32_32x32x16_bf16 v[124:139], v[88:91], v[64:67], v[124:139]
    s_waitcnt lgkmcnt(5)
    v_mfma_f32_32x32x16_bf16 v[108:123], v[92:95], v[68:71], v[108:123]
    v_mfma_f32_32x32x16_bf16 v[124:139], v[96:99], v[68:71], v[124:139]
    s_waitcnt lgkmcnt(0)
    v_mfma_f32_32x32x16_bf16 v[108:123], v[100:103], v[72:75], v[108:123]
    v_mfma_f32_32x32x16_bf16 v[124:139], v[104:107], v[72:75], v[124:139]
    s_waitcnt vmcnt(0)
    ds_write_b128 v3, v[12:15] offset:0
    ds_write_b128 v3, v[16:19] offset:16
    ds_write_b128 v3, v[20:23] offset:32
    ds_write_b128 v3, v[24:27] offset:48
    ds_write_b128 v4, v[44:47] offset:0
    ds_write_b128 v4, v[48:51] offset:16
    s_waitcnt lgkmcnt(0)
    s_barrier
    ds_read_b128 v[60:63], v5 offset:0
    ds_read_b64_tr_b16 v[76:77], v6 offset:0
    ds_read_b64_tr_b16 v[78:79], v6 offset:768
    ds_read_b64_tr_b16 v[80:81], v6 offset:64
    ds_read_b64_tr_b16 v[82:83], v6 offset:832
    ds_read_b128 v[64:67], v5 offset:32
    ds_read_b64_tr_b16 v[84:85], v6 offset:3072
    ds_read_b64_tr_b16 v[86:87], v6 offset:3840
    ds_read_b64_tr_b16 v[88:89], v6 offset:3136
    ds_read_b64_tr_b16 v[90:91], v6 offset:3904
    ds_read_b128 v[68:71], v5 offset:64
    ds_read_b64_tr_b16 v[92:93], v6 offset:6144
    ds_read_b64_tr_b16 v[94:95], v6 offset:6912
    ds_read_b64_tr_b16 v[96:97], v6 offset:6208
    ds_read_b64_tr_b16 v[98:99], v6 offset:6976
    ds_read_b128 v[72:75], v5 offset:96
    ds_read_b64_tr_b16 v[100:101], v6 offset:9216
    ds_read_b64_tr_b16 v[102:103], v6 offset:9984
    ds_read_b64_tr_b16 v[104:105], v6 offset:9280
    ds_read_b64_tr_b16 v[106:107], v6 offset:10048
    s_waitcnt lgkmcnt(15)
    v_mfma_f32_32x32x16_bf16 v[108:123], v[76:79], v[60:63], v[108:123]
    v_mfma_f32_32x32x16_bf16 v[124:139], v[80:83], v[60:63], v[124:139]
    s_waitcnt lgkmcnt(10)
    v_mfma_f32_32x32x16_bf16 v[108:123], v[84:87], v[64:67], v[108:123]
    v_mfma_f32_32x32x16_bf16 v[124:139], v[88:91], v[64:67], v[124:139]
    s_waitcnt lgkmcnt(5)
    v_mfma_f32_32x32x16_bf16 v[108:123], v[92:95], v[68:71], v[108:123]
    v_mfma_f32_32x32x16_bf16 v[124:139], v[96:99], v[68:71], v[124:139]
    s_waitcnt lgkmcnt(0)
    v_mfma_f32_32x32x16_bf16 v[108:123], v[100:103], v[72:75], v[108:123]
    v_mfma_f32_32x32x16_bf16 v[124:139], v[104:107], v[72:75], v[124:139]
    s_nop 7
    s_nop 7
    v_lshrrev_b32 v7, 6, v0
    v_lshlrev_b32 v7, 5, v7
    v_and_b32 v8, 31, v0
    v_add3_u32 v7, v7, v8, s30
    v_mul_u32_u24 v1, 1152, v7
    v_bfe_u32 v8, v0, 5, 1
    v_lshlrev_b32 v8, 3, v8
    v_add3_u32 v1, v1, v8, s31
    buffer_load_dwordx2 v[60:61], v1, s[24:27], 0 offen offset:0
    buffer_load_dwordx2 v[62:63], v1, s[24:27], 0 offen offset:16
    buffer_load_dwordx2 v[64:65], v1, s[24:27], 0 offen offset:32
    buffer_load_dwordx2 v[66:67], v1, s[24:27], 0 offen offset:48
    buffer_load_dwordx2 v[68:69], v1, s[24:27], 0 offen offset:64
    buffer_load_dwordx2 v[70:71], v1, s[24:27], 0 offen offset:80
    buffer_load_dwordx2 v[72:73], v1, s[24:27], 0 offen offset:96
    buffer_load_dwordx2 v[74:75], v1, s[24:27], 0 offen offset:112
    s_waitcnt vmcnt(0)
    v_cvt_pk_bf16_f32 v76, v108, v109
    v_lshlrev_b32 v108, 16, v76
    v_and_b32 v109, 0xffff0000, v76
    v_lshlrev_b32 v7, 16, v60
    v_and_b32 v8, 0xffff0000, v60
    v_add_f32 v108, v108, v7
    v_add_f32 v109, v109, v8
    v_cvt_pk_bf16_f32 v76, v108, v109
    v_cvt_pk_bf16_f32 v77, v110, v111
    v_lshlrev_b32 v110, 16, v77
    v_and_b32 v111, 0xffff0000, v77
    v_lshlrev_b32 v7, 16, v61
    v_and_b32 v8, 0xffff0000, v61
    v_add_f32 v110, v110, v7
    v_add_f32 v111, v111, v8
    v_cvt_pk_bf16_f32 v77, v110, v111
    buffer_store_dwordx2 v[76:77], v1, s[20:23], 0 offen offset:0
    v_cvt_pk_bf16_f32 v78, v112, v113
    v_lshlrev_b32 v112, 16, v78
    v_and_b32 v113, 0xffff0000, v78
    v_lshlrev_b32 v7, 16, v62
    v_and_b32 v8, 0xffff0000, v62
    v_add_f32 v112, v112, v7
    v_add_f32 v113, v113, v8
    v_cvt_pk_bf16_f32 v78, v112, v113
    v_cvt_pk_bf16_f32 v79, v114, v115
    v_lshlrev_b32 v114, 16, v79
    v_and_b32 v115, 0xffff0000, v79
    v_lshlrev_b32 v7, 16, v63
    v_and_b32 v8, 0xffff0000, v63
    v_add_f32 v114, v114, v7
    v_add_f32 v115, v115, v8
    v_cvt_pk_bf16_f32 v79, v114, v115
    buffer_store_dwordx2 v[78:79], v1, s[20:23], 0 offen offset:16
    v_cvt_pk_bf16_f32 v80, v116, v117
    v_lshlrev_b32 v116, 16, v80
    v_and_b32 v117, 0xffff0000, v80
    v_lshlrev_b32 v7, 16, v64
    v_and_b32 v8, 0xffff0000, v64
    v_add_f32 v116, v116, v7
    v_add_f32 v117, v117, v8
    v_cvt_pk_bf16_f32 v80, v116, v117
    v_cvt_pk_bf16_f32 v81, v118, v119
    v_lshlrev_b32 v118, 16, v81
    v_and_b32 v119, 0xffff0000, v81
    v_lshlrev_b32 v7, 16, v65
    v_and_b32 v8, 0xffff0000, v65
    v_add_f32 v118, v118, v7
    v_add_f32 v119, v119, v8
    v_cvt_pk_bf16_f32 v81, v118, v119
    buffer_store_dwordx2 v[80:81], v1, s[20:23], 0 offen offset:32
    v_cvt_pk_bf16_f32 v82, v120, v121
    v_lshlrev_b32 v120, 16, v82
    v_and_b32 v121, 0xffff0000, v82
    v_lshlrev_b32 v7, 16, v66
    v_and_b32 v8, 0xffff0000, v66
    v_add_f32 v120, v120, v7
    v_add_f32 v121, v121, v8
    v_cvt_pk_bf16_f32 v82, v120, v121
    v_cvt_pk_bf16_f32 v83, v122, v123
    v_lshlrev_b32 v122, 16, v83
    v_and_b32 v123, 0xffff0000, v83
    v_lshlrev_b32 v7, 16, v67
    v_and_b32 v8, 0xffff0000, v67
    v_add_f32 v122, v122, v7
    v_add_f32 v123, v123, v8
    v_cvt_pk_bf16_f32 v83, v122, v123
    buffer_store_dwordx2 v[82:83], v1, s[20:23], 0 offen offset:48
    v_cvt_pk_bf16_f32 v84, v124, v125
    v_lshlrev_b32 v124, 16, v84
    v_and_b32 v125, 0xffff0000, v84
    v_lshlrev_b32 v7, 16, v68
    v_and_b32 v8, 0xffff0000, v68
    v_add_f32 v124, v124, v7
    v_add_f32 v125, v125, v8
    v_cvt_pk_bf16_f32 v84, v124, v125
    v_cvt_pk_bf16_f32 v85, v126, v127
    v_lshlrev_b32 v126, 16, v85
    v_and_b32 v127, 0xffff0000, v85
    v_lshlrev_b32 v7, 16, v69
    v_and_b32 v8, 0xffff0000, v69
    v_add_f32 v126, v126, v7
    v_add_f32 v127, v127, v8
    v_cvt_pk_bf16_f32 v85, v126, v127
    buffer_store_dwordx2 v[84:85], v1, s[20:23], 0 offen offset:64
    v_cvt_pk_bf16_f32 v86, v128, v129
    v_lshlrev_b32 v128, 16, v86
    v_and_b32 v129, 0xffff0000, v86
    v_lshlrev_b32 v7, 16, v70
    v_and_b32 v8, 0xffff0000, v70
    v_add_f32 v128, v128, v7
    v_add_f32 v129, v129, v8
    v_cvt_pk_bf16_f32 v86, v128, v129
    v_cvt_pk_bf16_f32 v87, v130, v131
    v_lshlrev_b32 v130, 16, v87
    v_and_b32 v131, 0xffff0000, v87
    v_lshlrev_b32 v7, 16, v71
    v_and_b32 v8, 0xffff0000, v71
    v_add_f32 v130, v130, v7
    v_add_f32 v131, v131, v8
    v_cvt_pk_bf16_f32 v87, v130, v131
    buffer_store_dwordx2 v[86:87], v1, s[20:23], 0 offen offset:80
    v_cvt_pk_bf16_f32 v88, v132, v133
    v_lshlrev_b32 v132, 16, v88
    v_and_b32 v133, 0xffff0000, v88
    v_lshlrev_b32 v7, 16, v72
    v_and_b32 v8, 0xffff0000, v72
    v_add_f32 v132, v132, v7
    v_add_f32 v133, v133, v8
    v_cvt_pk_bf16_f32 v88, v132, v133
    v_cvt_pk_bf16_f32 v89, v134, v135
    v_lshlrev_b32 v134, 16, v89
    v_and_b32 v135, 0xffff0000, v89
    v_lshlrev_b32 v7, 16, v73
    v_and_b32 v8, 0xffff0000, v73
    v_add_f32 v134, v134, v7
    v_add_f32 v135, v135, v8
    v_cvt_pk_bf16_f32 v89, v134, v135
    buffer_store_dwordx2 v[88:89], v1, s[20:23], 0 offen offset:96
    v_cvt_pk_bf16_f32 v90, v136, v137
    v_lshlrev_b32 v136, 16, v90
    v_and_b32 v137, 0xffff0000, v90
    v_lshlrev_b32 v7, 16, v74
    v_and_b32 v8, 0xffff0000, v74
    v_add_f32 v136, v136, v7
    v_add_f32 v137, v137, v8
    v_cvt_pk_bf16_f32 v90, v136, v137
    v_cvt_pk_bf16_f32 v91, v138, v139
    v_lshlrev_b32 v138, 16, v91
    v_and_b32 v139, 0xffff0000, v91
    v_lshlrev_b32 v7, 16, v75
    v_and_b32 v8, 0xffff0000, v75
    v_add_f32 v138, v138, v7
    v_add_f32 v139, v139, v8
    v_cvt_pk_bf16_f32 v91, v138, v139
    buffer_store_dwordx2 v[90:91], v1, s[20:23], 0 offen offset:112
op1_kernel_done:
    s_endpgm
.globl ln2_kernel
.p2align 8
.type ln2_kernel,@function
ln2_kernel:
    s_load_dwordx2 s[4:5], s[0:1], 72
    s_load_dwordx2 s[6:7], s[0:1], 72
    s_cmp_ge_u32 s2, 256
    s_cbranch_scc1 ln2_kernel_done
    s_waitcnt lgkmcnt(0)
    s_add_u32 s4, s4, 0xd80000
    s_addc_u32 s5, s5, 0
    s_mov_b32 s8, s4
    s_and_b32 s9, s5, 0xffff
    s_mov_b32 s10, 0x240000
    s_mov_b32 s11, 0x20000
    s_mov_b32 s12, s6
    s_and_b32 s13, s7, 0xffff
    s_mov_b32 s14, 0x240000
    s_mov_b32 s15, 0x20000
    s_lshl_b32 s3, s2, 8
    v_add_u32 v1, s3, v0
    v_lshrrev_b32 v2, 5, v1
    v_mul_u32_u24 v2, 1152, v2
    v_and_b32 v1, 31, v1
    v_mul_u32_u24 v1, 36, v1
    v_add_u32 v2, v2, v1
    buffer_load_dwordx4 v[4:7], v2, s[8:11], 0 offen
    buffer_load_dwordx4 v[8:11], v2, s[8:11], 0 offen offset:16
    buffer_load_dword v12, v2, s[8:11], 0 offen offset:32
    s_waitcnt vmcnt(0)
    v_lshlrev_b32 v13, 16, v4
    v_and_b32 v14, 0xffff0000, v4
    v_lshlrev_b32 v15, 16, v5
    v_and_b32 v16, 0xffff0000, v5
    v_lshlrev_b32 v17, 16, v6
    v_and_b32 v18, 0xffff0000, v6
    v_lshlrev_b32 v19, 16, v7
    v_and_b32 v20, 0xffff0000, v7
    v_lshlrev_b32 v21, 16, v8
    v_and_b32 v22, 0xffff0000, v8
    v_lshlrev_b32 v23, 16, v9
    v_and_b32 v24, 0xffff0000, v9
    v_lshlrev_b32 v25, 16, v10
    v_and_b32 v26, 0xffff0000, v10
    v_lshlrev_b32 v27, 16, v11
    v_and_b32 v28, 0xffff0000, v11
    v_lshlrev_b32 v29, 16, v12
    v_and_b32 v30, 0xffff0000, v12
    v_add_f32 v31, v13, v14
    v_add_f32 v31, v31, v15
    v_add_f32 v31, v31, v16
    v_add_f32 v31, v31, v17
    v_add_f32 v31, v31, v18
    v_add_f32 v31, v31, v19
    v_add_f32 v31, v31, v20
    v_add_f32 v31, v31, v21
    v_add_f32 v31, v31, v22
    v_add_f32 v31, v31, v23
    v_add_f32 v31, v31, v24
    v_add_f32 v31, v31, v25
    v_add_f32 v31, v31, v26
    v_add_f32 v31, v31, v27
    v_add_f32 v31, v31, v28
    v_add_f32 v31, v31, v29
    v_add_f32 v31, v31, v30
    ds_swizzle_b32 v32, v31 offset:0x41f
    s_waitcnt lgkmcnt(0)
    v_add_f32 v31, v31, v32
    ds_swizzle_b32 v32, v31 offset:0x81f
    s_waitcnt lgkmcnt(0)
    v_add_f32 v31, v31, v32
    ds_swizzle_b32 v32, v31 offset:0x101f
    s_waitcnt lgkmcnt(0)
    v_add_f32 v31, v31, v32
    ds_swizzle_b32 v32, v31 offset:0x201f
    s_waitcnt lgkmcnt(0)
    v_add_f32 v31, v31, v32
    ds_swizzle_b32 v32, v31 offset:0x401f
    s_waitcnt lgkmcnt(0)
    v_add_f32 v31, v31, v32
    v_mul_f32 v33, 0x3ae38e39, v31
    v_sub_f32 v13, v13, v33
    v_sub_f32 v14, v14, v33
    v_sub_f32 v15, v15, v33
    v_sub_f32 v16, v16, v33
    v_sub_f32 v17, v17, v33
    v_sub_f32 v18, v18, v33
    v_sub_f32 v19, v19, v33
    v_sub_f32 v20, v20, v33
    v_sub_f32 v21, v21, v33
    v_sub_f32 v22, v22, v33
    v_sub_f32 v23, v23, v33
    v_sub_f32 v24, v24, v33
    v_sub_f32 v25, v25, v33
    v_sub_f32 v26, v26, v33
    v_sub_f32 v27, v27, v33
    v_sub_f32 v28, v28, v33
    v_sub_f32 v29, v29, v33
    v_sub_f32 v30, v30, v33
    v_mul_f32 v31, v13, v13
    v_fmac_f32 v31, v14, v14
    v_fmac_f32 v31, v15, v15
    v_fmac_f32 v31, v16, v16
    v_fmac_f32 v31, v17, v17
    v_fmac_f32 v31, v18, v18
    v_fmac_f32 v31, v19, v19
    v_fmac_f32 v31, v20, v20
    v_fmac_f32 v31, v21, v21
    v_fmac_f32 v31, v22, v22
    v_fmac_f32 v31, v23, v23
    v_fmac_f32 v31, v24, v24
    v_fmac_f32 v31, v25, v25
    v_fmac_f32 v31, v26, v26
    v_fmac_f32 v31, v27, v27
    v_fmac_f32 v31, v28, v28
    v_fmac_f32 v31, v29, v29
    v_fmac_f32 v31, v30, v30
    ds_swizzle_b32 v32, v31 offset:0x41f
    s_waitcnt lgkmcnt(0)
    v_add_f32 v31, v31, v32
    ds_swizzle_b32 v32, v31 offset:0x81f
    s_waitcnt lgkmcnt(0)
    v_add_f32 v31, v31, v32
    ds_swizzle_b32 v32, v31 offset:0x101f
    s_waitcnt lgkmcnt(0)
    v_add_f32 v31, v31, v32
    ds_swizzle_b32 v32, v31 offset:0x201f
    s_waitcnt lgkmcnt(0)
    v_add_f32 v31, v31, v32
    ds_swizzle_b32 v32, v31 offset:0x401f
    s_waitcnt lgkmcnt(0)
    v_add_f32 v31, v31, v32
    v_mov_b32 v34, 0x3727c5ac
    v_fmac_f32 v34, 0x3ae38e39, v31
    v_rsq_f32 v34, v34
    s_nop 0
    v_mul_f32 v13, v13, v34
    v_mul_f32 v14, v14, v34
    v_mul_f32 v15, v15, v34
    v_mul_f32 v16, v16, v34
    v_mul_f32 v17, v17, v34
    v_mul_f32 v18, v18, v34
    v_mul_f32 v19, v19, v34
    v_mul_f32 v20, v20, v34
    v_mul_f32 v21, v21, v34
    v_mul_f32 v22, v22, v34
    v_mul_f32 v23, v23, v34
    v_mul_f32 v24, v24, v34
    v_mul_f32 v25, v25, v34
    v_mul_f32 v26, v26, v34
    v_mul_f32 v27, v27, v34
    v_mul_f32 v28, v28, v34
    v_mul_f32 v29, v29, v34
    v_mul_f32 v30, v30, v34
    v_cvt_pk_bf16_f32 v4, v13, v14
    v_cvt_pk_bf16_f32 v5, v15, v16
    v_cvt_pk_bf16_f32 v6, v17, v18
    v_cvt_pk_bf16_f32 v7, v19, v20
    v_cvt_pk_bf16_f32 v8, v21, v22
    v_cvt_pk_bf16_f32 v9, v23, v24
    v_cvt_pk_bf16_f32 v10, v25, v26
    v_cvt_pk_bf16_f32 v11, v27, v28
    v_cvt_pk_bf16_f32 v12, v29, v30
    buffer_store_dwordx4 v[4:7], v2, s[12:15], 0 offen
    buffer_store_dwordx4 v[8:11], v2, s[12:15], 0 offen offset:16
    buffer_store_dword v12, v2, s[12:15], 0 offen offset:32
ln2_kernel_done:
    s_endpgm
.globl op2_kernel
.p2align 8
.type op2_kernel,@function
op2_kernel:
    s_load_dwordx2 s[4:5], s[0:1], 72
    s_load_dwordx2 s[6:7], s[0:1], 24
    s_load_dwordx2 s[8:9], s[0:1], 72
    s_load_dwordx2 s[10:11], s[0:1], 72
    s_cmp_ge_u32 s2, 144
    s_cbranch_scc1 op2_kernel_done
    s_waitcnt lgkmcnt(0)
    s_add_u32 s4, s4, 0x900000
    s_addc_u32 s5, s5, 0
    s_add_u32 s8, s8, 0xfc0000
    s_addc_u32 s9, s9, 0
    s_add_u32 s10, s10, 0xd80000
    s_addc_u32 s11, s11, 0
    s_mov_b32 s12, s4
    s_and_b32 s13, s5, 0xffff
    s_mov_b32 s14, 0x240000
    s_mov_b32 s15, 0x20000
    s_mov_b32 s16, s6
    s_and_b32 s17, s7, 0xffff
    s_mov_b32 s18, 0xa2000
    s_mov_b32 s19, 0x20000
    s_mov_b32 s20, s8
    s_and_b32 s21, s9, 0xffff
    s_mov_b32 s22, 0x240000
    s_mov_b32 s23, 0x20000
    s_mov_b32 s24, s10
    s_and_b32 s25, s11, 0xffff
    s_mov_b32 s26, 0x240000
    s_mov_b32 s27, 0x20000
    s_mov_b32 s30, 0x1c71c71d
    s_mul_hi_u32 s28, s2, s30
    s_mul_i32 s30, s28, 9
    s_sub_u32 s29, s2, s30
    s_lshl_b32 s30, s28, 7
    v_lshrrev_b32 v7, 1, v0
    v_add_u32 v8, s30, v7
    v_mul_u32_u24 v1, 1152, v8
    v_and_b32 v8, 1, v0
    v_lshlrev_b32 v8, 6, v8
    v_add_u32 v1, v1, v8
    v_mul_u32_u24 v3, 144, v7
    v_add_u32 v3, v3, v8
    v_lshrrev_b32 v7, 2, v0
    v_mul_u32_u24 v2, 1152, v7
    v_and_b32 v8, 3, v0
    v_lshlrev_b32 v8, 5, v8
    v_add_u32 v2, v2, v8
    s_lshl_b32 s31, s29, 7
    v_add_u32 v2, s31, v2
    v_mul_u32_u24 v4, 192, v7
    v_add_u32 v4, v4, v8
    v_add_u32 v4, 18432, v4
    v_lshrrev_b32 v7, 6, v0
    v_lshlrev_b32 v7, 5, v7
    v_and_b32 v8, 31, v0
    v_add_u32 v7, v7, v8
    v_mul_u32_u24 v5, 144, v7
    v_bfe_u32 v8, v0, 5, 1
    v_lshlrev_b32 v8, 4, v8
    v_add_u32 v5, v5, v8
    v_bfe_u32 v7, v0, 5, 1
    v_lshlrev_b32 v7, 3, v7
    v_bfe_u32 v8, v0, 2, 2
    v_add_u32 v7, v7, v8
    v_mul_u32_u24 v6, 192, v7
    v_bfe_u32 v7, v0, 4, 1
    v_lshlrev_b32 v7, 5, v7
    v_and_b32 v8, 3, v0
    v_lshlrev_b32 v8, 3, v8
    v_add3_u32 v6, v6, v7, v8
    v_add_u32 v6, 18432, v6
    v_mov_b32 v108, 0
    v_mov_b32 v109, 0
    v_mov_b32 v110, 0
    v_mov_b32 v111, 0
    v_mov_b32 v112, 0
    v_mov_b32 v113, 0
    v_mov_b32 v114, 0
    v_mov_b32 v115, 0
    v_mov_b32 v116, 0
    v_mov_b32 v117, 0
    v_mov_b32 v118, 0
    v_mov_b32 v119, 0
    v_mov_b32 v120, 0
    v_mov_b32 v121, 0
    v_mov_b32 v122, 0
    v_mov_b32 v123, 0
    v_mov_b32 v124, 0
    v_mov_b32 v125, 0
    v_mov_b32 v126, 0
    v_mov_b32 v127, 0
    v_mov_b32 v128, 0
    v_mov_b32 v129, 0
    v_mov_b32 v130, 0
    v_mov_b32 v131, 0
    v_mov_b32 v132, 0
    v_mov_b32 v133, 0
    v_mov_b32 v134, 0
    v_mov_b32 v135, 0
    v_mov_b32 v136, 0
    v_mov_b32 v137, 0
    v_mov_b32 v138, 0
    v_mov_b32 v139, 0
    buffer_load_dwordx4 v[12:15], v1, s[12:15], 0 offen offset:0
    buffer_load_dwordx4 v[16:19], v1, s[12:15], 0 offen offset:16
    buffer_load_dwordx4 v[20:23], v1, s[12:15], 0 offen offset:32
    buffer_load_dwordx4 v[24:27], v1, s[12:15], 0 offen offset:48
    s_mov_b32 s32, 0x0
    buffer_load_dwordx4 v[44:47], v2, s[16:19], s32 offen offset:0
    buffer_load_dwordx4 v[48:51], v2, s[16:19], s32 offen offset:16
    buffer_load_dwordx4 v[28:31], v1, s[12:15], 0 offen offset:128
    buffer_load_dwordx4 v[32:35], v1, s[12:15], 0 offen offset:144
    buffer_load_dwordx4 v[36:39], v1, s[12:15], 0 offen offset:160
    buffer_load_dwordx4 v[40:43], v1, s[12:15], 0 offen offset:176
    s_mov_b32 s32, 0x12000
    buffer_load_dwordx4 v[52:55], v2, s[16:19], s32 offen offset:0
    buffer_load_dwordx4 v[56:59], v2, s[16:19], s32 offen offset:16
    s_waitcnt vmcnt(6)
    ds_write_b128 v3, v[12:15] offset:0
    ds_write_b128 v3, v[16:19] offset:16
    ds_write_b128 v3, v[20:23] offset:32
    ds_write_b128 v3, v[24:27] offset:48
    ds_write_b128 v4, v[44:47] offset:0
    ds_write_b128 v4, v[48:51] offset:16
    s_waitcnt lgkmcnt(0)
    s_barrier
    buffer_load_dwordx4 v[12:15], v1, s[12:15], 0 offen offset:256
    buffer_load_dwordx4 v[16:19], v1, s[12:15], 0 offen offset:272
    buffer_load_dwordx4 v[20:23], v1, s[12:15], 0 offen offset:288
    buffer_load_dwordx4 v[24:27], v1, s[12:15], 0 offen offset:304
    s_mov_b32 s32, 0x24000
    buffer_load_dwordx4 v[44:47], v2, s[16:19], s32 offen offset:0
    buffer_load_dwordx4 v[48:51], v2, s[16:19], s32 offen offset:16
    ds_read_b128 v[60:63], v5 offset:0
    ds_read_b64_tr_b16 v[76:77], v6 offset:0
    ds_read_b64_tr_b16 v[78:79], v6 offset:768
    ds_read_b64_tr_b16 v[80:81], v6 offset:64
    ds_read_b64_tr_b16 v[82:83], v6 offset:832
    ds_read_b128 v[64:67], v5 offset:32
    ds_read_b64_tr_b16 v[84:85], v6 offset:3072
    ds_read_b64_tr_b16 v[86:87], v6 offset:3840
    ds_read_b64_tr_b16 v[88:89], v6 offset:3136
    ds_read_b64_tr_b16 v[90:91], v6 offset:3904
    ds_read_b128 v[68:71], v5 offset:64
    ds_read_b64_tr_b16 v[92:93], v6 offset:6144
    ds_read_b64_tr_b16 v[94:95], v6 offset:6912
    ds_read_b64_tr_b16 v[96:97], v6 offset:6208
    ds_read_b64_tr_b16 v[98:99], v6 offset:6976
    ds_read_b128 v[72:75], v5 offset:96
    ds_read_b64_tr_b16 v[100:101], v6 offset:9216
    ds_read_b64_tr_b16 v[102:103], v6 offset:9984
    ds_read_b64_tr_b16 v[104:105], v6 offset:9280
    ds_read_b64_tr_b16 v[106:107], v6 offset:10048
    s_waitcnt lgkmcnt(15)
    v_mfma_f32_32x32x16_bf16 v[108:123], v[76:79], v[60:63], v[108:123]
    v_mfma_f32_32x32x16_bf16 v[124:139], v[80:83], v[60:63], v[124:139]
    s_waitcnt lgkmcnt(10)
    v_mfma_f32_32x32x16_bf16 v[108:123], v[84:87], v[64:67], v[108:123]
    v_mfma_f32_32x32x16_bf16 v[124:139], v[88:91], v[64:67], v[124:139]
    s_waitcnt lgkmcnt(5)
    v_mfma_f32_32x32x16_bf16 v[108:123], v[92:95], v[68:71], v[108:123]
    v_mfma_f32_32x32x16_bf16 v[124:139], v[96:99], v[68:71], v[124:139]
    s_waitcnt lgkmcnt(0)
    v_mfma_f32_32x32x16_bf16 v[108:123], v[100:103], v[72:75], v[108:123]
    v_mfma_f32_32x32x16_bf16 v[124:139], v[104:107], v[72:75], v[124:139]
    s_waitcnt vmcnt(6)
    ds_write_b128 v3, v[28:31] offset:30720
    ds_write_b128 v3, v[32:35] offset:30736
    ds_write_b128 v3, v[36:39] offset:30752
    ds_write_b128 v3, v[40:43] offset:30768
    ds_write_b128 v4, v[52:55] offset:30720
    ds_write_b128 v4, v[56:59] offset:30736
    s_waitcnt lgkmcnt(0)
    s_barrier
    buffer_load_dwordx4 v[28:31], v1, s[12:15], 0 offen offset:384
    buffer_load_dwordx4 v[32:35], v1, s[12:15], 0 offen offset:400
    buffer_load_dwordx4 v[36:39], v1, s[12:15], 0 offen offset:416
    buffer_load_dwordx4 v[40:43], v1, s[12:15], 0 offen offset:432
    s_mov_b32 s32, 0x36000
    buffer_load_dwordx4 v[52:55], v2, s[16:19], s32 offen offset:0
    buffer_load_dwordx4 v[56:59], v2, s[16:19], s32 offen offset:16
    ds_read_b128 v[60:63], v5 offset:30720
    ds_read_b64_tr_b16 v[76:77], v6 offset:30720
    ds_read_b64_tr_b16 v[78:79], v6 offset:31488
    ds_read_b64_tr_b16 v[80:81], v6 offset:30784
    ds_read_b64_tr_b16 v[82:83], v6 offset:31552
    ds_read_b128 v[64:67], v5 offset:30752
    ds_read_b64_tr_b16 v[84:85], v6 offset:33792
    ds_read_b64_tr_b16 v[86:87], v6 offset:34560
    ds_read_b64_tr_b16 v[88:89], v6 offset:33856
    ds_read_b64_tr_b16 v[90:91], v6 offset:34624
    ds_read_b128 v[68:71], v5 offset:30784
    ds_read_b64_tr_b16 v[92:93], v6 offset:36864
    ds_read_b64_tr_b16 v[94:95], v6 offset:37632
    ds_read_b64_tr_b16 v[96:97], v6 offset:36928
    ds_read_b64_tr_b16 v[98:99], v6 offset:37696
    ds_read_b128 v[72:75], v5 offset:30816
    ds_read_b64_tr_b16 v[100:101], v6 offset:39936
    ds_read_b64_tr_b16 v[102:103], v6 offset:40704
    ds_read_b64_tr_b16 v[104:105], v6 offset:40000
    ds_read_b64_tr_b16 v[106:107], v6 offset:40768
    s_waitcnt lgkmcnt(15)
    v_mfma_f32_32x32x16_bf16 v[108:123], v[76:79], v[60:63], v[108:123]
    v_mfma_f32_32x32x16_bf16 v[124:139], v[80:83], v[60:63], v[124:139]
    s_waitcnt lgkmcnt(10)
    v_mfma_f32_32x32x16_bf16 v[108:123], v[84:87], v[64:67], v[108:123]
    v_mfma_f32_32x32x16_bf16 v[124:139], v[88:91], v[64:67], v[124:139]
    s_waitcnt lgkmcnt(5)
    v_mfma_f32_32x32x16_bf16 v[108:123], v[92:95], v[68:71], v[108:123]
    v_mfma_f32_32x32x16_bf16 v[124:139], v[96:99], v[68:71], v[124:139]
    s_waitcnt lgkmcnt(0)
    v_mfma_f32_32x32x16_bf16 v[108:123], v[100:103], v[72:75], v[108:123]
    v_mfma_f32_32x32x16_bf16 v[124:139], v[104:107], v[72:75], v[124:139]
    s_waitcnt vmcnt(6)
    ds_write_b128 v3, v[12:15] offset:0
    ds_write_b128 v3, v[16:19] offset:16
    ds_write_b128 v3, v[20:23] offset:32
    ds_write_b128 v3, v[24:27] offset:48
    ds_write_b128 v4, v[44:47] offset:0
    ds_write_b128 v4, v[48:51] offset:16
    s_waitcnt lgkmcnt(0)
    s_barrier
    buffer_load_dwordx4 v[12:15], v1, s[12:15], 0 offen offset:512
    buffer_load_dwordx4 v[16:19], v1, s[12:15], 0 offen offset:528
    buffer_load_dwordx4 v[20:23], v1, s[12:15], 0 offen offset:544
    buffer_load_dwordx4 v[24:27], v1, s[12:15], 0 offen offset:560
    s_mov_b32 s32, 0x48000
    buffer_load_dwordx4 v[44:47], v2, s[16:19], s32 offen offset:0
    buffer_load_dwordx4 v[48:51], v2, s[16:19], s32 offen offset:16
    ds_read_b128 v[60:63], v5 offset:0
    ds_read_b64_tr_b16 v[76:77], v6 offset:0
    ds_read_b64_tr_b16 v[78:79], v6 offset:768
    ds_read_b64_tr_b16 v[80:81], v6 offset:64
    ds_read_b64_tr_b16 v[82:83], v6 offset:832
    ds_read_b128 v[64:67], v5 offset:32
    ds_read_b64_tr_b16 v[84:85], v6 offset:3072
    ds_read_b64_tr_b16 v[86:87], v6 offset:3840
    ds_read_b64_tr_b16 v[88:89], v6 offset:3136
    ds_read_b64_tr_b16 v[90:91], v6 offset:3904
    ds_read_b128 v[68:71], v5 offset:64
    ds_read_b64_tr_b16 v[92:93], v6 offset:6144
    ds_read_b64_tr_b16 v[94:95], v6 offset:6912
    ds_read_b64_tr_b16 v[96:97], v6 offset:6208
    ds_read_b64_tr_b16 v[98:99], v6 offset:6976
    ds_read_b128 v[72:75], v5 offset:96
    ds_read_b64_tr_b16 v[100:101], v6 offset:9216
    ds_read_b64_tr_b16 v[102:103], v6 offset:9984
    ds_read_b64_tr_b16 v[104:105], v6 offset:9280
    ds_read_b64_tr_b16 v[106:107], v6 offset:10048
    s_waitcnt lgkmcnt(15)
    v_mfma_f32_32x32x16_bf16 v[108:123], v[76:79], v[60:63], v[108:123]
    v_mfma_f32_32x32x16_bf16 v[124:139], v[80:83], v[60:63], v[124:139]
    s_waitcnt lgkmcnt(10)
    v_mfma_f32_32x32x16_bf16 v[108:123], v[84:87], v[64:67], v[108:123]
    v_mfma_f32_32x32x16_bf16 v[124:139], v[88:91], v[64:67], v[124:139]
    s_waitcnt lgkmcnt(5)
    v_mfma_f32_32x32x16_bf16 v[108:123], v[92:95], v[68:71], v[108:123]
    v_mfma_f32_32x32x16_bf16 v[124:139], v[96:99], v[68:71], v[124:139]
    s_waitcnt lgkmcnt(0)
    v_mfma_f32_32x32x16_bf16 v[108:123], v[100:103], v[72:75], v[108:123]
    v_mfma_f32_32x32x16_bf16 v[124:139], v[104:107], v[72:75], v[124:139]
    s_waitcnt vmcnt(6)
    ds_write_b128 v3, v[28:31] offset:30720
    ds_write_b128 v3, v[32:35] offset:30736
    ds_write_b128 v3, v[36:39] offset:30752
    ds_write_b128 v3, v[40:43] offset:30768
    ds_write_b128 v4, v[52:55] offset:30720
    ds_write_b128 v4, v[56:59] offset:30736
    s_waitcnt lgkmcnt(0)
    s_barrier
    buffer_load_dwordx4 v[28:31], v1, s[12:15], 0 offen offset:640
    buffer_load_dwordx4 v[32:35], v1, s[12:15], 0 offen offset:656
    buffer_load_dwordx4 v[36:39], v1, s[12:15], 0 offen offset:672
    buffer_load_dwordx4 v[40:43], v1, s[12:15], 0 offen offset:688
    s_mov_b32 s32, 0x5a000
    buffer_load_dwordx4 v[52:55], v2, s[16:19], s32 offen offset:0
    buffer_load_dwordx4 v[56:59], v2, s[16:19], s32 offen offset:16
    ds_read_b128 v[60:63], v5 offset:30720
    ds_read_b64_tr_b16 v[76:77], v6 offset:30720
    ds_read_b64_tr_b16 v[78:79], v6 offset:31488
    ds_read_b64_tr_b16 v[80:81], v6 offset:30784
    ds_read_b64_tr_b16 v[82:83], v6 offset:31552
    ds_read_b128 v[64:67], v5 offset:30752
    ds_read_b64_tr_b16 v[84:85], v6 offset:33792
    ds_read_b64_tr_b16 v[86:87], v6 offset:34560
    ds_read_b64_tr_b16 v[88:89], v6 offset:33856
    ds_read_b64_tr_b16 v[90:91], v6 offset:34624
    ds_read_b128 v[68:71], v5 offset:30784
    ds_read_b64_tr_b16 v[92:93], v6 offset:36864
    ds_read_b64_tr_b16 v[94:95], v6 offset:37632
    ds_read_b64_tr_b16 v[96:97], v6 offset:36928
    ds_read_b64_tr_b16 v[98:99], v6 offset:37696
    ds_read_b128 v[72:75], v5 offset:30816
    ds_read_b64_tr_b16 v[100:101], v6 offset:39936
    ds_read_b64_tr_b16 v[102:103], v6 offset:40704
    ds_read_b64_tr_b16 v[104:105], v6 offset:40000
    ds_read_b64_tr_b16 v[106:107], v6 offset:40768
    s_waitcnt lgkmcnt(15)
    v_mfma_f32_32x32x16_bf16 v[108:123], v[76:79], v[60:63], v[108:123]
    v_mfma_f32_32x32x16_bf16 v[124:139], v[80:83], v[60:63], v[124:139]
    s_waitcnt lgkmcnt(10)
    v_mfma_f32_32x32x16_bf16 v[108:123], v[84:87], v[64:67], v[108:123]
    v_mfma_f32_32x32x16_bf16 v[124:139], v[88:91], v[64:67], v[124:139]
    s_waitcnt lgkmcnt(5)
    v_mfma_f32_32x32x16_bf16 v[108:123], v[92:95], v[68:71], v[108:123]
    v_mfma_f32_32x32x16_bf16 v[124:139], v[96:99], v[68:71], v[124:139]
    s_waitcnt lgkmcnt(0)
    v_mfma_f32_32x32x16_bf16 v[108:123], v[100:103], v[72:75], v[108:123]
    v_mfma_f32_32x32x16_bf16 v[124:139], v[104:107], v[72:75], v[124:139]
    s_waitcnt vmcnt(6)
    ds_write_b128 v3, v[12:15] offset:0
    ds_write_b128 v3, v[16:19] offset:16
    ds_write_b128 v3, v[20:23] offset:32
    ds_write_b128 v3, v[24:27] offset:48
    ds_write_b128 v4, v[44:47] offset:0
    ds_write_b128 v4, v[48:51] offset:16
    s_waitcnt lgkmcnt(0)
    s_barrier
    buffer_load_dwordx4 v[12:15], v1, s[12:15], 0 offen offset:768
    buffer_load_dwordx4 v[16:19], v1, s[12:15], 0 offen offset:784
    buffer_load_dwordx4 v[20:23], v1, s[12:15], 0 offen offset:800
    buffer_load_dwordx4 v[24:27], v1, s[12:15], 0 offen offset:816
    s_mov_b32 s32, 0x6c000
    buffer_load_dwordx4 v[44:47], v2, s[16:19], s32 offen offset:0
    buffer_load_dwordx4 v[48:51], v2, s[16:19], s32 offen offset:16
    ds_read_b128 v[60:63], v5 offset:0
    ds_read_b64_tr_b16 v[76:77], v6 offset:0
    ds_read_b64_tr_b16 v[78:79], v6 offset:768
    ds_read_b64_tr_b16 v[80:81], v6 offset:64
    ds_read_b64_tr_b16 v[82:83], v6 offset:832
    ds_read_b128 v[64:67], v5 offset:32
    ds_read_b64_tr_b16 v[84:85], v6 offset:3072
    ds_read_b64_tr_b16 v[86:87], v6 offset:3840
    ds_read_b64_tr_b16 v[88:89], v6 offset:3136
    ds_read_b64_tr_b16 v[90:91], v6 offset:3904
    ds_read_b128 v[68:71], v5 offset:64
    ds_read_b64_tr_b16 v[92:93], v6 offset:6144
    ds_read_b64_tr_b16 v[94:95], v6 offset:6912
    ds_read_b64_tr_b16 v[96:97], v6 offset:6208
    ds_read_b64_tr_b16 v[98:99], v6 offset:6976
    ds_read_b128 v[72:75], v5 offset:96
    ds_read_b64_tr_b16 v[100:101], v6 offset:9216
    ds_read_b64_tr_b16 v[102:103], v6 offset:9984
    ds_read_b64_tr_b16 v[104:105], v6 offset:9280
    ds_read_b64_tr_b16 v[106:107], v6 offset:10048
    s_waitcnt lgkmcnt(15)
    v_mfma_f32_32x32x16_bf16 v[108:123], v[76:79], v[60:63], v[108:123]
    v_mfma_f32_32x32x16_bf16 v[124:139], v[80:83], v[60:63], v[124:139]
    s_waitcnt lgkmcnt(10)
    v_mfma_f32_32x32x16_bf16 v[108:123], v[84:87], v[64:67], v[108:123]
    v_mfma_f32_32x32x16_bf16 v[124:139], v[88:91], v[64:67], v[124:139]
    s_waitcnt lgkmcnt(5)
    v_mfma_f32_32x32x16_bf16 v[108:123], v[92:95], v[68:71], v[108:123]
    v_mfma_f32_32x32x16_bf16 v[124:139], v[96:99], v[68:71], v[124:139]
    s_waitcnt lgkmcnt(0)
    v_mfma_f32_32x32x16_bf16 v[108:123], v[100:103], v[72:75], v[108:123]
    v_mfma_f32_32x32x16_bf16 v[124:139], v[104:107], v[72:75], v[124:139]
    s_waitcnt vmcnt(6)
    ds_write_b128 v3, v[28:31] offset:30720
    ds_write_b128 v3, v[32:35] offset:30736
    ds_write_b128 v3, v[36:39] offset:30752
    ds_write_b128 v3, v[40:43] offset:30768
    ds_write_b128 v4, v[52:55] offset:30720
    ds_write_b128 v4, v[56:59] offset:30736
    s_waitcnt lgkmcnt(0)
    s_barrier
    buffer_load_dwordx4 v[28:31], v1, s[12:15], 0 offen offset:896
    buffer_load_dwordx4 v[32:35], v1, s[12:15], 0 offen offset:912
    buffer_load_dwordx4 v[36:39], v1, s[12:15], 0 offen offset:928
    buffer_load_dwordx4 v[40:43], v1, s[12:15], 0 offen offset:944
    s_mov_b32 s32, 0x7e000
    buffer_load_dwordx4 v[52:55], v2, s[16:19], s32 offen offset:0
    buffer_load_dwordx4 v[56:59], v2, s[16:19], s32 offen offset:16
    ds_read_b128 v[60:63], v5 offset:30720
    ds_read_b64_tr_b16 v[76:77], v6 offset:30720
    ds_read_b64_tr_b16 v[78:79], v6 offset:31488
    ds_read_b64_tr_b16 v[80:81], v6 offset:30784
    ds_read_b64_tr_b16 v[82:83], v6 offset:31552
    ds_read_b128 v[64:67], v5 offset:30752
    ds_read_b64_tr_b16 v[84:85], v6 offset:33792
    ds_read_b64_tr_b16 v[86:87], v6 offset:34560
    ds_read_b64_tr_b16 v[88:89], v6 offset:33856
    ds_read_b64_tr_b16 v[90:91], v6 offset:34624
    ds_read_b128 v[68:71], v5 offset:30784
    ds_read_b64_tr_b16 v[92:93], v6 offset:36864
    ds_read_b64_tr_b16 v[94:95], v6 offset:37632
    ds_read_b64_tr_b16 v[96:97], v6 offset:36928
    ds_read_b64_tr_b16 v[98:99], v6 offset:37696
    ds_read_b128 v[72:75], v5 offset:30816
    ds_read_b64_tr_b16 v[100:101], v6 offset:39936
    ds_read_b64_tr_b16 v[102:103], v6 offset:40704
    ds_read_b64_tr_b16 v[104:105], v6 offset:40000
    ds_read_b64_tr_b16 v[106:107], v6 offset:40768
    s_waitcnt lgkmcnt(15)
    v_mfma_f32_32x32x16_bf16 v[108:123], v[76:79], v[60:63], v[108:123]
    v_mfma_f32_32x32x16_bf16 v[124:139], v[80:83], v[60:63], v[124:139]
    s_waitcnt lgkmcnt(10)
    v_mfma_f32_32x32x16_bf16 v[108:123], v[84:87], v[64:67], v[108:123]
    v_mfma_f32_32x32x16_bf16 v[124:139], v[88:91], v[64:67], v[124:139]
    s_waitcnt lgkmcnt(5)
    v_mfma_f32_32x32x16_bf16 v[108:123], v[92:95], v[68:71], v[108:123]
    v_mfma_f32_32x32x16_bf16 v[124:139], v[96:99], v[68:71], v[124:139]
    s_waitcnt lgkmcnt(0)
    v_mfma_f32_32x32x16_bf16 v[108:123], v[100:103], v[72:75], v[108:123]
    v_mfma_f32_32x32x16_bf16 v[124:139], v[104:107], v[72:75], v[124:139]
    s_waitcnt vmcnt(6)
    ds_write_b128 v3, v[12:15] offset:0
    ds_write_b128 v3, v[16:19] offset:16
    ds_write_b128 v3, v[20:23] offset:32
    ds_write_b128 v3, v[24:27] offset:48
    ds_write_b128 v4, v[44:47] offset:0
    ds_write_b128 v4, v[48:51] offset:16
    s_waitcnt lgkmcnt(0)
    s_barrier
    buffer_load_dwordx4 v[12:15], v1, s[12:15], 0 offen offset:1024
    buffer_load_dwordx4 v[16:19], v1, s[12:15], 0 offen offset:1040
    buffer_load_dwordx4 v[20:23], v1, s[12:15], 0 offen offset:1056
    buffer_load_dwordx4 v[24:27], v1, s[12:15], 0 offen offset:1072
    s_mov_b32 s32, 0x90000
    buffer_load_dwordx4 v[44:47], v2, s[16:19], s32 offen offset:0
    buffer_load_dwordx4 v[48:51], v2, s[16:19], s32 offen offset:16
    ds_read_b128 v[60:63], v5 offset:0
    ds_read_b64_tr_b16 v[76:77], v6 offset:0
    ds_read_b64_tr_b16 v[78:79], v6 offset:768
    ds_read_b64_tr_b16 v[80:81], v6 offset:64
    ds_read_b64_tr_b16 v[82:83], v6 offset:832
    ds_read_b128 v[64:67], v5 offset:32
    ds_read_b64_tr_b16 v[84:85], v6 offset:3072
    ds_read_b64_tr_b16 v[86:87], v6 offset:3840
    ds_read_b64_tr_b16 v[88:89], v6 offset:3136
    ds_read_b64_tr_b16 v[90:91], v6 offset:3904
    ds_read_b128 v[68:71], v5 offset:64
    ds_read_b64_tr_b16 v[92:93], v6 offset:6144
    ds_read_b64_tr_b16 v[94:95], v6 offset:6912
    ds_read_b64_tr_b16 v[96:97], v6 offset:6208
    ds_read_b64_tr_b16 v[98:99], v6 offset:6976
    ds_read_b128 v[72:75], v5 offset:96
    ds_read_b64_tr_b16 v[100:101], v6 offset:9216
    ds_read_b64_tr_b16 v[102:103], v6 offset:9984
    ds_read_b64_tr_b16 v[104:105], v6 offset:9280
    ds_read_b64_tr_b16 v[106:107], v6 offset:10048
    s_waitcnt lgkmcnt(15)
    v_mfma_f32_32x32x16_bf16 v[108:123], v[76:79], v[60:63], v[108:123]
    v_mfma_f32_32x32x16_bf16 v[124:139], v[80:83], v[60:63], v[124:139]
    s_waitcnt lgkmcnt(10)
    v_mfma_f32_32x32x16_bf16 v[108:123], v[84:87], v[64:67], v[108:123]
    v_mfma_f32_32x32x16_bf16 v[124:139], v[88:91], v[64:67], v[124:139]
    s_waitcnt lgkmcnt(5)
    v_mfma_f32_32x32x16_bf16 v[108:123], v[92:95], v[68:71], v[108:123]
    v_mfma_f32_32x32x16_bf16 v[124:139], v[96:99], v[68:71], v[124:139]
    s_waitcnt lgkmcnt(0)
    v_mfma_f32_32x32x16_bf16 v[108:123], v[100:103], v[72:75], v[108:123]
    v_mfma_f32_32x32x16_bf16 v[124:139], v[104:107], v[72:75], v[124:139]
    s_waitcnt vmcnt(6)
    ds_write_b128 v3, v[28:31] offset:30720
    ds_write_b128 v3, v[32:35] offset:30736
    ds_write_b128 v3, v[36:39] offset:30752
    ds_write_b128 v3, v[40:43] offset:30768
    ds_write_b128 v4, v[52:55] offset:30720
    ds_write_b128 v4, v[56:59] offset:30736
    s_waitcnt lgkmcnt(0)
    s_barrier
    ds_read_b128 v[60:63], v5 offset:30720
    ds_read_b64_tr_b16 v[76:77], v6 offset:30720
    ds_read_b64_tr_b16 v[78:79], v6 offset:31488
    ds_read_b64_tr_b16 v[80:81], v6 offset:30784
    ds_read_b64_tr_b16 v[82:83], v6 offset:31552
    ds_read_b128 v[64:67], v5 offset:30752
    ds_read_b64_tr_b16 v[84:85], v6 offset:33792
    ds_read_b64_tr_b16 v[86:87], v6 offset:34560
    ds_read_b64_tr_b16 v[88:89], v6 offset:33856
    ds_read_b64_tr_b16 v[90:91], v6 offset:34624
    ds_read_b128 v[68:71], v5 offset:30784
    ds_read_b64_tr_b16 v[92:93], v6 offset:36864
    ds_read_b64_tr_b16 v[94:95], v6 offset:37632
    ds_read_b64_tr_b16 v[96:97], v6 offset:36928
    ds_read_b64_tr_b16 v[98:99], v6 offset:37696
    ds_read_b128 v[72:75], v5 offset:30816
    ds_read_b64_tr_b16 v[100:101], v6 offset:39936
    ds_read_b64_tr_b16 v[102:103], v6 offset:40704
    ds_read_b64_tr_b16 v[104:105], v6 offset:40000
    ds_read_b64_tr_b16 v[106:107], v6 offset:40768
    s_waitcnt lgkmcnt(15)
    v_mfma_f32_32x32x16_bf16 v[108:123], v[76:79], v[60:63], v[108:123]
    v_mfma_f32_32x32x16_bf16 v[124:139], v[80:83], v[60:63], v[124:139]
    s_waitcnt lgkmcnt(10)
    v_mfma_f32_32x32x16_bf16 v[108:123], v[84:87], v[64:67], v[108:123]
    v_mfma_f32_32x32x16_bf16 v[124:139], v[88:91], v[64:67], v[124:139]
    s_waitcnt lgkmcnt(5)
    v_mfma_f32_32x32x16_bf16 v[108:123], v[92:95], v[68:71], v[108:123]
    v_mfma_f32_32x32x16_bf16 v[124:139], v[96:99], v[68:71], v[124:139]
    s_waitcnt lgkmcnt(0)
    v_mfma_f32_32x32x16_bf16 v[108:123], v[100:103], v[72:75], v[108:123]
    v_mfma_f32_32x32x16_bf16 v[124:139], v[104:107], v[72:75], v[124:139]
    s_waitcnt vmcnt(0)
    ds_write_b128 v3, v[12:15] offset:0
    ds_write_b128 v3, v[16:19] offset:16
    ds_write_b128 v3, v[20:23] offset:32
    ds_write_b128 v3, v[24:27] offset:48
    ds_write_b128 v4, v[44:47] offset:0
    ds_write_b128 v4, v[48:51] offset:16
    s_waitcnt lgkmcnt(0)
    s_barrier
    ds_read_b128 v[60:63], v5 offset:0
    ds_read_b64_tr_b16 v[76:77], v6 offset:0
    ds_read_b64_tr_b16 v[78:79], v6 offset:768
    ds_read_b64_tr_b16 v[80:81], v6 offset:64
    ds_read_b64_tr_b16 v[82:83], v6 offset:832
    ds_read_b128 v[64:67], v5 offset:32
    ds_read_b64_tr_b16 v[84:85], v6 offset:3072
    ds_read_b64_tr_b16 v[86:87], v6 offset:3840
    ds_read_b64_tr_b16 v[88:89], v6 offset:3136
    ds_read_b64_tr_b16 v[90:91], v6 offset:3904
    ds_read_b128 v[68:71], v5 offset:64
    ds_read_b64_tr_b16 v[92:93], v6 offset:6144
    ds_read_b64_tr_b16 v[94:95], v6 offset:6912
    ds_read_b64_tr_b16 v[96:97], v6 offset:6208
    ds_read_b64_tr_b16 v[98:99], v6 offset:6976
    ds_read_b128 v[72:75], v5 offset:96
    ds_read_b64_tr_b16 v[100:101], v6 offset:9216
    ds_read_b64_tr_b16 v[102:103], v6 offset:9984
    ds_read_b64_tr_b16 v[104:105], v6 offset:9280
    ds_read_b64_tr_b16 v[106:107], v6 offset:10048
    s_waitcnt lgkmcnt(15)
    v_mfma_f32_32x32x16_bf16 v[108:123], v[76:79], v[60:63], v[108:123]
    v_mfma_f32_32x32x16_bf16 v[124:139], v[80:83], v[60:63], v[124:139]
    s_waitcnt lgkmcnt(10)
    v_mfma_f32_32x32x16_bf16 v[108:123], v[84:87], v[64:67], v[108:123]
    v_mfma_f32_32x32x16_bf16 v[124:139], v[88:91], v[64:67], v[124:139]
    s_waitcnt lgkmcnt(5)
    v_mfma_f32_32x32x16_bf16 v[108:123], v[92:95], v[68:71], v[108:123]
    v_mfma_f32_32x32x16_bf16 v[124:139], v[96:99], v[68:71], v[124:139]
    s_waitcnt lgkmcnt(0)
    v_mfma_f32_32x32x16_bf16 v[108:123], v[100:103], v[72:75], v[108:123]
    v_mfma_f32_32x32x16_bf16 v[124:139], v[104:107], v[72:75], v[124:139]
    s_nop 7
    s_nop 7
    v_lshrrev_b32 v7, 6, v0
    v_lshlrev_b32 v7, 5, v7
    v_and_b32 v8, 31, v0
    v_add3_u32 v7, v7, v8, s30
    v_mul_u32_u24 v1, 1152, v7
    v_bfe_u32 v8, v0, 5, 1
    v_lshlrev_b32 v8, 3, v8
    v_add3_u32 v1, v1, v8, s31
    buffer_load_dwordx2 v[60:61], v1, s[24:27], 0 offen offset:0
    buffer_load_dwordx2 v[62:63], v1, s[24:27], 0 offen offset:16
    buffer_load_dwordx2 v[64:65], v1, s[24:27], 0 offen offset:32
    buffer_load_dwordx2 v[66:67], v1, s[24:27], 0 offen offset:48
    buffer_load_dwordx2 v[68:69], v1, s[24:27], 0 offen offset:64
    buffer_load_dwordx2 v[70:71], v1, s[24:27], 0 offen offset:80
    buffer_load_dwordx2 v[72:73], v1, s[24:27], 0 offen offset:96
    buffer_load_dwordx2 v[74:75], v1, s[24:27], 0 offen offset:112
    s_waitcnt vmcnt(0)
    v_cvt_pk_bf16_f32 v76, v108, v109
    v_lshlrev_b32 v108, 16, v76
    v_and_b32 v109, 0xffff0000, v76
    v_lshlrev_b32 v7, 16, v60
    v_and_b32 v8, 0xffff0000, v60
    v_add_f32 v108, v108, v7
    v_add_f32 v109, v109, v8
    v_cvt_pk_bf16_f32 v76, v108, v109
    v_cvt_pk_bf16_f32 v77, v110, v111
    v_lshlrev_b32 v110, 16, v77
    v_and_b32 v111, 0xffff0000, v77
    v_lshlrev_b32 v7, 16, v61
    v_and_b32 v8, 0xffff0000, v61
    v_add_f32 v110, v110, v7
    v_add_f32 v111, v111, v8
    v_cvt_pk_bf16_f32 v77, v110, v111
    buffer_store_dwordx2 v[76:77], v1, s[20:23], 0 offen offset:0
    v_cvt_pk_bf16_f32 v78, v112, v113
    v_lshlrev_b32 v112, 16, v78
    v_and_b32 v113, 0xffff0000, v78
    v_lshlrev_b32 v7, 16, v62
    v_and_b32 v8, 0xffff0000, v62
    v_add_f32 v112, v112, v7
    v_add_f32 v113, v113, v8
    v_cvt_pk_bf16_f32 v78, v112, v113
    v_cvt_pk_bf16_f32 v79, v114, v115
    v_lshlrev_b32 v114, 16, v79
    v_and_b32 v115, 0xffff0000, v79
    v_lshlrev_b32 v7, 16, v63
    v_and_b32 v8, 0xffff0000, v63
    v_add_f32 v114, v114, v7
    v_add_f32 v115, v115, v8
    v_cvt_pk_bf16_f32 v79, v114, v115
    buffer_store_dwordx2 v[78:79], v1, s[20:23], 0 offen offset:16
    v_cvt_pk_bf16_f32 v80, v116, v117
    v_lshlrev_b32 v116, 16, v80
    v_and_b32 v117, 0xffff0000, v80
    v_lshlrev_b32 v7, 16, v64
    v_and_b32 v8, 0xffff0000, v64
    v_add_f32 v116, v116, v7
    v_add_f32 v117, v117, v8
    v_cvt_pk_bf16_f32 v80, v116, v117
    v_cvt_pk_bf16_f32 v81, v118, v119
    v_lshlrev_b32 v118, 16, v81
    v_and_b32 v119, 0xffff0000, v81
    v_lshlrev_b32 v7, 16, v65
    v_and_b32 v8, 0xffff0000, v65
    v_add_f32 v118, v118, v7
    v_add_f32 v119, v119, v8
    v_cvt_pk_bf16_f32 v81, v118, v119
    buffer_store_dwordx2 v[80:81], v1, s[20:23], 0 offen offset:32
    v_cvt_pk_bf16_f32 v82, v120, v121
    v_lshlrev_b32 v120, 16, v82
    v_and_b32 v121, 0xffff0000, v82
    v_lshlrev_b32 v7, 16, v66
    v_and_b32 v8, 0xffff0000, v66
    v_add_f32 v120, v120, v7
    v_add_f32 v121, v121, v8
    v_cvt_pk_bf16_f32 v82, v120, v121
    v_cvt_pk_bf16_f32 v83, v122, v123
    v_lshlrev_b32 v122, 16, v83
    v_and_b32 v123, 0xffff0000, v83
    v_lshlrev_b32 v7, 16, v67
    v_and_b32 v8, 0xffff0000, v67
    v_add_f32 v122, v122, v7
    v_add_f32 v123, v123, v8
    v_cvt_pk_bf16_f32 v83, v122, v123
    buffer_store_dwordx2 v[82:83], v1, s[20:23], 0 offen offset:48
    v_cvt_pk_bf16_f32 v84, v124, v125
    v_lshlrev_b32 v124, 16, v84
    v_and_b32 v125, 0xffff0000, v84
    v_lshlrev_b32 v7, 16, v68
    v_and_b32 v8, 0xffff0000, v68
    v_add_f32 v124, v124, v7
    v_add_f32 v125, v125, v8
    v_cvt_pk_bf16_f32 v84, v124, v125
    v_cvt_pk_bf16_f32 v85, v126, v127
    v_lshlrev_b32 v126, 16, v85
    v_and_b32 v127, 0xffff0000, v85
    v_lshlrev_b32 v7, 16, v69
    v_and_b32 v8, 0xffff0000, v69
    v_add_f32 v126, v126, v7
    v_add_f32 v127, v127, v8
    v_cvt_pk_bf16_f32 v85, v126, v127
    buffer_store_dwordx2 v[84:85], v1, s[20:23], 0 offen offset:64
    v_cvt_pk_bf16_f32 v86, v128, v129
    v_lshlrev_b32 v128, 16, v86
    v_and_b32 v129, 0xffff0000, v86
    v_lshlrev_b32 v7, 16, v70
    v_and_b32 v8, 0xffff0000, v70
    v_add_f32 v128, v128, v7
    v_add_f32 v129, v129, v8
    v_cvt_pk_bf16_f32 v86, v128, v129
    v_cvt_pk_bf16_f32 v87, v130, v131
    v_lshlrev_b32 v130, 16, v87
    v_and_b32 v131, 0xffff0000, v87
    v_lshlrev_b32 v7, 16, v71
    v_and_b32 v8, 0xffff0000, v71
    v_add_f32 v130, v130, v7
    v_add_f32 v131, v131, v8
    v_cvt_pk_bf16_f32 v87, v130, v131
    buffer_store_dwordx2 v[86:87], v1, s[20:23], 0 offen offset:80
    v_cvt_pk_bf16_f32 v88, v132, v133
    v_lshlrev_b32 v132, 16, v88
    v_and_b32 v133, 0xffff0000, v88
    v_lshlrev_b32 v7, 16, v72
    v_and_b32 v8, 0xffff0000, v72
    v_add_f32 v132, v132, v7
    v_add_f32 v133, v133, v8
    v_cvt_pk_bf16_f32 v88, v132, v133
    v_cvt_pk_bf16_f32 v89, v134, v135
    v_lshlrev_b32 v134, 16, v89
    v_and_b32 v135, 0xffff0000, v89
    v_lshlrev_b32 v7, 16, v73
    v_and_b32 v8, 0xffff0000, v73
    v_add_f32 v134, v134, v7
    v_add_f32 v135, v135, v8
    v_cvt_pk_bf16_f32 v89, v134, v135
    buffer_store_dwordx2 v[88:89], v1, s[20:23], 0 offen offset:96
    v_cvt_pk_bf16_f32 v90, v136, v137
    v_lshlrev_b32 v136, 16, v90
    v_and_b32 v137, 0xffff0000, v90
    v_lshlrev_b32 v7, 16, v74
    v_and_b32 v8, 0xffff0000, v74
    v_add_f32 v136, v136, v7
    v_add_f32 v137, v137, v8
    v_cvt_pk_bf16_f32 v90, v136, v137
    v_cvt_pk_bf16_f32 v91, v138, v139
    v_lshlrev_b32 v138, 16, v91
    v_and_b32 v139, 0xffff0000, v91
    v_lshlrev_b32 v7, 16, v75
    v_and_b32 v8, 0xffff0000, v75
    v_add_f32 v138, v138, v7
    v_add_f32 v139, v139, v8
    v_cvt_pk_bf16_f32 v91, v138, v139
    buffer_store_dwordx2 v[90:91], v1, s[20:23], 0 offen offset:112
op2_kernel_done:
    s_endpgm
.globl ln3_kernel
.p2align 8
.type ln3_kernel,@function
ln3_kernel:
    s_load_dwordx2 s[4:5], s[0:1], 72
    s_load_dwordx2 s[6:7], s[0:1], 72
    s_cmp_ge_u32 s2, 256
    s_cbranch_scc1 ln3_kernel_done
    s_waitcnt lgkmcnt(0)
    s_add_u32 s4, s4, 0xfc0000
    s_addc_u32 s5, s5, 0
    s_mov_b32 s8, s4
    s_and_b32 s9, s5, 0xffff
    s_mov_b32 s10, 0x240000
    s_mov_b32 s11, 0x20000
    s_mov_b32 s12, s6
    s_and_b32 s13, s7, 0xffff
    s_mov_b32 s14, 0x240000
    s_mov_b32 s15, 0x20000
    s_lshl_b32 s3, s2, 8
    v_add_u32 v1, s3, v0
    v_lshrrev_b32 v2, 5, v1
    v_mul_u32_u24 v2, 1152, v2
    v_and_b32 v1, 31, v1
    v_mul_u32_u24 v1, 36, v1
    v_add_u32 v2, v2, v1
    buffer_load_dwordx4 v[4:7], v2, s[8:11], 0 offen
    buffer_load_dwordx4 v[8:11], v2, s[8:11], 0 offen offset:16
    buffer_load_dword v12, v2, s[8:11], 0 offen offset:32
    s_waitcnt vmcnt(0)
    v_lshlrev_b32 v13, 16, v4
    v_and_b32 v14, 0xffff0000, v4
    v_lshlrev_b32 v15, 16, v5
    v_and_b32 v16, 0xffff0000, v5
    v_lshlrev_b32 v17, 16, v6
    v_and_b32 v18, 0xffff0000, v6
    v_lshlrev_b32 v19, 16, v7
    v_and_b32 v20, 0xffff0000, v7
    v_lshlrev_b32 v21, 16, v8
    v_and_b32 v22, 0xffff0000, v8
    v_lshlrev_b32 v23, 16, v9
    v_and_b32 v24, 0xffff0000, v9
    v_lshlrev_b32 v25, 16, v10
    v_and_b32 v26, 0xffff0000, v10
    v_lshlrev_b32 v27, 16, v11
    v_and_b32 v28, 0xffff0000, v11
    v_lshlrev_b32 v29, 16, v12
    v_and_b32 v30, 0xffff0000, v12
    v_add_f32 v31, v13, v14
    v_add_f32 v31, v31, v15
    v_add_f32 v31, v31, v16
    v_add_f32 v31, v31, v17
    v_add_f32 v31, v31, v18
    v_add_f32 v31, v31, v19
    v_add_f32 v31, v31, v20
    v_add_f32 v31, v31, v21
    v_add_f32 v31, v31, v22
    v_add_f32 v31, v31, v23
    v_add_f32 v31, v31, v24
    v_add_f32 v31, v31, v25
    v_add_f32 v31, v31, v26
    v_add_f32 v31, v31, v27
    v_add_f32 v31, v31, v28
    v_add_f32 v31, v31, v29
    v_add_f32 v31, v31, v30
    ds_swizzle_b32 v32, v31 offset:0x41f
    s_waitcnt lgkmcnt(0)
    v_add_f32 v31, v31, v32
    ds_swizzle_b32 v32, v31 offset:0x81f
    s_waitcnt lgkmcnt(0)
    v_add_f32 v31, v31, v32
    ds_swizzle_b32 v32, v31 offset:0x101f
    s_waitcnt lgkmcnt(0)
    v_add_f32 v31, v31, v32
    ds_swizzle_b32 v32, v31 offset:0x201f
    s_waitcnt lgkmcnt(0)
    v_add_f32 v31, v31, v32
    ds_swizzle_b32 v32, v31 offset:0x401f
    s_waitcnt lgkmcnt(0)
    v_add_f32 v31, v31, v32
    v_mul_f32 v33, 0x3ae38e39, v31
    v_sub_f32 v13, v13, v33
    v_sub_f32 v14, v14, v33
    v_sub_f32 v15, v15, v33
    v_sub_f32 v16, v16, v33
    v_sub_f32 v17, v17, v33
    v_sub_f32 v18, v18, v33
    v_sub_f32 v19, v19, v33
    v_sub_f32 v20, v20, v33
    v_sub_f32 v21, v21, v33
    v_sub_f32 v22, v22, v33
    v_sub_f32 v23, v23, v33
    v_sub_f32 v24, v24, v33
    v_sub_f32 v25, v25, v33
    v_sub_f32 v26, v26, v33
    v_sub_f32 v27, v27, v33
    v_sub_f32 v28, v28, v33
    v_sub_f32 v29, v29, v33
    v_sub_f32 v30, v30, v33
    v_mul_f32 v31, v13, v13
    v_fmac_f32 v31, v14, v14
    v_fmac_f32 v31, v15, v15
    v_fmac_f32 v31, v16, v16
    v_fmac_f32 v31, v17, v17
    v_fmac_f32 v31, v18, v18
    v_fmac_f32 v31, v19, v19
    v_fmac_f32 v31, v20, v20
    v_fmac_f32 v31, v21, v21
    v_fmac_f32 v31, v22, v22
    v_fmac_f32 v31, v23, v23
    v_fmac_f32 v31, v24, v24
    v_fmac_f32 v31, v25, v25
    v_fmac_f32 v31, v26, v26
    v_fmac_f32 v31, v27, v27
    v_fmac_f32 v31, v28, v28
    v_fmac_f32 v31, v29, v29
    v_fmac_f32 v31, v30, v30
    ds_swizzle_b32 v32, v31 offset:0x41f
    s_waitcnt lgkmcnt(0)
    v_add_f32 v31, v31, v32
    ds_swizzle_b32 v32, v31 offset:0x81f
    s_waitcnt lgkmcnt(0)
    v_add_f32 v31, v31, v32
    ds_swizzle_b32 v32, v31 offset:0x101f
    s_waitcnt lgkmcnt(0)
    v_add_f32 v31, v31, v32
    ds_swizzle_b32 v32, v31 offset:0x201f
    s_waitcnt lgkmcnt(0)
    v_add_f32 v31, v31, v32
    ds_swizzle_b32 v32, v31 offset:0x401f
    s_waitcnt lgkmcnt(0)
    v_add_f32 v31, v31, v32
    v_mov_b32 v34, 0x3727c5ac
    v_fmac_f32 v34, 0x3ae38e39, v31
    v_rsq_f32 v34, v34
    s_nop 0
    v_mul_f32 v13, v13, v34
    v_mul_f32 v14, v14, v34
    v_mul_f32 v15, v15, v34
    v_mul_f32 v16, v16, v34
    v_mul_f32 v17, v17, v34
    v_mul_f32 v18, v18, v34
    v_mul_f32 v19, v19, v34
    v_mul_f32 v20, v20, v34
    v_mul_f32 v21, v21, v34
    v_mul_f32 v22, v22, v34
    v_mul_f32 v23, v23, v34
    v_mul_f32 v24, v24, v34
    v_mul_f32 v25, v25, v34
    v_mul_f32 v26, v26, v34
    v_mul_f32 v27, v27, v34
    v_mul_f32 v28, v28, v34
    v_mul_f32 v29, v29, v34
    v_mul_f32 v30, v30, v34
    v_cvt_pk_bf16_f32 v4, v13, v14
    v_cvt_pk_bf16_f32 v5, v15, v16
    v_cvt_pk_bf16_f32 v6, v17, v18
    v_cvt_pk_bf16_f32 v7, v19, v20
    v_cvt_pk_bf16_f32 v8, v21, v22
    v_cvt_pk_bf16_f32 v9, v23, v24
    v_cvt_pk_bf16_f32 v10, v25, v26
    v_cvt_pk_bf16_f32 v11, v27, v28
    v_cvt_pk_bf16_f32 v12, v29, v30
    buffer_store_dwordx4 v[4:7], v2, s[12:15], 0 offen
    buffer_store_dwordx4 v[8:11], v2, s[12:15], 0 offen offset:16
    buffer_store_dword v12, v2, s[12:15], 0 offen offset:32
ln3_kernel_done:
    s_endpgm
.globl op3_kernel
.p2align 8
.type op3_kernel,@function
op3_kernel:
    s_load_dwordx2 s[4:5], s[0:1], 72
    s_load_dwordx2 s[6:7], s[0:1], 48
    s_load_dwordx2 s[8:9], s[0:1], 56
    s_load_dwordx2 s[10:11], s[0:1], 72
    s_cmp_ge_u32 s2, 144
    s_cbranch_scc1 op3_kernel_done
    s_waitcnt lgkmcnt(0)
    s_add_u32 s4, s4, 0x900000
    s_addc_u32 s5, s5, 0
    s_add_u32 s10, s10, 0xfc0000
    s_addc_u32 s11, s11, 0
    s_mov_b32 s12, s4
    s_and_b32 s13, s5, 0xffff
    s_mov_b32 s14, 0x240000
    s_mov_b32 s15, 0x20000
    s_mov_b32 s16, s6
    s_and_b32 s17, s7, 0xffff
    s_mov_b32 s18, 0xa2000
    s_mov_b32 s19, 0x20000
    s_mov_b32 s20, s8
    s_and_b32 s21, s9, 0xffff
    s_mov_b32 s22, 0x240000
    s_mov_b32 s23, 0x20000
    s_mov_b32 s24, s10
    s_and_b32 s25, s11, 0xffff
    s_mov_b32 s26, 0x240000
    s_mov_b32 s27, 0x20000
    s_mov_b32 s30, 0x1c71c71d
    s_mul_hi_u32 s28, s2, s30
    s_mul_i32 s30, s28, 9
    s_sub_u32 s29, s2, s30
    s_lshl_b32 s30, s28, 7
    v_lshrrev_b32 v7, 1, v0
    v_add_u32 v8, s30, v7
    v_mul_u32_u24 v1, 1152, v8
    v_and_b32 v8, 1, v0
    v_lshlrev_b32 v8, 6, v8
    v_add_u32 v1, v1, v8
    v_mul_u32_u24 v3, 144, v7
    v_add_u32 v3, v3, v8
    v_lshrrev_b32 v7, 2, v0
    v_mul_u32_u24 v2, 1152, v7
    v_and_b32 v8, 3, v0
    v_lshlrev_b32 v8, 5, v8
    v_add_u32 v2, v2, v8
    s_lshl_b32 s31, s29, 7
    v_add_u32 v2, s31, v2
    v_mul_u32_u24 v4, 192, v7
    v_add_u32 v4, v4, v8
    v_add_u32 v4, 18432, v4
    v_lshrrev_b32 v7, 6, v0
    v_lshlrev_b32 v7, 5, v7
    v_and_b32 v8, 31, v0
    v_add_u32 v7, v7, v8
    v_mul_u32_u24 v5, 144, v7
    v_bfe_u32 v8, v0, 5, 1
    v_lshlrev_b32 v8, 4, v8
    v_add_u32 v5, v5, v8
    v_bfe_u32 v7, v0, 5, 1
    v_lshlrev_b32 v7, 3, v7
    v_bfe_u32 v8, v0, 2, 2
    v_add_u32 v7, v7, v8
    v_mul_u32_u24 v6, 192, v7
    v_bfe_u32 v7, v0, 4, 1
    v_lshlrev_b32 v7, 5, v7
    v_and_b32 v8, 3, v0
    v_lshlrev_b32 v8, 3, v8
    v_add3_u32 v6, v6, v7, v8
    v_add_u32 v6, 18432, v6
    v_mov_b32 v108, 0
    v_mov_b32 v109, 0
    v_mov_b32 v110, 0
    v_mov_b32 v111, 0
    v_mov_b32 v112, 0
    v_mov_b32 v113, 0
    v_mov_b32 v114, 0
    v_mov_b32 v115, 0
    v_mov_b32 v116, 0
    v_mov_b32 v117, 0
    v_mov_b32 v118, 0
    v_mov_b32 v119, 0
    v_mov_b32 v120, 0
    v_mov_b32 v121, 0
    v_mov_b32 v122, 0
    v_mov_b32 v123, 0
    v_mov_b32 v124, 0
    v_mov_b32 v125, 0
    v_mov_b32 v126, 0
    v_mov_b32 v127, 0
    v_mov_b32 v128, 0
    v_mov_b32 v129, 0
    v_mov_b32 v130, 0
    v_mov_b32 v131, 0
    v_mov_b32 v132, 0
    v_mov_b32 v133, 0
    v_mov_b32 v134, 0
    v_mov_b32 v135, 0
    v_mov_b32 v136, 0
    v_mov_b32 v137, 0
    v_mov_b32 v138, 0
    v_mov_b32 v139, 0
    buffer_load_dwordx4 v[12:15], v1, s[12:15], 0 offen offset:0
    buffer_load_dwordx4 v[16:19], v1, s[12:15], 0 offen offset:16
    buffer_load_dwordx4 v[20:23], v1, s[12:15], 0 offen offset:32
    buffer_load_dwordx4 v[24:27], v1, s[12:15], 0 offen offset:48
    s_mov_b32 s32, 0x0
    buffer_load_dwordx4 v[44:47], v2, s[16:19], s32 offen offset:0
    buffer_load_dwordx4 v[48:51], v2, s[16:19], s32 offen offset:16
    buffer_load_dwordx4 v[28:31], v1, s[12:15], 0 offen offset:128
    buffer_load_dwordx4 v[32:35], v1, s[12:15], 0 offen offset:144
    buffer_load_dwordx4 v[36:39], v1, s[12:15], 0 offen offset:160
    buffer_load_dwordx4 v[40:43], v1, s[12:15], 0 offen offset:176
    s_mov_b32 s32, 0x12000
    buffer_load_dwordx4 v[52:55], v2, s[16:19], s32 offen offset:0
    buffer_load_dwordx4 v[56:59], v2, s[16:19], s32 offen offset:16
    s_waitcnt vmcnt(6)
    ds_write_b128 v3, v[12:15] offset:0
    ds_write_b128 v3, v[16:19] offset:16
    ds_write_b128 v3, v[20:23] offset:32
    ds_write_b128 v3, v[24:27] offset:48
    ds_write_b128 v4, v[44:47] offset:0
    ds_write_b128 v4, v[48:51] offset:16
    s_waitcnt lgkmcnt(0)
    s_barrier
    buffer_load_dwordx4 v[12:15], v1, s[12:15], 0 offen offset:256
    buffer_load_dwordx4 v[16:19], v1, s[12:15], 0 offen offset:272
    buffer_load_dwordx4 v[20:23], v1, s[12:15], 0 offen offset:288
    buffer_load_dwordx4 v[24:27], v1, s[12:15], 0 offen offset:304
    s_mov_b32 s32, 0x24000
    buffer_load_dwordx4 v[44:47], v2, s[16:19], s32 offen offset:0
    buffer_load_dwordx4 v[48:51], v2, s[16:19], s32 offen offset:16
    ds_read_b128 v[60:63], v5 offset:0
    ds_read_b64_tr_b16 v[76:77], v6 offset:0
    ds_read_b64_tr_b16 v[78:79], v6 offset:768
    ds_read_b64_tr_b16 v[80:81], v6 offset:64
    ds_read_b64_tr_b16 v[82:83], v6 offset:832
    ds_read_b128 v[64:67], v5 offset:32
    ds_read_b64_tr_b16 v[84:85], v6 offset:3072
    ds_read_b64_tr_b16 v[86:87], v6 offset:3840
    ds_read_b64_tr_b16 v[88:89], v6 offset:3136
    ds_read_b64_tr_b16 v[90:91], v6 offset:3904
    ds_read_b128 v[68:71], v5 offset:64
    ds_read_b64_tr_b16 v[92:93], v6 offset:6144
    ds_read_b64_tr_b16 v[94:95], v6 offset:6912
    ds_read_b64_tr_b16 v[96:97], v6 offset:6208
    ds_read_b64_tr_b16 v[98:99], v6 offset:6976
    ds_read_b128 v[72:75], v5 offset:96
    ds_read_b64_tr_b16 v[100:101], v6 offset:9216
    ds_read_b64_tr_b16 v[102:103], v6 offset:9984
    ds_read_b64_tr_b16 v[104:105], v6 offset:9280
    ds_read_b64_tr_b16 v[106:107], v6 offset:10048
    s_waitcnt lgkmcnt(15)
    v_mfma_f32_32x32x16_bf16 v[108:123], v[76:79], v[60:63], v[108:123]
    v_mfma_f32_32x32x16_bf16 v[124:139], v[80:83], v[60:63], v[124:139]
    s_waitcnt lgkmcnt(10)
    v_mfma_f32_32x32x16_bf16 v[108:123], v[84:87], v[64:67], v[108:123]
    v_mfma_f32_32x32x16_bf16 v[124:139], v[88:91], v[64:67], v[124:139]
    s_waitcnt lgkmcnt(5)
    v_mfma_f32_32x32x16_bf16 v[108:123], v[92:95], v[68:71], v[108:123]
    v_mfma_f32_32x32x16_bf16 v[124:139], v[96:99], v[68:71], v[124:139]
    s_waitcnt lgkmcnt(0)
    v_mfma_f32_32x32x16_bf16 v[108:123], v[100:103], v[72:75], v[108:123]
    v_mfma_f32_32x32x16_bf16 v[124:139], v[104:107], v[72:75], v[124:139]
    s_waitcnt vmcnt(6)
    ds_write_b128 v3, v[28:31] offset:30720
    ds_write_b128 v3, v[32:35] offset:30736
    ds_write_b128 v3, v[36:39] offset:30752
    ds_write_b128 v3, v[40:43] offset:30768
    ds_write_b128 v4, v[52:55] offset:30720
    ds_write_b128 v4, v[56:59] offset:30736
    s_waitcnt lgkmcnt(0)
    s_barrier
    buffer_load_dwordx4 v[28:31], v1, s[12:15], 0 offen offset:384
    buffer_load_dwordx4 v[32:35], v1, s[12:15], 0 offen offset:400
    buffer_load_dwordx4 v[36:39], v1, s[12:15], 0 offen offset:416
    buffer_load_dwordx4 v[40:43], v1, s[12:15], 0 offen offset:432
    s_mov_b32 s32, 0x36000
    buffer_load_dwordx4 v[52:55], v2, s[16:19], s32 offen offset:0
    buffer_load_dwordx4 v[56:59], v2, s[16:19], s32 offen offset:16
    ds_read_b128 v[60:63], v5 offset:30720
    ds_read_b64_tr_b16 v[76:77], v6 offset:30720
    ds_read_b64_tr_b16 v[78:79], v6 offset:31488
    ds_read_b64_tr_b16 v[80:81], v6 offset:30784
    ds_read_b64_tr_b16 v[82:83], v6 offset:31552
    ds_read_b128 v[64:67], v5 offset:30752
    ds_read_b64_tr_b16 v[84:85], v6 offset:33792
    ds_read_b64_tr_b16 v[86:87], v6 offset:34560
    ds_read_b64_tr_b16 v[88:89], v6 offset:33856
    ds_read_b64_tr_b16 v[90:91], v6 offset:34624
    ds_read_b128 v[68:71], v5 offset:30784
    ds_read_b64_tr_b16 v[92:93], v6 offset:36864
    ds_read_b64_tr_b16 v[94:95], v6 offset:37632
    ds_read_b64_tr_b16 v[96:97], v6 offset:36928
    ds_read_b64_tr_b16 v[98:99], v6 offset:37696
    ds_read_b128 v[72:75], v5 offset:30816
    ds_read_b64_tr_b16 v[100:101], v6 offset:39936
    ds_read_b64_tr_b16 v[102:103], v6 offset:40704
    ds_read_b64_tr_b16 v[104:105], v6 offset:40000
    ds_read_b64_tr_b16 v[106:107], v6 offset:40768
    s_waitcnt lgkmcnt(15)
    v_mfma_f32_32x32x16_bf16 v[108:123], v[76:79], v[60:63], v[108:123]
    v_mfma_f32_32x32x16_bf16 v[124:139], v[80:83], v[60:63], v[124:139]
    s_waitcnt lgkmcnt(10)
    v_mfma_f32_32x32x16_bf16 v[108:123], v[84:87], v[64:67], v[108:123]
    v_mfma_f32_32x32x16_bf16 v[124:139], v[88:91], v[64:67], v[124:139]
    s_waitcnt lgkmcnt(5)
    v_mfma_f32_32x32x16_bf16 v[108:123], v[92:95], v[68:71], v[108:123]
    v_mfma_f32_32x32x16_bf16 v[124:139], v[96:99], v[68:71], v[124:139]
    s_waitcnt lgkmcnt(0)
    v_mfma_f32_32x32x16_bf16 v[108:123], v[100:103], v[72:75], v[108:123]
    v_mfma_f32_32x32x16_bf16 v[124:139], v[104:107], v[72:75], v[124:139]
    s_waitcnt vmcnt(6)
    ds_write_b128 v3, v[12:15] offset:0
    ds_write_b128 v3, v[16:19] offset:16
    ds_write_b128 v3, v[20:23] offset:32
    ds_write_b128 v3, v[24:27] offset:48
    ds_write_b128 v4, v[44:47] offset:0
    ds_write_b128 v4, v[48:51] offset:16
    s_waitcnt lgkmcnt(0)
    s_barrier
    buffer_load_dwordx4 v[12:15], v1, s[12:15], 0 offen offset:512
    buffer_load_dwordx4 v[16:19], v1, s[12:15], 0 offen offset:528
    buffer_load_dwordx4 v[20:23], v1, s[12:15], 0 offen offset:544
    buffer_load_dwordx4 v[24:27], v1, s[12:15], 0 offen offset:560
    s_mov_b32 s32, 0x48000
    buffer_load_dwordx4 v[44:47], v2, s[16:19], s32 offen offset:0
    buffer_load_dwordx4 v[48:51], v2, s[16:19], s32 offen offset:16
    ds_read_b128 v[60:63], v5 offset:0
    ds_read_b64_tr_b16 v[76:77], v6 offset:0
    ds_read_b64_tr_b16 v[78:79], v6 offset:768
    ds_read_b64_tr_b16 v[80:81], v6 offset:64
    ds_read_b64_tr_b16 v[82:83], v6 offset:832
    ds_read_b128 v[64:67], v5 offset:32
    ds_read_b64_tr_b16 v[84:85], v6 offset:3072
    ds_read_b64_tr_b16 v[86:87], v6 offset:3840
    ds_read_b64_tr_b16 v[88:89], v6 offset:3136
    ds_read_b64_tr_b16 v[90:91], v6 offset:3904
    ds_read_b128 v[68:71], v5 offset:64
    ds_read_b64_tr_b16 v[92:93], v6 offset:6144
    ds_read_b64_tr_b16 v[94:95], v6 offset:6912
    ds_read_b64_tr_b16 v[96:97], v6 offset:6208
    ds_read_b64_tr_b16 v[98:99], v6 offset:6976
    ds_read_b128 v[72:75], v5 offset:96
    ds_read_b64_tr_b16 v[100:101], v6 offset:9216
    ds_read_b64_tr_b16 v[102:103], v6 offset:9984
    ds_read_b64_tr_b16 v[104:105], v6 offset:9280
    ds_read_b64_tr_b16 v[106:107], v6 offset:10048
    s_waitcnt lgkmcnt(15)
    v_mfma_f32_32x32x16_bf16 v[108:123], v[76:79], v[60:63], v[108:123]
    v_mfma_f32_32x32x16_bf16 v[124:139], v[80:83], v[60:63], v[124:139]
    s_waitcnt lgkmcnt(10)
    v_mfma_f32_32x32x16_bf16 v[108:123], v[84:87], v[64:67], v[108:123]
    v_mfma_f32_32x32x16_bf16 v[124:139], v[88:91], v[64:67], v[124:139]
    s_waitcnt lgkmcnt(5)
    v_mfma_f32_32x32x16_bf16 v[108:123], v[92:95], v[68:71], v[108:123]
    v_mfma_f32_32x32x16_bf16 v[124:139], v[96:99], v[68:71], v[124:139]
    s_waitcnt lgkmcnt(0)
    v_mfma_f32_32x32x16_bf16 v[108:123], v[100:103], v[72:75], v[108:123]
    v_mfma_f32_32x32x16_bf16 v[124:139], v[104:107], v[72:75], v[124:139]
    s_waitcnt vmcnt(6)
    ds_write_b128 v3, v[28:31] offset:30720
    ds_write_b128 v3, v[32:35] offset:30736
    ds_write_b128 v3, v[36:39] offset:30752
    ds_write_b128 v3, v[40:43] offset:30768
    ds_write_b128 v4, v[52:55] offset:30720
    ds_write_b128 v4, v[56:59] offset:30736
    s_waitcnt lgkmcnt(0)
    s_barrier
    buffer_load_dwordx4 v[28:31], v1, s[12:15], 0 offen offset:640
    buffer_load_dwordx4 v[32:35], v1, s[12:15], 0 offen offset:656
    buffer_load_dwordx4 v[36:39], v1, s[12:15], 0 offen offset:672
    buffer_load_dwordx4 v[40:43], v1, s[12:15], 0 offen offset:688
    s_mov_b32 s32, 0x5a000
    buffer_load_dwordx4 v[52:55], v2, s[16:19], s32 offen offset:0
    buffer_load_dwordx4 v[56:59], v2, s[16:19], s32 offen offset:16
    ds_read_b128 v[60:63], v5 offset:30720
    ds_read_b64_tr_b16 v[76:77], v6 offset:30720
    ds_read_b64_tr_b16 v[78:79], v6 offset:31488
    ds_read_b64_tr_b16 v[80:81], v6 offset:30784
    ds_read_b64_tr_b16 v[82:83], v6 offset:31552
    ds_read_b128 v[64:67], v5 offset:30752
    ds_read_b64_tr_b16 v[84:85], v6 offset:33792
    ds_read_b64_tr_b16 v[86:87], v6 offset:34560
    ds_read_b64_tr_b16 v[88:89], v6 offset:33856
    ds_read_b64_tr_b16 v[90:91], v6 offset:34624
    ds_read_b128 v[68:71], v5 offset:30784
    ds_read_b64_tr_b16 v[92:93], v6 offset:36864
    ds_read_b64_tr_b16 v[94:95], v6 offset:37632
    ds_read_b64_tr_b16 v[96:97], v6 offset:36928
    ds_read_b64_tr_b16 v[98:99], v6 offset:37696
    ds_read_b128 v[72:75], v5 offset:30816
    ds_read_b64_tr_b16 v[100:101], v6 offset:39936
    ds_read_b64_tr_b16 v[102:103], v6 offset:40704
    ds_read_b64_tr_b16 v[104:105], v6 offset:40000
    ds_read_b64_tr_b16 v[106:107], v6 offset:40768
    s_waitcnt lgkmcnt(15)
    v_mfma_f32_32x32x16_bf16 v[108:123], v[76:79], v[60:63], v[108:123]
    v_mfma_f32_32x32x16_bf16 v[124:139], v[80:83], v[60:63], v[124:139]
    s_waitcnt lgkmcnt(10)
    v_mfma_f32_32x32x16_bf16 v[108:123], v[84:87], v[64:67], v[108:123]
    v_mfma_f32_32x32x16_bf16 v[124:139], v[88:91], v[64:67], v[124:139]
    s_waitcnt lgkmcnt(5)
    v_mfma_f32_32x32x16_bf16 v[108:123], v[92:95], v[68:71], v[108:123]
    v_mfma_f32_32x32x16_bf16 v[124:139], v[96:99], v[68:71], v[124:139]
    s_waitcnt lgkmcnt(0)
    v_mfma_f32_32x32x16_bf16 v[108:123], v[100:103], v[72:75], v[108:123]
    v_mfma_f32_32x32x16_bf16 v[124:139], v[104:107], v[72:75], v[124:139]
    s_waitcnt vmcnt(6)
    ds_write_b128 v3, v[12:15] offset:0
    ds_write_b128 v3, v[16:19] offset:16
    ds_write_b128 v3, v[20:23] offset:32
    ds_write_b128 v3, v[24:27] offset:48
    ds_write_b128 v4, v[44:47] offset:0
    ds_write_b128 v4, v[48:51] offset:16
    s_waitcnt lgkmcnt(0)
    s_barrier
    buffer_load_dwordx4 v[12:15], v1, s[12:15], 0 offen offset:768
    buffer_load_dwordx4 v[16:19], v1, s[12:15], 0 offen offset:784
    buffer_load_dwordx4 v[20:23], v1, s[12:15], 0 offen offset:800
    buffer_load_dwordx4 v[24:27], v1, s[12:15], 0 offen offset:816
    s_mov_b32 s32, 0x6c000
    buffer_load_dwordx4 v[44:47], v2, s[16:19], s32 offen offset:0
    buffer_load_dwordx4 v[48:51], v2, s[16:19], s32 offen offset:16
    ds_read_b128 v[60:63], v5 offset:0
    ds_read_b64_tr_b16 v[76:77], v6 offset:0
    ds_read_b64_tr_b16 v[78:79], v6 offset:768
    ds_read_b64_tr_b16 v[80:81], v6 offset:64
    ds_read_b64_tr_b16 v[82:83], v6 offset:832
    ds_read_b128 v[64:67], v5 offset:32
    ds_read_b64_tr_b16 v[84:85], v6 offset:3072
    ds_read_b64_tr_b16 v[86:87], v6 offset:3840
    ds_read_b64_tr_b16 v[88:89], v6 offset:3136
    ds_read_b64_tr_b16 v[90:91], v6 offset:3904
    ds_read_b128 v[68:71], v5 offset:64
    ds_read_b64_tr_b16 v[92:93], v6 offset:6144
    ds_read_b64_tr_b16 v[94:95], v6 offset:6912
    ds_read_b64_tr_b16 v[96:97], v6 offset:6208
    ds_read_b64_tr_b16 v[98:99], v6 offset:6976
    ds_read_b128 v[72:75], v5 offset:96
    ds_read_b64_tr_b16 v[100:101], v6 offset:9216
    ds_read_b64_tr_b16 v[102:103], v6 offset:9984
    ds_read_b64_tr_b16 v[104:105], v6 offset:9280
    ds_read_b64_tr_b16 v[106:107], v6 offset:10048
    s_waitcnt lgkmcnt(15)
    v_mfma_f32_32x32x16_bf16 v[108:123], v[76:79], v[60:63], v[108:123]
    v_mfma_f32_32x32x16_bf16 v[124:139], v[80:83], v[60:63], v[124:139]
    s_waitcnt lgkmcnt(10)
    v_mfma_f32_32x32x16_bf16 v[108:123], v[84:87], v[64:67], v[108:123]
    v_mfma_f32_32x32x16_bf16 v[124:139], v[88:91], v[64:67], v[124:139]
    s_waitcnt lgkmcnt(5)
    v_mfma_f32_32x32x16_bf16 v[108:123], v[92:95], v[68:71], v[108:123]
    v_mfma_f32_32x32x16_bf16 v[124:139], v[96:99], v[68:71], v[124:139]
    s_waitcnt lgkmcnt(0)
    v_mfma_f32_32x32x16_bf16 v[108:123], v[100:103], v[72:75], v[108:123]
    v_mfma_f32_32x32x16_bf16 v[124:139], v[104:107], v[72:75], v[124:139]
    s_waitcnt vmcnt(6)
    ds_write_b128 v3, v[28:31] offset:30720
    ds_write_b128 v3, v[32:35] offset:30736
    ds_write_b128 v3, v[36:39] offset:30752
    ds_write_b128 v3, v[40:43] offset:30768
    ds_write_b128 v4, v[52:55] offset:30720
    ds_write_b128 v4, v[56:59] offset:30736
    s_waitcnt lgkmcnt(0)
    s_barrier
    buffer_load_dwordx4 v[28:31], v1, s[12:15], 0 offen offset:896
    buffer_load_dwordx4 v[32:35], v1, s[12:15], 0 offen offset:912
    buffer_load_dwordx4 v[36:39], v1, s[12:15], 0 offen offset:928
    buffer_load_dwordx4 v[40:43], v1, s[12:15], 0 offen offset:944
    s_mov_b32 s32, 0x7e000
    buffer_load_dwordx4 v[52:55], v2, s[16:19], s32 offen offset:0
    buffer_load_dwordx4 v[56:59], v2, s[16:19], s32 offen offset:16
    ds_read_b128 v[60:63], v5 offset:30720
    ds_read_b64_tr_b16 v[76:77], v6 offset:30720
    ds_read_b64_tr_b16 v[78:79], v6 offset:31488
    ds_read_b64_tr_b16 v[80:81], v6 offset:30784
    ds_read_b64_tr_b16 v[82:83], v6 offset:31552
    ds_read_b128 v[64:67], v5 offset:30752
    ds_read_b64_tr_b16 v[84:85], v6 offset:33792
    ds_read_b64_tr_b16 v[86:87], v6 offset:34560
    ds_read_b64_tr_b16 v[88:89], v6 offset:33856
    ds_read_b64_tr_b16 v[90:91], v6 offset:34624
    ds_read_b128 v[68:71], v5 offset:30784
    ds_read_b64_tr_b16 v[92:93], v6 offset:36864
    ds_read_b64_tr_b16 v[94:95], v6 offset:37632
    ds_read_b64_tr_b16 v[96:97], v6 offset:36928
    ds_read_b64_tr_b16 v[98:99], v6 offset:37696
    ds_read_b128 v[72:75], v5 offset:30816
    ds_read_b64_tr_b16 v[100:101], v6 offset:39936
    ds_read_b64_tr_b16 v[102:103], v6 offset:40704
    ds_read_b64_tr_b16 v[104:105], v6 offset:40000
    ds_read_b64_tr_b16 v[106:107], v6 offset:40768
    s_waitcnt lgkmcnt(15)
    v_mfma_f32_32x32x16_bf16 v[108:123], v[76:79], v[60:63], v[108:123]
    v_mfma_f32_32x32x16_bf16 v[124:139], v[80:83], v[60:63], v[124:139]
    s_waitcnt lgkmcnt(10)
    v_mfma_f32_32x32x16_bf16 v[108:123], v[84:87], v[64:67], v[108:123]
    v_mfma_f32_32x32x16_bf16 v[124:139], v[88:91], v[64:67], v[124:139]
    s_waitcnt lgkmcnt(5)
    v_mfma_f32_32x32x16_bf16 v[108:123], v[92:95], v[68:71], v[108:123]
    v_mfma_f32_32x32x16_bf16 v[124:139], v[96:99], v[68:71], v[124:139]
    s_waitcnt lgkmcnt(0)
    v_mfma_f32_32x32x16_bf16 v[108:123], v[100:103], v[72:75], v[108:123]
    v_mfma_f32_32x32x16_bf16 v[124:139], v[104:107], v[72:75], v[124:139]
    s_waitcnt vmcnt(6)
    ds_write_b128 v3, v[12:15] offset:0
    ds_write_b128 v3, v[16:19] offset:16
    ds_write_b128 v3, v[20:23] offset:32
    ds_write_b128 v3, v[24:27] offset:48
    ds_write_b128 v4, v[44:47] offset:0
    ds_write_b128 v4, v[48:51] offset:16
    s_waitcnt lgkmcnt(0)
    s_barrier
    buffer_load_dwordx4 v[12:15], v1, s[12:15], 0 offen offset:1024
    buffer_load_dwordx4 v[16:19], v1, s[12:15], 0 offen offset:1040
    buffer_load_dwordx4 v[20:23], v1, s[12:15], 0 offen offset:1056
    buffer_load_dwordx4 v[24:27], v1, s[12:15], 0 offen offset:1072
    s_mov_b32 s32, 0x90000
    buffer_load_dwordx4 v[44:47], v2, s[16:19], s32 offen offset:0
    buffer_load_dwordx4 v[48:51], v2, s[16:19], s32 offen offset:16
    ds_read_b128 v[60:63], v5 offset:0
    ds_read_b64_tr_b16 v[76:77], v6 offset:0
    ds_read_b64_tr_b16 v[78:79], v6 offset:768
    ds_read_b64_tr_b16 v[80:81], v6 offset:64
    ds_read_b64_tr_b16 v[82:83], v6 offset:832
    ds_read_b128 v[64:67], v5 offset:32
    ds_read_b64_tr_b16 v[84:85], v6 offset:3072
    ds_read_b64_tr_b16 v[86:87], v6 offset:3840
    ds_read_b64_tr_b16 v[88:89], v6 offset:3136
    ds_read_b64_tr_b16 v[90:91], v6 offset:3904
    ds_read_b128 v[68:71], v5 offset:64
    ds_read_b64_tr_b16 v[92:93], v6 offset:6144
    ds_read_b64_tr_b16 v[94:95], v6 offset:6912
    ds_read_b64_tr_b16 v[96:97], v6 offset:6208
    ds_read_b64_tr_b16 v[98:99], v6 offset:6976
    ds_read_b128 v[72:75], v5 offset:96
    ds_read_b64_tr_b16 v[100:101], v6 offset:9216
    ds_read_b64_tr_b16 v[102:103], v6 offset:9984
    ds_read_b64_tr_b16 v[104:105], v6 offset:9280
    ds_read_b64_tr_b16 v[106:107], v6 offset:10048
    s_waitcnt lgkmcnt(15)
    v_mfma_f32_32x32x16_bf16 v[108:123], v[76:79], v[60:63], v[108:123]
    v_mfma_f32_32x32x16_bf16 v[124:139], v[80:83], v[60:63], v[124:139]
    s_waitcnt lgkmcnt(10)
    v_mfma_f32_32x32x16_bf16 v[108:123], v[84:87], v[64:67], v[108:123]
    v_mfma_f32_32x32x16_bf16 v[124:139], v[88:91], v[64:67], v[124:139]
    s_waitcnt lgkmcnt(5)
    v_mfma_f32_32x32x16_bf16 v[108:123], v[92:95], v[68:71], v[108:123]
    v_mfma_f32_32x32x16_bf16 v[124:139], v[96:99], v[68:71], v[124:139]
    s_waitcnt lgkmcnt(0)
    v_mfma_f32_32x32x16_bf16 v[108:123], v[100:103], v[72:75], v[108:123]
    v_mfma_f32_32x32x16_bf16 v[124:139], v[104:107], v[72:75], v[124:139]
    s_waitcnt vmcnt(6)
    ds_write_b128 v3, v[28:31] offset:30720
    ds_write_b128 v3, v[32:35] offset:30736
    ds_write_b128 v3, v[36:39] offset:30752
    ds_write_b128 v3, v[40:43] offset:30768
    ds_write_b128 v4, v[52:55] offset:30720
    ds_write_b128 v4, v[56:59] offset:30736
    s_waitcnt lgkmcnt(0)
    s_barrier
    ds_read_b128 v[60:63], v5 offset:30720
    ds_read_b64_tr_b16 v[76:77], v6 offset:30720
    ds_read_b64_tr_b16 v[78:79], v6 offset:31488
    ds_read_b64_tr_b16 v[80:81], v6 offset:30784
    ds_read_b64_tr_b16 v[82:83], v6 offset:31552
    ds_read_b128 v[64:67], v5 offset:30752
    ds_read_b64_tr_b16 v[84:85], v6 offset:33792
    ds_read_b64_tr_b16 v[86:87], v6 offset:34560
    ds_read_b64_tr_b16 v[88:89], v6 offset:33856
    ds_read_b64_tr_b16 v[90:91], v6 offset:34624
    ds_read_b128 v[68:71], v5 offset:30784
    ds_read_b64_tr_b16 v[92:93], v6 offset:36864
    ds_read_b64_tr_b16 v[94:95], v6 offset:37632
    ds_read_b64_tr_b16 v[96:97], v6 offset:36928
    ds_read_b64_tr_b16 v[98:99], v6 offset:37696
    ds_read_b128 v[72:75], v5 offset:30816
    ds_read_b64_tr_b16 v[100:101], v6 offset:39936
    ds_read_b64_tr_b16 v[102:103], v6 offset:40704
    ds_read_b64_tr_b16 v[104:105], v6 offset:40000
    ds_read_b64_tr_b16 v[106:107], v6 offset:40768
    s_waitcnt lgkmcnt(15)
    v_mfma_f32_32x32x16_bf16 v[108:123], v[76:79], v[60:63], v[108:123]
    v_mfma_f32_32x32x16_bf16 v[124:139], v[80:83], v[60:63], v[124:139]
    s_waitcnt lgkmcnt(10)
    v_mfma_f32_32x32x16_bf16 v[108:123], v[84:87], v[64:67], v[108:123]
    v_mfma_f32_32x32x16_bf16 v[124:139], v[88:91], v[64:67], v[124:139]
    s_waitcnt lgkmcnt(5)
    v_mfma_f32_32x32x16_bf16 v[108:123], v[92:95], v[68:71], v[108:123]
    v_mfma_f32_32x32x16_bf16 v[124:139], v[96:99], v[68:71], v[124:139]
    s_waitcnt lgkmcnt(0)
    v_mfma_f32_32x32x16_bf16 v[108:123], v[100:103], v[72:75], v[108:123]
    v_mfma_f32_32x32x16_bf16 v[124:139], v[104:107], v[72:75], v[124:139]
    s_waitcnt vmcnt(0)
    ds_write_b128 v3, v[12:15] offset:0
    ds_write_b128 v3, v[16:19] offset:16
    ds_write_b128 v3, v[20:23] offset:32
    ds_write_b128 v3, v[24:27] offset:48
    ds_write_b128 v4, v[44:47] offset:0
    ds_write_b128 v4, v[48:51] offset:16
    s_waitcnt lgkmcnt(0)
    s_barrier
    ds_read_b128 v[60:63], v5 offset:0
    ds_read_b64_tr_b16 v[76:77], v6 offset:0
    ds_read_b64_tr_b16 v[78:79], v6 offset:768
    ds_read_b64_tr_b16 v[80:81], v6 offset:64
    ds_read_b64_tr_b16 v[82:83], v6 offset:832
    ds_read_b128 v[64:67], v5 offset:32
    ds_read_b64_tr_b16 v[84:85], v6 offset:3072
    ds_read_b64_tr_b16 v[86:87], v6 offset:3840
    ds_read_b64_tr_b16 v[88:89], v6 offset:3136
    ds_read_b64_tr_b16 v[90:91], v6 offset:3904
    ds_read_b128 v[68:71], v5 offset:64
    ds_read_b64_tr_b16 v[92:93], v6 offset:6144
    ds_read_b64_tr_b16 v[94:95], v6 offset:6912
    ds_read_b64_tr_b16 v[96:97], v6 offset:6208
    ds_read_b64_tr_b16 v[98:99], v6 offset:6976
    ds_read_b128 v[72:75], v5 offset:96
    ds_read_b64_tr_b16 v[100:101], v6 offset:9216
    ds_read_b64_tr_b16 v[102:103], v6 offset:9984
    ds_read_b64_tr_b16 v[104:105], v6 offset:9280
    ds_read_b64_tr_b16 v[106:107], v6 offset:10048
    s_waitcnt lgkmcnt(15)
    v_mfma_f32_32x32x16_bf16 v[108:123], v[76:79], v[60:63], v[108:123]
    v_mfma_f32_32x32x16_bf16 v[124:139], v[80:83], v[60:63], v[124:139]
    s_waitcnt lgkmcnt(10)
    v_mfma_f32_32x32x16_bf16 v[108:123], v[84:87], v[64:67], v[108:123]
    v_mfma_f32_32x32x16_bf16 v[124:139], v[88:91], v[64:67], v[124:139]
    s_waitcnt lgkmcnt(5)
    v_mfma_f32_32x32x16_bf16 v[108:123], v[92:95], v[68:71], v[108:123]
    v_mfma_f32_32x32x16_bf16 v[124:139], v[96:99], v[68:71], v[124:139]
    s_waitcnt lgkmcnt(0)
    v_mfma_f32_32x32x16_bf16 v[108:123], v[100:103], v[72:75], v[108:123]
    v_mfma_f32_32x32x16_bf16 v[124:139], v[104:107], v[72:75], v[124:139]
    s_nop 7
    s_nop 7
    v_lshrrev_b32 v7, 6, v0
    v_lshlrev_b32 v7, 5, v7
    v_and_b32 v8, 31, v0
    v_add3_u32 v7, v7, v8, s30
    v_mul_u32_u24 v1, 1152, v7
    v_bfe_u32 v8, v0, 5, 1
    v_lshlrev_b32 v8, 3, v8
    v_add3_u32 v1, v1, v8, s31
    buffer_load_dwordx2 v[60:61], v1, s[24:27], 0 offen offset:0
    buffer_load_dwordx2 v[62:63], v1, s[24:27], 0 offen offset:16
    buffer_load_dwordx2 v[64:65], v1, s[24:27], 0 offen offset:32
    buffer_load_dwordx2 v[66:67], v1, s[24:27], 0 offen offset:48
    buffer_load_dwordx2 v[68:69], v1, s[24:27], 0 offen offset:64
    buffer_load_dwordx2 v[70:71], v1, s[24:27], 0 offen offset:80
    buffer_load_dwordx2 v[72:73], v1, s[24:27], 0 offen offset:96
    buffer_load_dwordx2 v[74:75], v1, s[24:27], 0 offen offset:112
    s_waitcnt vmcnt(0)
    v_cvt_pk_bf16_f32 v76, v108, v109
    v_lshlrev_b32 v108, 16, v76
    v_and_b32 v109, 0xffff0000, v76
    v_lshlrev_b32 v7, 16, v60
    v_and_b32 v8, 0xffff0000, v60
    v_add_f32 v108, v108, v7
    v_add_f32 v109, v109, v8
    v_cvt_pk_bf16_f32 v76, v108, v109
    v_cvt_pk_bf16_f32 v77, v110, v111
    v_lshlrev_b32 v110, 16, v77
    v_and_b32 v111, 0xffff0000, v77
    v_lshlrev_b32 v7, 16, v61
    v_and_b32 v8, 0xffff0000, v61
    v_add_f32 v110, v110, v7
    v_add_f32 v111, v111, v8
    v_cvt_pk_bf16_f32 v77, v110, v111
    buffer_store_dwordx2 v[76:77], v1, s[20:23], 0 offen offset:0
    v_cvt_pk_bf16_f32 v78, v112, v113
    v_lshlrev_b32 v112, 16, v78
    v_and_b32 v113, 0xffff0000, v78
    v_lshlrev_b32 v7, 16, v62
    v_and_b32 v8, 0xffff0000, v62
    v_add_f32 v112, v112, v7
    v_add_f32 v113, v113, v8
    v_cvt_pk_bf16_f32 v78, v112, v113
    v_cvt_pk_bf16_f32 v79, v114, v115
    v_lshlrev_b32 v114, 16, v79
    v_and_b32 v115, 0xffff0000, v79
    v_lshlrev_b32 v7, 16, v63
    v_and_b32 v8, 0xffff0000, v63
    v_add_f32 v114, v114, v7
    v_add_f32 v115, v115, v8
    v_cvt_pk_bf16_f32 v79, v114, v115
    buffer_store_dwordx2 v[78:79], v1, s[20:23], 0 offen offset:16
    v_cvt_pk_bf16_f32 v80, v116, v117
    v_lshlrev_b32 v116, 16, v80
    v_and_b32 v117, 0xffff0000, v80
    v_lshlrev_b32 v7, 16, v64
    v_and_b32 v8, 0xffff0000, v64
    v_add_f32 v116, v116, v7
    v_add_f32 v117, v117, v8
    v_cvt_pk_bf16_f32 v80, v116, v117
    v_cvt_pk_bf16_f32 v81, v118, v119
    v_lshlrev_b32 v118, 16, v81
    v_and_b32 v119, 0xffff0000, v81
    v_lshlrev_b32 v7, 16, v65
    v_and_b32 v8, 0xffff0000, v65
    v_add_f32 v118, v118, v7
    v_add_f32 v119, v119, v8
    v_cvt_pk_bf16_f32 v81, v118, v119
    buffer_store_dwordx2 v[80:81], v1, s[20:23], 0 offen offset:32
    v_cvt_pk_bf16_f32 v82, v120, v121
    v_lshlrev_b32 v120, 16, v82
    v_and_b32 v121, 0xffff0000, v82
    v_lshlrev_b32 v7, 16, v66
    v_and_b32 v8, 0xffff0000, v66
    v_add_f32 v120, v120, v7
    v_add_f32 v121, v121, v8
    v_cvt_pk_bf16_f32 v82, v120, v121
    v_cvt_pk_bf16_f32 v83, v122, v123
    v_lshlrev_b32 v122, 16, v83
    v_and_b32 v123, 0xffff0000, v83
    v_lshlrev_b32 v7, 16, v67
    v_and_b32 v8, 0xffff0000, v67
    v_add_f32 v122, v122, v7
    v_add_f32 v123, v123, v8
    v_cvt_pk_bf16_f32 v83, v122, v123
    buffer_store_dwordx2 v[82:83], v1, s[20:23], 0 offen offset:48
    v_cvt_pk_bf16_f32 v84, v124, v125
    v_lshlrev_b32 v124, 16, v84
    v_and_b32 v125, 0xffff0000, v84
    v_lshlrev_b32 v7, 16, v68
    v_and_b32 v8, 0xffff0000, v68
    v_add_f32 v124, v124, v7
    v_add_f32 v125, v125, v8
    v_cvt_pk_bf16_f32 v84, v124, v125
    v_cvt_pk_bf16_f32 v85, v126, v127
    v_lshlrev_b32 v126, 16, v85
    v_and_b32 v127, 0xffff0000, v85
    v_lshlrev_b32 v7, 16, v69
    v_and_b32 v8, 0xffff0000, v69
    v_add_f32 v126, v126, v7
    v_add_f32 v127, v127, v8
    v_cvt_pk_bf16_f32 v85, v126, v127
    buffer_store_dwordx2 v[84:85], v1, s[20:23], 0 offen offset:64
    v_cvt_pk_bf16_f32 v86, v128, v129
    v_lshlrev_b32 v128, 16, v86
    v_and_b32 v129, 0xffff0000, v86
    v_lshlrev_b32 v7, 16, v70
    v_and_b32 v8, 0xffff0000, v70
    v_add_f32 v128, v128, v7
    v_add_f32 v129, v129, v8
    v_cvt_pk_bf16_f32 v86, v128, v129
    v_cvt_pk_bf16_f32 v87, v130, v131
    v_lshlrev_b32 v130, 16, v87
    v_and_b32 v131, 0xffff0000, v87
    v_lshlrev_b32 v7, 16, v71
    v_and_b32 v8, 0xffff0000, v71
    v_add_f32 v130, v130, v7
    v_add_f32 v131, v131, v8
    v_cvt_pk_bf16_f32 v87, v130, v131
    buffer_store_dwordx2 v[86:87], v1, s[20:23], 0 offen offset:80
    v_cvt_pk_bf16_f32 v88, v132, v133
    v_lshlrev_b32 v132, 16, v88
    v_and_b32 v133, 0xffff0000, v88
    v_lshlrev_b32 v7, 16, v72
    v_and_b32 v8, 0xffff0000, v72
    v_add_f32 v132, v132, v7
    v_add_f32 v133, v133, v8
    v_cvt_pk_bf16_f32 v88, v132, v133
    v_cvt_pk_bf16_f32 v89, v134, v135
    v_lshlrev_b32 v134, 16, v89
    v_and_b32 v135, 0xffff0000, v89
    v_lshlrev_b32 v7, 16, v73
    v_and_b32 v8, 0xffff0000, v73
    v_add_f32 v134, v134, v7
    v_add_f32 v135, v135, v8
    v_cvt_pk_bf16_f32 v89, v134, v135
    buffer_store_dwordx2 v[88:89], v1, s[20:23], 0 offen offset:96
    v_cvt_pk_bf16_f32 v90, v136, v137
    v_lshlrev_b32 v136, 16, v90
    v_and_b32 v137, 0xffff0000, v90
    v_lshlrev_b32 v7, 16, v74
    v_and_b32 v8, 0xffff0000, v74
    v_add_f32 v136, v136, v7
    v_add_f32 v137, v137, v8
    v_cvt_pk_bf16_f32 v90, v136, v137
    v_cvt_pk_bf16_f32 v91, v138, v139
    v_lshlrev_b32 v138, 16, v91
    v_and_b32 v139, 0xffff0000, v91
    v_lshlrev_b32 v7, 16, v75
    v_and_b32 v8, 0xffff0000, v75
    v_add_f32 v138, v138, v7
    v_add_f32 v139, v139, v8
    v_cvt_pk_bf16_f32 v91, v138, v139
    buffer_store_dwordx2 v[90:91], v1, s[20:23], 0 offen offset:112
op3_kernel_done:
    s_endpgm
.section .rodata,"a"
.p2align 6
.amdhsa_kernel qkva_kernel
  .amdhsa_next_free_vgpr 140
  .amdhsa_next_free_sgpr 102
  .amdhsa_accum_offset 140
  .amdhsa_group_segment_fixed_size 0
  .amdhsa_kernarg_size 80
  .amdhsa_user_sgpr_count 2
  .amdhsa_user_sgpr_kernarg_segment_ptr 1
  .amdhsa_system_sgpr_workgroup_id_x 1
.end_amdhsa_kernel
.amdhsa_kernel qkvb_kernel
  .amdhsa_next_free_vgpr 140
  .amdhsa_next_free_sgpr 102
  .amdhsa_accum_offset 140
  .amdhsa_group_segment_fixed_size 0
  .amdhsa_kernarg_size 80
  .amdhsa_user_sgpr_count 2
  .amdhsa_user_sgpr_kernarg_segment_ptr 1
  .amdhsa_system_sgpr_workgroup_id_x 1
.end_amdhsa_kernel
.amdhsa_kernel kvred_kernel
  .amdhsa_next_free_vgpr 132
  .amdhsa_next_free_sgpr 102
  .amdhsa_accum_offset 132
  .amdhsa_group_segment_fixed_size 0
  .amdhsa_kernarg_size 80
  .amdhsa_user_sgpr_count 2
  .amdhsa_user_sgpr_kernarg_segment_ptr 1
  .amdhsa_system_sgpr_workgroup_id_x 1
.end_amdhsa_kernel
.amdhsa_kernel apply_kernel
  .amdhsa_next_free_vgpr 190
  .amdhsa_next_free_sgpr 102
  .amdhsa_accum_offset 192
  .amdhsa_group_segment_fixed_size 0
  .amdhsa_kernarg_size 80
  .amdhsa_user_sgpr_count 2
  .amdhsa_user_sgpr_kernarg_segment_ptr 1
  .amdhsa_system_sgpr_workgroup_id_x 1
.end_amdhsa_kernel
.amdhsa_kernel attn_kernel
  .amdhsa_next_free_vgpr 208
  .amdhsa_next_free_sgpr 102
  .amdhsa_accum_offset 208
  .amdhsa_group_segment_fixed_size 0
  .amdhsa_kernarg_size 80
  .amdhsa_user_sgpr_count 2
  .amdhsa_user_sgpr_kernarg_segment_ptr 1
  .amdhsa_system_sgpr_workgroup_id_x 1
.end_amdhsa_kernel
.amdhsa_kernel ln0_kernel
  .amdhsa_next_free_vgpr 35
  .amdhsa_next_free_sgpr 102
  .amdhsa_accum_offset 36
  .amdhsa_group_segment_fixed_size 0
  .amdhsa_kernarg_size 80
  .amdhsa_user_sgpr_count 2
  .amdhsa_user_sgpr_kernarg_segment_ptr 1
  .amdhsa_system_sgpr_workgroup_id_x 1
.end_amdhsa_kernel
.amdhsa_kernel op0_kernel
  .amdhsa_next_free_vgpr 140
  .amdhsa_next_free_sgpr 102
  .amdhsa_accum_offset 140
  .amdhsa_group_segment_fixed_size 0
  .amdhsa_kernarg_size 80
  .amdhsa_user_sgpr_count 2
  .amdhsa_user_sgpr_kernarg_segment_ptr 1
  .amdhsa_system_sgpr_workgroup_id_x 1
.end_amdhsa_kernel
.amdhsa_kernel ln1_kernel
  .amdhsa_next_free_vgpr 35
  .amdhsa_next_free_sgpr 102
  .amdhsa_accum_offset 36
  .amdhsa_group_segment_fixed_size 0
  .amdhsa_kernarg_size 80
  .amdhsa_user_sgpr_count 2
  .amdhsa_user_sgpr_kernarg_segment_ptr 1
  .amdhsa_system_sgpr_workgroup_id_x 1
.end_amdhsa_kernel
.amdhsa_kernel op1_kernel
  .amdhsa_next_free_vgpr 140
  .amdhsa_next_free_sgpr 102
  .amdhsa_accum_offset 140
  .amdhsa_group_segment_fixed_size 0
  .amdhsa_kernarg_size 80
  .amdhsa_user_sgpr_count 2
  .amdhsa_user_sgpr_kernarg_segment_ptr 1
  .amdhsa_system_sgpr_workgroup_id_x 1
.end_amdhsa_kernel
.amdhsa_kernel ln2_kernel
  .amdhsa_next_free_vgpr 35
  .amdhsa_next_free_sgpr 102
  .amdhsa_accum_offset 36
  .amdhsa_group_segment_fixed_size 0
  .amdhsa_kernarg_size 80
  .amdhsa_user_sgpr_count 2
  .amdhsa_user_sgpr_kernarg_segment_ptr 1
  .amdhsa_system_sgpr_workgroup_id_x 1
.end_amdhsa_kernel
.amdhsa_kernel op2_kernel
  .amdhsa_next_free_vgpr 140
  .amdhsa_next_free_sgpr 102
  .amdhsa_accum_offset 140
  .amdhsa_group_segment_fixed_size 0
  .amdhsa_kernarg_size 80
  .amdhsa_user_sgpr_count 2
  .amdhsa_user_sgpr_kernarg_segment_ptr 1
  .amdhsa_system_sgpr_workgroup_id_x 1
.end_amdhsa_kernel
.amdhsa_kernel ln3_kernel
  .amdhsa_next_free_vgpr 35
  .amdhsa_next_free_sgpr 102
  .amdhsa_accum_offset 36
  .amdhsa_group_segment_fixed_size 0
  .amdhsa_kernarg_size 80
  .amdhsa_user_sgpr_count 2
  .amdhsa_user_sgpr_kernarg_segment_ptr 1
  .amdhsa_system_sgpr_workgroup_id_x 1
.end_amdhsa_kernel
.amdhsa_kernel op3_kernel
  .amdhsa_next_free_vgpr 140
  .amdhsa_next_free_sgpr 102
  .amdhsa_accum_offset 140
  .amdhsa_group_segment_fixed_size 0
  .amdhsa_kernarg_size 80
  .amdhsa_user_sgpr_count 2
  .amdhsa_user_sgpr_kernarg_segment_ptr 1
  .amdhsa_system_sgpr_workgroup_id_x 1
.end_amdhsa_kernel
```
